```python
import torch

def _softmax(x, axis=-1):
    return torch.softmax(x, dim=axis)
def _gelu(x):
    return torch.nn.functional.gelu(x, approximate="tanh")
def _silu(x):
    return torch.nn.functional.silu(x)
def _sigmoid(x):
    return torch.sigmoid(x)
def _layernorm(x, axis=-1, eps=1e-5):
    m = x.mean(dim=axis, keepdim=True)
    v = x.var(dim=axis, keepdim=True, unbiased=False)
    return (x - m) / torch.sqrt(v + eps)
def _scatter_add(tgt, idx, src, axis=0):
    return tgt.clone().index_add_(axis, idx, src)
def _segment_sum(src, seg, n):
    out = torch.zeros((n,) + src.shape[1:], dtype=src.dtype)
    return out.index_add_(0, seg, src)
def _pad(x, pw):
    flat = tuple(v for pair in reversed(pw) for v in pair)
    return torch.nn.functional.pad(x, flat)

kernel_name = 'concat_heads__mha_block_cached__gqa_block_cached__near_ridge'

def setup_inputs():

    _w = (lambda a: (lambda t: t.to(torch.bfloat16) if t.is_floating_point() else t)(torch.as_tensor(a)))
    def _A_setup():
        B, Sq, D = 32, 32, 640
        H, Sk, Dh = 32, 32, 128
        return {
            "x": _w((lambda *s: torch.randn(*s, dtype=torch.bfloat16) * 0.8)(B, Sq, D)),
            "k_cache": _w((lambda *s: torch.randn(*s, dtype=torch.bfloat16) * 0.8)(B, H, Sk, Dh)),
            "v_cache": _w((lambda *s: torch.randn(*s, dtype=torch.bfloat16) * 0.05)(B, H, Sk, Dh)),
            "wq": _w((lambda *s: torch.randn(*s, dtype=torch.bfloat16) * 0.8)(D, H * Dh) * (D ** -0.5)),
            "wo": _w((lambda *s: torch.randn(*s, dtype=torch.bfloat16) * 0.05)(H * Dh, D) * ((H * Dh) ** -0.5)),
        }
    _A_in = _A_setup()

    def _B_setup():
        B, Sq, D = 32, 32, 640
        Hq, Hkv, Sk, Dh = 32, 32, 32, 128
        assert Hq % Hkv == 0, (Hq, Hkv)
        return {
            "x": _w((lambda *s: torch.randn(*s, dtype=torch.bfloat16) * 0.8)(B, Sq, D)),
            "k_cache": _w((lambda *s: torch.randn(*s, dtype=torch.bfloat16) * 0.8)(B, Hkv, Sk, Dh)),
            "v_cache": _w((lambda *s: torch.randn(*s, dtype=torch.bfloat16) * 0.05)(B, Hkv, Sk, Dh)),
            "wq": _w((lambda *s: torch.randn(*s, dtype=torch.bfloat16) * 0.8)(D, Hq * Dh) * (D ** -0.5)),
            "wo": _w((lambda *s: torch.randn(*s, dtype=torch.bfloat16) * 0.05)(Hq * Dh, D) * ((Hq * Dh) ** -0.5)),
        }
    _B_in = _B_setup()

    return {
        "A_x": _A_in["x"],
        "A_k_cache": _A_in["k_cache"],
        "A_v_cache": _A_in["v_cache"],
        "A_wq": _A_in["wq"],
        "A_wo": _A_in["wo"],
        "B_x": _B_in["x"],
        "B_k_cache": _B_in["k_cache"],
        "B_v_cache": _B_in["v_cache"],
        "B_wq": _B_in["wq"],
        "B_wo": _B_in["wo"],
    }

def reference(A_x, A_k_cache, A_v_cache, A_wq, A_wo, B_x, B_k_cache, B_v_cache, B_wq, B_wo):
    def _A_ref(x, k_cache, v_cache, wq, wo):
        B, Sq, D = x.shape
        H, Dh = 32, 128
        q = (lambda x, *d: x.permute(*d))((x @ wq).reshape(B, Sq, H, Dh), 0, 2, 1, 3)
        scores = torch.einsum("bhqd,bhkd->bhqk", q, k_cache) * (Dh ** -0.5)
        p = _softmax(scores, axis=-1)
        o = torch.einsum("bhqk,bhkd->bhqd", p, v_cache)
        return (lambda x, *d: x.permute(*d))(o, 0, 2, 1, 3).reshape(B, Sq, H * Dh) @ wo

    def _B_ref(x, k_cache, v_cache, wq, wo):
        B, Sq, D = x.shape
        Hq, Dh = 32, 128
        Hkv = k_cache.shape[1]
        rep = Hq // Hkv
        q = (lambda x, *d: x.permute(*d))((x @ wq).reshape(B, Sq, Hq, Dh), 0, 2, 1, 3)
        k = (lambda x, n, axis: torch.repeat_interleave(x, n, dim=axis))(k_cache, rep, axis=1)
        v = (lambda x, n, axis: torch.repeat_interleave(x, n, dim=axis))(v_cache, rep, axis=1)
        scores = torch.einsum("bhqd,bhkd->bhqk", q, k) * (Dh ** -0.5)
        p = _softmax(scores, axis=-1)
        o = torch.einsum("bhqk,bhkd->bhqd", p, v)
        return (lambda x, *d: x.permute(*d))(o, 0, 2, 1, 3).reshape(B, Sq, Hq * Dh) @ wo

    a = _A_ref(A_x, A_k_cache, A_v_cache, A_wq, A_wo)
    b = _B_ref(B_x, B_k_cache, B_v_cache, B_wq, B_wo)
    return torch.concatenate([a, b], axis=-1)
```

```asm
; @launch grid=(256,1,1) block=(512,1,1) lds=163840
.amdgcn_target "amdgcn-amd-amdhsa--gfx950"
.text
.globl concat_heads__mha_block_cached__gqa_block_cached__near_ridge_kernel
.p2align 8
.type concat_heads__mha_block_cached__gqa_block_cached__near_ridge_kernel,@function
concat_heads__mha_block_cached__gqa_block_cached__near_ridge_kernel:
    s_cmp_ge_u32 s2, 256
    s_cbranch_scc1 L_end
    v_lshrrev_b32 v33, 6, v0
    s_bfe_u32 s9, s2, 0x10002
    v_readfirstlane_b32 s31, v33
    s_mul_i32 s10, s9, 40
    v_and_b32 v0, 63, v0
    s_add_u32 s4, s0, s10
    s_addc_u32 s5, s1, 0
    s_cmp_lt_u32 s31, 4
    s_cbranch_scc1 L_compute
    s_load_dwordx2 s[36:37], s[4:5], 0
    s_load_dwordx2 s[48:49], s[4:5], 24
    s_and_b32 s35, s2, 3
    s_bfe_u32 s6, s2, 0x20003
    s_lshr_b32 s7, s2, 5
    s_and_b32 s3, s31, 3
    s_lshl_b32 s73, s3, 12
    s_mul_i32 s34, s7, 5
    v_lshrrev_b32 v33, 4, v0
    s_mul_i32 s10, s6, 5
    v_lshrrev_b32 v37, 3, v0
    s_lshr_b32 s34, s34, 2
    v_and_b32 v34, 7, v0
    s_lshr_b32 s10, s10, 1
    v_mul_u32_u24 v35, 1280, v37
    s_add_u32 s34, s34, s10
    v_xor_b32 v36, v34, v33
    s_add_u32 s34, s34, s35
    v_lshl_add_u32 v5, v36, 4, v35
    s_sub_u32 s30, s34, 10
    s_min_u32 s34, s34, s30
    v_xor_b32 v36, 4, v36
    s_lshl_b32 s10, s7, 2
    v_lshl_add_u32 v6, v36, 4, v35
    s_add_u32 s10, s10, s3
    v_add_u32 v7, 18432, v5
    s_mul_i32 s69, s10, 40960
    v_add_u32 v8, 27648, v6
    s_mov_b32 s38, 1310720
    v_add_u32 v6, 9216, v6
    s_mov_b32 s39, 0x00020000
    s_lshl_b32 s76, s34, 7
    s_add_u32 s76, s76, s69
    s_add_u32 m0, s73, 65536
    s_waitcnt lgkmcnt(0)
    buffer_load_dwordx4 v5, s[36:39], s76 offen offset:0  lds
    buffer_load_dwordx4 v6, s[36:39], s76 offen offset:1024  lds
    buffer_load_dwordx4 v7, s[36:39], s76 offen offset:2048  lds
    buffer_load_dwordx4 v8, s[36:39], s76 offen offset:3072  lds
    v_bfe_u32 v36, v0, 1, 3
    s_lshl_b32 s10, s35, 2
    v_xor_b32 v36, v36, v33
    s_add_u32 s10, s10, s6
    v_and_b32 v35, 4, v36
    s_lshl_b32 s68, s10, 9
    v_and_b32 v36, 3, v36
    s_lshl_b32 s10, s3, 17
    v_lshlrev_b32 v35, 6, v35
    s_add_u32 s68, s68, s10
    v_lshl_or_b32 v36, v36, 5, v35
    s_lshl_b32 s75, s34, 19
    v_and_b32 v35, 1, v0
    s_add_u32 s75, s75, s68
    v_lshl_or_b32 v36, v35, 4, v36
    s_mov_b32 s50, 5242880
    v_lshl_or_b32 v1, v33, 13, v36
    s_mov_b32 s51, 0x00020000
    v_add_u32 v2, 31744, v1
    v_xor_b32 v3, 0x100, v1
    v_add_u32 v4, 95232, v3
    v_add_u32 v3, 63488, v3
    s_add_u32 m0, s73, 0
    s_nop 0
    buffer_load_dwordx4 v1, s[48:51], s75 offen offset:0  lds
    buffer_load_dwordx4 v2, s[48:51], s75 offen offset:1024  lds
    buffer_load_dwordx4 v3, s[48:51], s75 offen offset:2048  lds
    buffer_load_dwordx4 v4, s[48:51], s75 offen offset:3072  lds
    s_load_dwordx2 s[40:41], s[4:5], 8
    s_load_dwordx2 s[44:45], s[4:5], 16
    s_load_dwordx2 s[52:53], s[4:5], 32
    s_load_dwordx2 s[56:57], s[0:1], 80
    s_load_dwordx2 s[64:65], s[0:1], 96
    v_lshlrev_b32 v28, 4, v0
    s_getpc_b64 s[22:23]
L_pc:
    s_lshr_b32 s10, s2, 3
    s_lshl_b32 s10, s10, 11
    v_and_b32 v35, 15, v0
    v_lshlrev_b32 v35, 7, v35
    v_add_u32 v35, s10, v35
    v_min_u32 v35, L_code_end-concat_heads__mha_block_cached__gqa_block_cached__near_ridge_kernel-4, v35
    s_sub_u32 s22, s22, L_pc-concat_heads__mha_block_cached__gqa_block_cached__near_ridge_kernel
    s_subb_u32 s23, s23, 0
    global_load_dword v38, v35, s[22:23]
    s_mov_b32 s42, 8388608
    s_mov_b32 s43, 0x00020000
    v_and_b32 v35, 15, v0
    v_xor_b32 v35, v35, v33
    v_lshlrev_b32 v35, 4, v35
    v_lshl_or_b32 v9, v33, 8, v35
    v_xor_b32 v10, 64, v9
    v_xor_b32 v11, 0x80, v9
    v_xor_b32 v12, 0xc0, v9
    v_lshlrev_b32 v35, 1, v33
    v_xor_b32 v35, v35, v34
    v_lshlrev_b32 v35, 4, v35
    v_lshl_or_b32 v13, v37, 8, v35
    v_add_u32 v14, 1024, v13
    v_add_u32 v15, 2048, v13
    v_add_u32 v16, 3072, v13
    s_lshl_b32 s10, s7, 1
    s_lshr_b32 s11, s3, 1
    s_add_u32 s10, s10, s11
    s_lshl_b32 s10, s10, 6
    s_lshl_b32 s11, s35, 3
    s_add_u32 s10, s10, s11
    s_lshl_b32 s11, s6, 1
    s_add_u32 s10, s10, s11
    s_and_b32 s11, s3, 1
    s_add_u32 s10, s10, s11
    s_xor_b32 s75, s75, 128
    s_add_u32 m0, s73, 16384
    s_nop 0
    buffer_load_dwordx4 v1, s[48:51], s75 offen offset:0  lds
    s_lshl_b32 s70, s10, 13
    s_lshr_b32 s33, s2, 3
    s_lshl_b32 s10, s7, 2
    s_add_u32 s10, s10, s3
    s_lshl_b32 s10, s10, 2
    s_add_u32 s10, s10, s35
    s_lshl_b32 s71, s10, 16
    s_mov_b32 s46, 8388608
    s_mov_b32 s47, 0x00020000
    s_mov_b32 s54, 5242880
    s_mov_b32 s55, 0x00020000
    s_mov_b32 s66, 268435456
    s_mov_b32 s67, 0x00020000
    s_lshl_b32 s10, s9, 3
    s_add_u32 s10, s10, s7
    s_lshl_b32 s8, s10, 2
    s_add_u32 s8, s8, s6
    s_lshl_b32 s10, s8, 18
    s_add_u32 s10, s10, s73
    s_lshl_b32 s11, s35, 14
    s_add_u32 s79, s10, s11
    s_lshl_b32 s11, s35, 16
    s_add_u32 s80, s10, s11
    s_lshl_b32 s10, s9, 3
    s_add_u32 s10, s10, s7
    s_lshl_b32 s10, s10, 7
    buffer_load_dwordx4 v2, s[48:51], s75 offen offset:1024  lds
    s_lshl_b32 s11, s35, 3
    s_add_u32 s10, s10, s11
    s_lshl_b32 s11, s3, 5
    s_add_u32 s11, s11, s10
    s_lshl_b32 s11, s11, 11
    s_add_u32 s83, s11, 16777216
    s_lshr_b32 s11, s3, 1
    s_lshl_b32 s11, s11, 6
    s_add_u32 s10, s10, s11
    s_lshl_b32 s11, s6, 1
    s_add_u32 s10, s10, s11
    s_and_b32 s11, s3, 1
    s_add_u32 s10, s10, s11
    s_lshl_b32 s10, s10, 11
    s_add_u32 s81, s10, 16777216
    s_lshl_b32 s10, s8, 13
    s_lshl_b32 s11, s3, 9
    s_add_u32 s10, s10, s11
    s_add_u32 s82, s10, 20971520
    s_lshl_b32 s11, s35, 11
    s_add_u32 s98, s82, s11
    v_mov_b32 v33, 1073741824
    v_cmp_eq_u32 vcc, 0, v0
    v_mov_b32 v35, 0
    v_mov_b32 v31, 1
    v_cndmask_b32 v30, v33, v35, vcc
    buffer_load_dwordx4 v3, s[48:51], s75 offen offset:2048  lds
    v_lshlrev_b32 v29, 3, v0
    v_lshlrev_b32 v54, 7, v0
    v_min_u32 v35, 47, v0
    v_mul_u32_u24 v36, 86, v35
    v_lshrrev_b32 v36, 8, v36
    v_mul_u32_u24 v55, 896, v36
    v_lshl_add_u32 v55, v35, 7, v55
    s_and_b32 s86, s7, 1
    s_lshl_b32 s86, s86, 1
    s_add_u32 s86, s86, s6
    s_and_b32 s86, s86, 3
    s_lshl_b32 s10, s35, 7
    s_andn2_b32 s11, s7, 1
    s_lshl_b32 s11, s11, 2
    s_add_u32 s10, s10, s11
    s_lshl_b32 s11, s3, 1
    s_add_u32 s10, s10, s11
    s_mul_i32 s10, s10, 10240
    s_mul_i32 s11, s86, 320
    s_and_b32 s11, s11, 0xffffff80
    s_add_u32 s87, s10, s11
    v_mov_b32 v35, 1073741824
    v_cmp_gt_u32 vcc, 3, v0
    s_nop 1
    v_cndmask_b32 v22, v35, v54, vcc
    buffer_load_dwordx4 v4, s[48:51], s75 offen offset:3072  lds
    s_waitcnt lgkmcnt(0)
    s_waitcnt vmcnt(5)
    s_barrier
    s_and_b32 s10, s33, 3
    s_cmp_eq_u32 s10, 1
    s_cbranch_scc1 L_var1
    s_cmp_eq_u32 s10, 2
    s_cbranch_scc1 L_var2
    s_cmp_eq_u32 s10, 3
    s_cbranch_scc1 L_var3
L_var0:
    s_add_u32 s34, s34, 1
    s_cmp_eq_u32 s34, 10
    s_cselect_b32 s34, 0, s34
    s_lshl_b32 s76, s34, 7
    s_add_u32 s76, s76, s69
    s_lshl_b32 s75, s34, 19
    s_add_u32 s75, s75, s68
    s_add_u32 m0, s73, 81920
    s_nop 0
    buffer_load_dwordx4 v5, s[36:39], s76 offen offset:0  lds
    buffer_load_dwordx4 v6, s[36:39], s76 offen offset:1024  lds
    buffer_load_dwordx4 v7, s[36:39], s76 offen offset:2048  lds
    buffer_load_dwordx4 v8, s[36:39], s76 offen offset:3072  lds
    s_add_u32 m0, s73, 32768
    s_nop 0
    buffer_load_dwordx4 v1, s[48:51], s75 offen offset:0  lds
    buffer_load_dwordx4 v2, s[48:51], s75 offen offset:1024  lds
    buffer_load_dwordx4 v3, s[48:51], s75 offen offset:2048  lds
    buffer_load_dwordx4 v4, s[48:51], s75 offen offset:3072  lds
    s_xor_b32 s75, s75, 128
    s_add_u32 m0, s73, 49152
    s_nop 0
    buffer_load_dwordx4 v1, s[48:51], s75 offen offset:0  lds
    buffer_load_dwordx4 v2, s[48:51], s75 offen offset:1024  lds
    buffer_load_dwordx4 v3, s[48:51], s75 offen offset:2048  lds
    buffer_load_dwordx4 v4, s[48:51], s75 offen offset:3072  lds
    s_waitcnt vmcnt(12)
    s_barrier
    s_add_u32 s34, s34, 1
    s_cmp_eq_u32 s34, 10
    s_cselect_b32 s34, 0, s34
    s_lshl_b32 s76, s34, 7
    s_add_u32 s76, s76, s69
    s_lshl_b32 s75, s34, 19
    s_add_u32 s75, s75, s68
    s_add_u32 m0, s73, 65536
    s_nop 0
    buffer_load_dwordx4 v5, s[36:39], s76 offen offset:0  lds
    buffer_load_dwordx4 v6, s[36:39], s76 offen offset:1024  lds
    buffer_load_dwordx4 v7, s[36:39], s76 offen offset:2048  lds
    buffer_load_dwordx4 v8, s[36:39], s76 offen offset:3072  lds
    s_add_u32 m0, s73, 0
    s_nop 0
    buffer_load_dwordx4 v1, s[48:51], s75 offen offset:0  lds
    buffer_load_dwordx4 v2, s[48:51], s75 offen offset:1024  lds
    buffer_load_dwordx4 v3, s[48:51], s75 offen offset:2048  lds
    buffer_load_dwordx4 v4, s[48:51], s75 offen offset:3072  lds
    s_waitcnt vmcnt(12)
    s_barrier
    s_xor_b32 s75, s75, 128
    s_add_u32 m0, s73, 16384
    s_nop 0
    buffer_load_dwordx4 v1, s[48:51], s75 offen offset:0  lds
    buffer_load_dwordx4 v2, s[48:51], s75 offen offset:1024  lds
    buffer_load_dwordx4 v3, s[48:51], s75 offen offset:2048  lds
    buffer_load_dwordx4 v4, s[48:51], s75 offen offset:3072  lds
    s_waitcnt vmcnt(12)
    s_barrier
    s_add_u32 s34, s34, 1
    s_cmp_eq_u32 s34, 10
    s_cselect_b32 s34, 0, s34
    s_lshl_b32 s76, s34, 7
    s_add_u32 s76, s76, s69
    s_lshl_b32 s75, s34, 19
    s_add_u32 s75, s75, s68
    s_add_u32 m0, s73, 81920
    s_nop 0
    buffer_load_dwordx4 v5, s[36:39], s76 offen offset:0  lds
    buffer_load_dwordx4 v6, s[36:39], s76 offen offset:1024  lds
    buffer_load_dwordx4 v7, s[36:39], s76 offen offset:2048  lds
    buffer_load_dwordx4 v8, s[36:39], s76 offen offset:3072  lds
    s_add_u32 m0, s73, 32768
    s_nop 0
    buffer_load_dwordx4 v1, s[48:51], s75 offen offset:0  lds
    buffer_load_dwordx4 v2, s[48:51], s75 offen offset:1024  lds
    buffer_load_dwordx4 v3, s[48:51], s75 offen offset:2048  lds
    buffer_load_dwordx4 v4, s[48:51], s75 offen offset:3072  lds
    s_add_u32 s77, s70, 0
    s_lshl_b32 s78, s73, 2
    s_add_u32 m0, s78, 98304
    s_nop 0
    buffer_load_dwordx4 v9, s[40:43], s77 offen offset:0 nt lds
    buffer_load_dwordx4 v10, s[40:43], s77 offen offset:1024 nt lds
    buffer_load_dwordx4 v11, s[40:43], s77 offen offset:2048 nt lds
    buffer_load_dwordx4 v12, s[40:43], s77 offen offset:3072 nt lds
    s_add_u32 s77, s70, 4096
    s_lshl_b32 s78, s73, 2
    s_add_u32 m0, s78, 102400
    s_nop 0
    buffer_load_dwordx4 v9, s[40:43], s77 offen offset:0 nt lds
    buffer_load_dwordx4 v10, s[40:43], s77 offen offset:1024 nt lds
    buffer_load_dwordx4 v11, s[40:43], s77 offen offset:2048 nt lds
    buffer_load_dwordx4 v12, s[40:43], s77 offen offset:3072 nt lds
    s_waitcnt vmcnt(20)
    s_barrier
    s_waitcnt vmcnt(16)
    s_barrier
    s_xor_b32 s75, s75, 128
    s_add_u32 m0, s73, 49152
    s_nop 0
    buffer_load_dwordx4 v1, s[48:51], s75 offen offset:0  lds
    buffer_load_dwordx4 v2, s[48:51], s75 offen offset:1024  lds
    buffer_load_dwordx4 v3, s[48:51], s75 offen offset:2048  lds
    buffer_load_dwordx4 v4, s[48:51], s75 offen offset:3072  lds
    s_add_u32 s34, s34, 1
    s_cmp_eq_u32 s34, 10
    s_cselect_b32 s34, 0, s34
    s_lshl_b32 s76, s34, 7
    s_add_u32 s76, s76, s69
    s_lshl_b32 s75, s34, 19
    s_add_u32 s75, s75, s68
    s_add_u32 m0, s73, 65536
    s_nop 0
    buffer_load_dwordx4 v5, s[36:39], s76 offen offset:0  lds
    buffer_load_dwordx4 v6, s[36:39], s76 offen offset:1024  lds
    buffer_load_dwordx4 v7, s[36:39], s76 offen offset:2048  lds
    buffer_load_dwordx4 v8, s[36:39], s76 offen offset:3072  lds
    s_waitcnt vmcnt(16)
    s_barrier
    s_add_u32 m0, s73, 0
    s_nop 0
    buffer_load_dwordx4 v1, s[48:51], s75 offen offset:0  lds
    buffer_load_dwordx4 v2, s[48:51], s75 offen offset:1024  lds
    buffer_load_dwordx4 v3, s[48:51], s75 offen offset:2048  lds
    buffer_load_dwordx4 v4, s[48:51], s75 offen offset:3072  lds
    s_xor_b32 s75, s75, 128
    s_add_u32 m0, s73, 16384
    s_nop 0
    buffer_load_dwordx4 v1, s[48:51], s75 offen offset:0  lds
    buffer_load_dwordx4 v2, s[48:51], s75 offen offset:1024  lds
    buffer_load_dwordx4 v3, s[48:51], s75 offen offset:2048  lds
    buffer_load_dwordx4 v4, s[48:51], s75 offen offset:3072  lds
    s_waitcnt vmcnt(12)
    s_barrier
    s_add_u32 s34, s34, 1
    s_cmp_eq_u32 s34, 10
    s_cselect_b32 s34, 0, s34
    s_lshl_b32 s76, s34, 7
    s_add_u32 s76, s76, s69
    s_lshl_b32 s75, s34, 19
    s_add_u32 s75, s75, s68
    s_add_u32 m0, s73, 81920
    s_nop 0
    buffer_load_dwordx4 v5, s[36:39], s76 offen offset:0  lds
    buffer_load_dwordx4 v6, s[36:39], s76 offen offset:1024  lds
    buffer_load_dwordx4 v7, s[36:39], s76 offen offset:2048  lds
    buffer_load_dwordx4 v8, s[36:39], s76 offen offset:3072  lds
    s_add_u32 m0, s73, 32768
    s_nop 0
    buffer_load_dwordx4 v1, s[48:51], s75 offen offset:0  lds
    buffer_load_dwordx4 v2, s[48:51], s75 offen offset:1024  lds
    buffer_load_dwordx4 v3, s[48:51], s75 offen offset:2048  lds
    buffer_load_dwordx4 v4, s[48:51], s75 offen offset:3072  lds
    s_waitcnt vmcnt(12)
    s_barrier
    s_xor_b32 s75, s75, 128
    s_add_u32 m0, s73, 49152
    s_nop 0
    buffer_load_dwordx4 v1, s[48:51], s75 offen offset:0  lds
    buffer_load_dwordx4 v2, s[48:51], s75 offen offset:1024  lds
    buffer_load_dwordx4 v3, s[48:51], s75 offen offset:2048  lds
    buffer_load_dwordx4 v4, s[48:51], s75 offen offset:3072  lds
    s_waitcnt vmcnt(12)
    s_barrier
    s_add_u32 s34, s34, 1
    s_cmp_eq_u32 s34, 10
    s_cselect_b32 s34, 0, s34
    s_lshl_b32 s76, s34, 7
    s_add_u32 s76, s76, s69
    s_lshl_b32 s75, s34, 19
    s_add_u32 s75, s75, s68
    s_add_u32 m0, s73, 65536
    s_nop 0
    buffer_load_dwordx4 v5, s[36:39], s76 offen offset:0  lds
    buffer_load_dwordx4 v6, s[36:39], s76 offen offset:1024  lds
    buffer_load_dwordx4 v7, s[36:39], s76 offen offset:2048  lds
    buffer_load_dwordx4 v8, s[36:39], s76 offen offset:3072  lds
    s_add_u32 m0, s73, 0
    s_nop 0
    buffer_load_dwordx4 v1, s[48:51], s75 offen offset:0  lds
    buffer_load_dwordx4 v2, s[48:51], s75 offen offset:1024  lds
    buffer_load_dwordx4 v3, s[48:51], s75 offen offset:2048  lds
    buffer_load_dwordx4 v4, s[48:51], s75 offen offset:3072  lds
    s_add_u32 s77, s70, 262144
    s_lshl_b32 s78, s73, 2
    s_add_u32 m0, s78, 106496
    s_nop 0
    buffer_load_dwordx4 v9, s[40:43], s77 offen offset:0 nt lds
    buffer_load_dwordx4 v10, s[40:43], s77 offen offset:1024 nt lds
    buffer_load_dwordx4 v11, s[40:43], s77 offen offset:2048 nt lds
    buffer_load_dwordx4 v12, s[40:43], s77 offen offset:3072 nt lds
    s_add_u32 s77, s70, 266240
    s_lshl_b32 s78, s73, 2
    s_add_u32 m0, s78, 110592
    s_nop 0
    buffer_load_dwordx4 v9, s[40:43], s77 offen offset:0 nt lds
    buffer_load_dwordx4 v10, s[40:43], s77 offen offset:1024 nt lds
    buffer_load_dwordx4 v11, s[40:43], s77 offen offset:2048 nt lds
    buffer_load_dwordx4 v12, s[40:43], s77 offen offset:3072 nt lds
    s_waitcnt vmcnt(20)
    s_barrier
    s_waitcnt vmcnt(16)
    s_barrier
    s_xor_b32 s75, s75, 128
    s_add_u32 m0, s73, 16384
    s_nop 0
    buffer_load_dwordx4 v1, s[48:51], s75 offen offset:0  lds
    buffer_load_dwordx4 v2, s[48:51], s75 offen offset:1024  lds
    buffer_load_dwordx4 v3, s[48:51], s75 offen offset:2048  lds
    buffer_load_dwordx4 v4, s[48:51], s75 offen offset:3072  lds
    s_add_u32 s34, s34, 1
    s_cmp_eq_u32 s34, 10
    s_cselect_b32 s34, 0, s34
    s_lshl_b32 s76, s34, 7
    s_add_u32 s76, s76, s69
    s_lshl_b32 s75, s34, 19
    s_add_u32 s75, s75, s68
    s_add_u32 m0, s73, 81920
    s_nop 0
    buffer_load_dwordx4 v5, s[36:39], s76 offen offset:0  lds
    buffer_load_dwordx4 v6, s[36:39], s76 offen offset:1024  lds
    buffer_load_dwordx4 v7, s[36:39], s76 offen offset:2048  lds
    buffer_load_dwordx4 v8, s[36:39], s76 offen offset:3072  lds
    s_waitcnt vmcnt(16)
    s_barrier
    s_add_u32 m0, s73, 32768
    s_nop 0
    buffer_load_dwordx4 v1, s[48:51], s75 offen offset:0  lds
    buffer_load_dwordx4 v2, s[48:51], s75 offen offset:1024  lds
    buffer_load_dwordx4 v3, s[48:51], s75 offen offset:2048  lds
    buffer_load_dwordx4 v4, s[48:51], s75 offen offset:3072  lds
    s_xor_b32 s75, s75, 128
    s_add_u32 m0, s73, 49152
    s_nop 0
    buffer_load_dwordx4 v1, s[48:51], s75 offen offset:0  lds
    buffer_load_dwordx4 v2, s[48:51], s75 offen offset:1024  lds
    buffer_load_dwordx4 v3, s[48:51], s75 offen offset:2048  lds
    buffer_load_dwordx4 v4, s[48:51], s75 offen offset:3072  lds
    s_mov_b32 s58, 2621440
    s_mov_b32 s59, 0x00020000
    s_lshl_b32 s10, s7, 2
    s_add_u32 s10, s10, s3
    s_mul_i32 s10, s10, 81920
    s_mul_i32 s11, s9, 1280
    s_add_u32 s10, s10, s11
    s_mul_i32 s11, s86, 320
    s_add_u32 s10, s10, s11
    s_lshl_b32 s30, s35, 6
    s_add_u32 s90, s10, s30
    s_and_b32 s30, s35, 1
    s_mul_i32 s30, s30, 40960
    s_add_u32 s10, s10, s30
    s_lshr_b32 s30, s35, 1
    s_lshl_b32 s30, s30, 5
    s_add_u32 s10, s10, s30
    s_add_u32 s91, s10, 256
    s_lshl_b32 s10, s35, 6
    s_add_u32 s10, s10, s3
    s_mul_i32 s10, s10, 20480
    s_add_u32 s72, s10, s11
    s_mul_i32 s74, s3, 5120
    s_add_u32 s10, s35, 1
    s_movk_i32 s11, 3277
    v_add_u32 v33, 0, v0
    v_mul_u32_u24 v34, s11, v33
    v_lshrrev_b32 v34, 16, v34
    v_mul_u32_u24 v35, 20, v34
    v_sub_u32 v33, v33, v35
    v_lshrrev_b32 v35, 2, v33
    v_add_u32 v36, s10, v35
    v_and_b32 v36, 3, v36
    v_cmp_gt_u32 vcc, 4, v35
    v_and_b32 v33, 3, v33
    v_bfe_u32 v37, v34, 2, 1
    v_cndmask_b32 v35, v35, v36, vcc
    v_lshlrev_b32 v37, 1, v37
    v_xor_b32 v33, v33, v37
    v_lshlrev_b32 v33, 4, v33
    v_lshl_or_b32 v33, v35, 6, v33
    v_mul_u32_u24 v34, 1280, v34
    v_add_u32 v17, v33, v34
    v_add_u32 v33, 64, v0
    v_mul_u32_u24 v34, s11, v33
    v_lshrrev_b32 v34, 16, v34
    v_mul_u32_u24 v35, 20, v34
    v_sub_u32 v33, v33, v35
    v_lshrrev_b32 v35, 2, v33
    v_add_u32 v36, s10, v35
    v_and_b32 v36, 3, v36
    v_cmp_gt_u32 vcc, 4, v35
    v_and_b32 v33, 3, v33
    v_bfe_u32 v37, v34, 2, 1
    v_cndmask_b32 v35, v35, v36, vcc
    v_lshlrev_b32 v37, 1, v37
    v_xor_b32 v33, v33, v37
    v_lshlrev_b32 v33, 4, v33
    v_lshl_or_b32 v33, v35, 6, v33
    v_mul_u32_u24 v34, 1280, v34
    v_add_u32 v18, v33, v34
    v_subrev_u32 v18, 1024, v18
    v_add_u32 v33, 128, v0
    v_mul_u32_u24 v34, s11, v33
    v_lshrrev_b32 v34, 16, v34
    v_mul_u32_u24 v35, 20, v34
    v_sub_u32 v33, v33, v35
    v_lshrrev_b32 v35, 2, v33
    v_add_u32 v36, s10, v35
    v_and_b32 v36, 3, v36
    v_cmp_gt_u32 vcc, 4, v35
    v_and_b32 v33, 3, v33
    v_bfe_u32 v37, v34, 2, 1
    v_cndmask_b32 v35, v35, v36, vcc
    v_lshlrev_b32 v37, 1, v37
    v_xor_b32 v33, v33, v37
    v_lshlrev_b32 v33, 4, v33
    v_lshl_or_b32 v33, v35, 6, v33
    v_mul_u32_u24 v34, 1280, v34
    v_add_u32 v19, v33, v34
    v_subrev_u32 v19, 2048, v19
    v_add_u32 v33, 192, v0
    v_mul_u32_u24 v34, s11, v33
    v_lshrrev_b32 v34, 16, v34
    v_mul_u32_u24 v35, 20, v34
    v_sub_u32 v33, v33, v35
    v_lshrrev_b32 v35, 2, v33
    v_add_u32 v36, s10, v35
    v_and_b32 v36, 3, v36
    v_cmp_gt_u32 vcc, 4, v35
    v_and_b32 v33, 3, v33
    v_bfe_u32 v37, v34, 2, 1
    v_cndmask_b32 v35, v35, v36, vcc
    v_lshlrev_b32 v37, 1, v37
    v_xor_b32 v33, v33, v37
    v_lshlrev_b32 v33, 4, v33
    v_lshl_or_b32 v33, v35, 6, v33
    v_mul_u32_u24 v34, 1280, v34
    v_add_u32 v20, v33, v34
    s_waitcnt vmcnt(12)
    s_barrier
    s_add_u32 s34, s34, 1
    s_cmp_eq_u32 s34, 10
    s_cselect_b32 s34, 0, s34
    s_lshl_b32 s76, s34, 7
    s_add_u32 s76, s76, s69
    s_lshl_b32 s75, s34, 19
    s_add_u32 s75, s75, s68
    s_add_u32 m0, s73, 65536
    s_nop 0
    buffer_load_dwordx4 v5, s[36:39], s76 offen offset:0  lds
    buffer_load_dwordx4 v6, s[36:39], s76 offen offset:1024  lds
    buffer_load_dwordx4 v7, s[36:39], s76 offen offset:2048  lds
    buffer_load_dwordx4 v8, s[36:39], s76 offen offset:3072  lds
    s_add_u32 m0, s73, 0
    s_nop 0
    buffer_load_dwordx4 v1, s[48:51], s75 offen offset:0  lds
    buffer_load_dwordx4 v2, s[48:51], s75 offen offset:1024  lds
    buffer_load_dwordx4 v3, s[48:51], s75 offen offset:2048  lds
    buffer_load_dwordx4 v4, s[48:51], s75 offen offset:3072  lds
    v_subrev_u32 v20, 3072, v20
    v_add_u32 v33, 256, v0
    v_mul_u32_u24 v34, s11, v33
    v_lshrrev_b32 v34, 16, v34
    v_mul_u32_u24 v35, 20, v34
    v_sub_u32 v33, v33, v35
    v_lshrrev_b32 v35, 2, v33
    v_add_u32 v36, s10, v35
    v_and_b32 v36, 3, v36
    v_cmp_gt_u32 vcc, 4, v35
    v_and_b32 v33, 3, v33
    v_bfe_u32 v37, v34, 2, 1
    v_cndmask_b32 v35, v35, v36, vcc
    v_lshlrev_b32 v37, 1, v37
    v_xor_b32 v33, v33, v37
    v_lshlrev_b32 v33, 4, v33
    v_lshl_or_b32 v33, v35, 6, v33
    v_mul_u32_u24 v34, 1280, v34
    v_add_u32 v21, v33, v34
    v_and_b32 v33, 15, v0
    v_lshrrev_b32 v34, 4, v0
    v_lshrrev_b32 v35, 1, v34
    v_bfe_u32 v36, v0, 1, 2
    v_xor_b32 v36, v36, v35
    v_lshlrev_b32 v36, 4, v36
    v_and_b32 v37, 1, v34
    v_lshl_or_b32 v36, v37, 3, v36
    v_lshl_or_b32 v36, v33, 6, v36
    s_add_u32 s10, s73, 16384
    v_add_u32 v47, s10, v36
    v_lshlrev_b32 v36, 3, v34
    v_lshl_or_b32 v36, v33, 5, v36
    s_add_u32 s11, s10, 2048
    v_add_u32 v48, s11, v36
    v_add_u32 v50, s11, v28
    v_lshrrev_b32 v33, 2, v0
    v_and_b32 v34, 3, v0
    v_bfe_u32 v35, v0, 3, 2
    v_xor_b32 v35, v35, v34
    v_lshlrev_b32 v35, 4, v35
    v_lshl_or_b32 v35, v33, 6, v35
    v_add_u32 v49, s10, v35
    v_mul_u32_u24 v33, 2560, v33
    v_lshl_or_b32 v51, v34, 4, v33
    v_add_u32 v52, 40960, v51
    v_lshrrev_b32 v33, 1, v0
    v_and_b32 v34, 1, v0
    v_mul_u32_u24 v33, 2560, v33
    v_lshl_or_b32 v33, v34, 4, v33
    v_mov_b32 v34, 1073741824
    v_cmp_gt_u32 vcc, 32, v0
    v_add_u32 v46, s73, v28
    s_lshl_b32 s10, s35, 10
    s_add_u32 s10, s10, 32768
    v_add_u32 v56, s10, v46
    v_mov_b32 v40, 0
    v_cndmask_b32 v53, v34, v33, vcc
    v_and_b32 v33, 1, v0
    v_lshlrev_b32 v33, 4, v33
    v_mov_b32 v34, 0x3f80
    v_lshlrev_b32 v33, v33, v34
    v_lshrrev_b32 v34, 4, v0
    v_bfe_u32 v35, v0, 2, 2
    v_cmp_eq_u32 vcc, v34, v35
    v_mov_b32 v41, 0
    v_and_b32 v35, 3, v0
    v_cndmask_b32 v33, v40, v33, vcc
    v_cmp_gt_u32 vcc, 2, v35
    v_mov_b32 v44, 0
    v_mov_b32 v45, 0
    v_cndmask_b32 v42, v40, v33, vcc
    v_cndmask_b32 v43, v33, v40, vcc
    v_mov_b32 v112, 0
    v_mov_b32 v113, 0
    v_mov_b32 v114, 0
    v_mov_b32 v115, 0
    v_mov_b32 v116, 0
    v_mov_b32 v117, 0
    v_mov_b32 v118, 0
    v_mov_b32 v119, 0
    v_mov_b32 v120, 0
    v_mov_b32 v121, 0
    v_mov_b32 v122, 0
    v_mov_b32 v123, 0
    v_mov_b32 v124, 0
    v_mov_b32 v125, 0
    v_mov_b32 v126, 0
    v_mov_b32 v127, 0
    v_mov_b32 v128, 0
    v_mov_b32 v129, 0
    v_mov_b32 v130, 0
    v_mov_b32 v131, 0
    v_mov_b32 v74, 0
    v_mov_b32 v75, 0
    v_mov_b32 v86, 0
    v_mov_b32 v87, 0
    v_mov_b32 v98, 0
    v_mov_b32 v99, 0
    v_mov_b32 v110, 0
    v_mov_b32 v111, 0
    s_waitcnt vmcnt(12)
    s_barrier
    s_xor_b32 s75, s75, 128
    s_add_u32 m0, s73, 16384
    s_nop 0
    buffer_load_dwordx4 v1, s[48:51], s75 offen offset:0  lds
    buffer_load_dwordx4 v2, s[48:51], s75 offen offset:1024  lds
    buffer_load_dwordx4 v3, s[48:51], s75 offen offset:2048  lds
    buffer_load_dwordx4 v4, s[48:51], s75 offen offset:3072  lds
    s_waitcnt vmcnt(12)
    s_barrier
    s_add_u32 s34, s34, 1
    s_cmp_eq_u32 s34, 10
    s_cselect_b32 s34, 0, s34
    s_lshl_b32 s76, s34, 7
    s_add_u32 s76, s76, s69
    s_lshl_b32 s75, s34, 19
    s_add_u32 s75, s75, s68
    s_add_u32 m0, s73, 81920
    s_nop 0
    buffer_load_dwordx4 v5, s[36:39], s76 offen offset:0  lds
    buffer_load_dwordx4 v6, s[36:39], s76 offen offset:1024  lds
    buffer_load_dwordx4 v7, s[36:39], s76 offen offset:2048  lds
    buffer_load_dwordx4 v8, s[36:39], s76 offen offset:3072  lds
    s_add_u32 m0, s73, 32768
    s_nop 0
    buffer_load_dwordx4 v1, s[48:51], s75 offen offset:0  lds
    buffer_load_dwordx4 v2, s[48:51], s75 offen offset:1024  lds
    buffer_load_dwordx4 v3, s[48:51], s75 offen offset:2048  lds
    buffer_load_dwordx4 v4, s[48:51], s75 offen offset:3072  lds
    s_add_u32 s78, s6, 0
    s_and_b32 s78, s78, 3
    s_mul_i32 s78, s78, 327680
    s_add_u32 s78, s78, s87
    buffer_load_dword v38, v55, s[52:55], s78 offen
    s_waitcnt vmcnt(13)
    s_barrier
    s_xor_b32 s75, s75, 128
    s_add_u32 m0, s73, 49152
    s_nop 0
    buffer_load_dwordx4 v1, s[48:51], s75 offen offset:0  lds
    buffer_load_dwordx4 v2, s[48:51], s75 offen offset:1024  lds
    buffer_load_dwordx4 v3, s[48:51], s75 offen offset:2048  lds
    buffer_load_dwordx4 v4, s[48:51], s75 offen offset:3072  lds
    s_waitcnt vmcnt(13)
    s_barrier
    s_lshl_b32 s77, s6, 1
    s_add_u32 s77, s77, 0
    s_and_b32 s77, s77, 7
    s_lshl_b32 s77, s77, 13
    s_add_u32 s77, s77, s71
    s_add_u32 m0, s73, 0
    s_nop 0
    buffer_load_dwordx4 v13, s[44:47], s77 offen offset:0  lds
    buffer_load_dwordx4 v14, s[44:47], s77 offen offset:1024  lds
    buffer_load_dwordx4 v15, s[44:47], s77 offen offset:2048  lds
    buffer_load_dwordx4 v16, s[44:47], s77 offen offset:3072  lds
    s_waitcnt vmcnt(9)
    s_barrier
    s_lshl_b32 s77, s6, 1
    s_add_u32 s77, s77, 0
    s_and_b32 s77, s77, 7
    s_lshl_b32 s77, s77, 13
    s_add_u32 s77, s77, s71
    s_add_u32 s77, s77, 128
    s_add_u32 m0, s73, 16384
    s_nop 0
    buffer_load_dwordx4 v13, s[44:47], s77 offen offset:0  lds
    buffer_load_dwordx4 v14, s[44:47], s77 offen offset:1024  lds
    buffer_load_dwordx4 v15, s[44:47], s77 offen offset:2048  lds
    buffer_load_dwordx4 v16, s[44:47], s77 offen offset:3072  lds
    s_waitcnt vmcnt(8)
    s_barrier
    s_barrier
    s_branch L_join
L_var1:
    s_add_u32 s34, s34, 1
    s_cmp_eq_u32 s34, 10
    s_cselect_b32 s34, 0, s34
    s_lshl_b32 s76, s34, 7
    s_add_u32 s76, s76, s69
    s_lshl_b32 s75, s34, 19
    s_add_u32 s75, s75, s68
    s_add_u32 m0, s73, 81920
    s_nop 0
    buffer_load_dwordx4 v5, s[36:39], s76 offen offset:0  lds
    buffer_load_dwordx4 v6, s[36:39], s76 offen offset:1024  lds
    buffer_load_dwordx4 v7, s[36:39], s76 offen offset:2048  lds
    buffer_load_dwordx4 v8, s[36:39], s76 offen offset:3072  lds
    s_add_u32 m0, s73, 32768
    s_nop 0
    buffer_load_dwordx4 v1, s[48:51], s75 offen offset:0  lds
    buffer_load_dwordx4 v2, s[48:51], s75 offen offset:1024  lds
    buffer_load_dwordx4 v3, s[48:51], s75 offen offset:2048  lds
    buffer_load_dwordx4 v4, s[48:51], s75 offen offset:3072  lds
    s_xor_b32 s75, s75, 128
    s_add_u32 m0, s73, 49152
    s_nop 0
    buffer_load_dwordx4 v1, s[48:51], s75 offen offset:0  lds
    buffer_load_dwordx4 v2, s[48:51], s75 offen offset:1024  lds
    buffer_load_dwordx4 v3, s[48:51], s75 offen offset:2048  lds
    buffer_load_dwordx4 v4, s[48:51], s75 offen offset:3072  lds
    s_waitcnt vmcnt(12)
    s_barrier
    s_add_u32 s34, s34, 1
    s_cmp_eq_u32 s34, 10
    s_cselect_b32 s34, 0, s34
    s_lshl_b32 s76, s34, 7
    s_add_u32 s76, s76, s69
    s_lshl_b32 s75, s34, 19
    s_add_u32 s75, s75, s68
    s_add_u32 m0, s73, 65536
    s_nop 0
    buffer_load_dwordx4 v5, s[36:39], s76 offen offset:0  lds
    buffer_load_dwordx4 v6, s[36:39], s76 offen offset:1024  lds
    buffer_load_dwordx4 v7, s[36:39], s76 offen offset:2048  lds
    buffer_load_dwordx4 v8, s[36:39], s76 offen offset:3072  lds
    s_add_u32 m0, s73, 0
    s_nop 0
    buffer_load_dwordx4 v1, s[48:51], s75 offen offset:0  lds
    buffer_load_dwordx4 v2, s[48:51], s75 offen offset:1024  lds
    buffer_load_dwordx4 v3, s[48:51], s75 offen offset:2048  lds
    buffer_load_dwordx4 v4, s[48:51], s75 offen offset:3072  lds
    s_waitcnt vmcnt(12)
    s_barrier
    s_xor_b32 s75, s75, 128
    s_add_u32 m0, s73, 16384
    s_nop 0
    buffer_load_dwordx4 v1, s[48:51], s75 offen offset:0  lds
    buffer_load_dwordx4 v2, s[48:51], s75 offen offset:1024  lds
    buffer_load_dwordx4 v3, s[48:51], s75 offen offset:2048  lds
    buffer_load_dwordx4 v4, s[48:51], s75 offen offset:3072  lds
    s_waitcnt vmcnt(12)
    s_barrier
    s_add_u32 s34, s34, 1
    s_cmp_eq_u32 s34, 10
    s_cselect_b32 s34, 0, s34
    s_lshl_b32 s76, s34, 7
    s_add_u32 s76, s76, s69
    s_lshl_b32 s75, s34, 19
    s_add_u32 s75, s75, s68
    s_add_u32 m0, s73, 81920
    s_nop 0
    buffer_load_dwordx4 v5, s[36:39], s76 offen offset:0  lds
    buffer_load_dwordx4 v6, s[36:39], s76 offen offset:1024  lds
    buffer_load_dwordx4 v7, s[36:39], s76 offen offset:2048  lds
    buffer_load_dwordx4 v8, s[36:39], s76 offen offset:3072  lds
    s_add_u32 m0, s73, 32768
    s_nop 0
    buffer_load_dwordx4 v1, s[48:51], s75 offen offset:0  lds
    buffer_load_dwordx4 v2, s[48:51], s75 offen offset:1024  lds
    buffer_load_dwordx4 v3, s[48:51], s75 offen offset:2048  lds
    buffer_load_dwordx4 v4, s[48:51], s75 offen offset:3072  lds
    s_waitcnt vmcnt(12)
    s_barrier
    s_xor_b32 s75, s75, 128
    s_add_u32 m0, s73, 49152
    s_nop 0
    buffer_load_dwordx4 v1, s[48:51], s75 offen offset:0  lds
    buffer_load_dwordx4 v2, s[48:51], s75 offen offset:1024  lds
    buffer_load_dwordx4 v3, s[48:51], s75 offen offset:2048  lds
    buffer_load_dwordx4 v4, s[48:51], s75 offen offset:3072  lds
    s_add_u32 s77, s70, 0
    s_lshl_b32 s78, s73, 2
    s_add_u32 m0, s78, 98304
    s_nop 0
    buffer_load_dwordx4 v9, s[40:43], s77 offen offset:0 nt lds
    buffer_load_dwordx4 v10, s[40:43], s77 offen offset:1024 nt lds
    buffer_load_dwordx4 v11, s[40:43], s77 offen offset:2048 nt lds
    buffer_load_dwordx4 v12, s[40:43], s77 offen offset:3072 nt lds
    s_add_u32 s77, s70, 4096
    s_lshl_b32 s78, s73, 2
    s_add_u32 m0, s78, 102400
    s_nop 0
    buffer_load_dwordx4 v9, s[40:43], s77 offen offset:0 nt lds
    buffer_load_dwordx4 v10, s[40:43], s77 offen offset:1024 nt lds
    buffer_load_dwordx4 v11, s[40:43], s77 offen offset:2048 nt lds
    buffer_load_dwordx4 v12, s[40:43], s77 offen offset:3072 nt lds
    s_waitcnt vmcnt(20)
    s_barrier
    s_waitcnt vmcnt(12)
    s_barrier
    s_add_u32 s34, s34, 1
    s_cmp_eq_u32 s34, 10
    s_cselect_b32 s34, 0, s34
    s_lshl_b32 s76, s34, 7
    s_add_u32 s76, s76, s69
    s_lshl_b32 s75, s34, 19
    s_add_u32 s75, s75, s68
    s_add_u32 m0, s73, 65536
    s_nop 0
    buffer_load_dwordx4 v5, s[36:39], s76 offen offset:0  lds
    buffer_load_dwordx4 v6, s[36:39], s76 offen offset:1024  lds
    buffer_load_dwordx4 v7, s[36:39], s76 offen offset:2048  lds
    buffer_load_dwordx4 v8, s[36:39], s76 offen offset:3072  lds
    s_add_u32 m0, s73, 0
    s_nop 0
    buffer_load_dwordx4 v1, s[48:51], s75 offen offset:0  lds
    buffer_load_dwordx4 v2, s[48:51], s75 offen offset:1024  lds
    buffer_load_dwordx4 v3, s[48:51], s75 offen offset:2048  lds
    buffer_load_dwordx4 v4, s[48:51], s75 offen offset:3072  lds
    s_waitcnt vmcnt(16)
    s_barrier
    s_xor_b32 s75, s75, 128
    s_add_u32 m0, s73, 16384
    s_nop 0
    buffer_load_dwordx4 v1, s[48:51], s75 offen offset:0  lds
    buffer_load_dwordx4 v2, s[48:51], s75 offen offset:1024  lds
    buffer_load_dwordx4 v3, s[48:51], s75 offen offset:2048  lds
    buffer_load_dwordx4 v4, s[48:51], s75 offen offset:3072  lds
    s_add_u32 s34, s34, 1
    s_cmp_eq_u32 s34, 10
    s_cselect_b32 s34, 0, s34
    s_lshl_b32 s76, s34, 7
    s_add_u32 s76, s76, s69
    s_lshl_b32 s75, s34, 19
    s_add_u32 s75, s75, s68
    s_add_u32 m0, s73, 81920
    s_nop 0
    buffer_load_dwordx4 v5, s[36:39], s76 offen offset:0  lds
    buffer_load_dwordx4 v6, s[36:39], s76 offen offset:1024  lds
    buffer_load_dwordx4 v7, s[36:39], s76 offen offset:2048  lds
    buffer_load_dwordx4 v8, s[36:39], s76 offen offset:3072  lds
    s_waitcnt vmcnt(8)
    s_barrier
    s_add_u32 m0, s73, 32768
    s_nop 0
    buffer_load_dwordx4 v1, s[48:51], s75 offen offset:0  lds
    buffer_load_dwordx4 v2, s[48:51], s75 offen offset:1024  lds
    buffer_load_dwordx4 v3, s[48:51], s75 offen offset:2048  lds
    buffer_load_dwordx4 v4, s[48:51], s75 offen offset:3072  lds
    s_xor_b32 s75, s75, 128
    s_add_u32 m0, s73, 49152
    s_nop 0
    buffer_load_dwordx4 v1, s[48:51], s75 offen offset:0  lds
    buffer_load_dwordx4 v2, s[48:51], s75 offen offset:1024  lds
    buffer_load_dwordx4 v3, s[48:51], s75 offen offset:2048  lds
    buffer_load_dwordx4 v4, s[48:51], s75 offen offset:3072  lds
    s_waitcnt vmcnt(12)
    s_barrier
    s_add_u32 s34, s34, 1
    s_cmp_eq_u32 s34, 10
    s_cselect_b32 s34, 0, s34
    s_lshl_b32 s76, s34, 7
    s_add_u32 s76, s76, s69
    s_lshl_b32 s75, s34, 19
    s_add_u32 s75, s75, s68
    s_add_u32 m0, s73, 65536
    s_nop 0
    buffer_load_dwordx4 v5, s[36:39], s76 offen offset:0  lds
    buffer_load_dwordx4 v6, s[36:39], s76 offen offset:1024  lds
    buffer_load_dwordx4 v7, s[36:39], s76 offen offset:2048  lds
    buffer_load_dwordx4 v8, s[36:39], s76 offen offset:3072  lds
    s_add_u32 m0, s73, 0
    s_nop 0
    buffer_load_dwordx4 v1, s[48:51], s75 offen offset:0  lds
    buffer_load_dwordx4 v2, s[48:51], s75 offen offset:1024  lds
    buffer_load_dwordx4 v3, s[48:51], s75 offen offset:2048  lds
    buffer_load_dwordx4 v4, s[48:51], s75 offen offset:3072  lds
    s_waitcnt vmcnt(12)
    s_barrier
    s_xor_b32 s75, s75, 128
    s_add_u32 m0, s73, 16384
    s_nop 0
    buffer_load_dwordx4 v1, s[48:51], s75 offen offset:0  lds
    buffer_load_dwordx4 v2, s[48:51], s75 offen offset:1024  lds
    buffer_load_dwordx4 v3, s[48:51], s75 offen offset:2048  lds
    buffer_load_dwordx4 v4, s[48:51], s75 offen offset:3072  lds
    s_add_u32 s77, s70, 262144
    s_lshl_b32 s78, s73, 2
    s_add_u32 m0, s78, 106496
    s_nop 0
    buffer_load_dwordx4 v9, s[40:43], s77 offen offset:0 nt lds
    buffer_load_dwordx4 v10, s[40:43], s77 offen offset:1024 nt lds
    buffer_load_dwordx4 v11, s[40:43], s77 offen offset:2048 nt lds
    buffer_load_dwordx4 v12, s[40:43], s77 offen offset:3072 nt lds
    s_add_u32 s77, s70, 266240
    s_lshl_b32 s78, s73, 2
    s_add_u32 m0, s78, 110592
    s_nop 0
    buffer_load_dwordx4 v9, s[40:43], s77 offen offset:0 nt lds
    buffer_load_dwordx4 v10, s[40:43], s77 offen offset:1024 nt lds
    buffer_load_dwordx4 v11, s[40:43], s77 offen offset:2048 nt lds
    buffer_load_dwordx4 v12, s[40:43], s77 offen offset:3072 nt lds
    s_waitcnt vmcnt(20)
    s_barrier
    s_waitcnt vmcnt(12)
    s_barrier
    s_add_u32 s34, s34, 1
    s_cmp_eq_u32 s34, 10
    s_cselect_b32 s34, 0, s34
    s_lshl_b32 s76, s34, 7
    s_add_u32 s76, s76, s69
    s_lshl_b32 s75, s34, 19
    s_add_u32 s75, s75, s68
    s_add_u32 m0, s73, 81920
    s_nop 0
    buffer_load_dwordx4 v5, s[36:39], s76 offen offset:0  lds
    buffer_load_dwordx4 v6, s[36:39], s76 offen offset:1024  lds
    buffer_load_dwordx4 v7, s[36:39], s76 offen offset:2048  lds
    buffer_load_dwordx4 v8, s[36:39], s76 offen offset:3072  lds
    s_add_u32 m0, s73, 32768
    s_nop 0
    buffer_load_dwordx4 v1, s[48:51], s75 offen offset:0  lds
    buffer_load_dwordx4 v2, s[48:51], s75 offen offset:1024  lds
    buffer_load_dwordx4 v3, s[48:51], s75 offen offset:2048  lds
    buffer_load_dwordx4 v4, s[48:51], s75 offen offset:3072  lds
    s_mov_b32 s58, 2621440
    s_mov_b32 s59, 0x00020000
    s_lshl_b32 s10, s7, 2
    s_add_u32 s10, s10, s3
    s_mul_i32 s10, s10, 81920
    s_mul_i32 s11, s9, 1280
    s_add_u32 s10, s10, s11
    s_mul_i32 s11, s86, 320
    s_add_u32 s10, s10, s11
    s_lshl_b32 s30, s35, 6
    s_add_u32 s90, s10, s30
    s_and_b32 s30, s35, 1
    s_mul_i32 s30, s30, 40960
    s_add_u32 s10, s10, s30
    s_lshr_b32 s30, s35, 1
    s_lshl_b32 s30, s30, 5
    s_add_u32 s10, s10, s30
    s_add_u32 s91, s10, 256
    s_lshl_b32 s10, s35, 6
    s_add_u32 s10, s10, s3
    s_mul_i32 s10, s10, 20480
    s_add_u32 s72, s10, s11
    s_mul_i32 s74, s3, 5120
    s_add_u32 s10, s35, 1
    s_movk_i32 s11, 3277
    v_add_u32 v33, 0, v0
    v_mul_u32_u24 v34, s11, v33
    v_lshrrev_b32 v34, 16, v34
    v_mul_u32_u24 v35, 20, v34
    v_sub_u32 v33, v33, v35
    v_lshrrev_b32 v35, 2, v33
    v_add_u32 v36, s10, v35
    v_and_b32 v36, 3, v36
    v_cmp_gt_u32 vcc, 4, v35
    v_and_b32 v33, 3, v33
    v_bfe_u32 v37, v34, 2, 1
    v_cndmask_b32 v35, v35, v36, vcc
    v_lshlrev_b32 v37, 1, v37
    v_xor_b32 v33, v33, v37
    v_lshlrev_b32 v33, 4, v33
    v_lshl_or_b32 v33, v35, 6, v33
    v_mul_u32_u24 v34, 1280, v34
    v_add_u32 v17, v33, v34
    v_add_u32 v33, 64, v0
    v_mul_u32_u24 v34, s11, v33
    v_lshrrev_b32 v34, 16, v34
    v_mul_u32_u24 v35, 20, v34
    v_sub_u32 v33, v33, v35
    v_lshrrev_b32 v35, 2, v33
    v_add_u32 v36, s10, v35
    v_and_b32 v36, 3, v36
    v_cmp_gt_u32 vcc, 4, v35
    v_and_b32 v33, 3, v33
    v_bfe_u32 v37, v34, 2, 1
    v_cndmask_b32 v35, v35, v36, vcc
    v_lshlrev_b32 v37, 1, v37
    v_xor_b32 v33, v33, v37
    v_lshlrev_b32 v33, 4, v33
    v_lshl_or_b32 v33, v35, 6, v33
    v_mul_u32_u24 v34, 1280, v34
    v_add_u32 v18, v33, v34
    v_subrev_u32 v18, 1024, v18
    v_add_u32 v33, 128, v0
    v_mul_u32_u24 v34, s11, v33
    v_lshrrev_b32 v34, 16, v34
    v_mul_u32_u24 v35, 20, v34
    v_sub_u32 v33, v33, v35
    v_lshrrev_b32 v35, 2, v33
    v_add_u32 v36, s10, v35
    v_and_b32 v36, 3, v36
    v_cmp_gt_u32 vcc, 4, v35
    v_and_b32 v33, 3, v33
    v_bfe_u32 v37, v34, 2, 1
    v_cndmask_b32 v35, v35, v36, vcc
    v_lshlrev_b32 v37, 1, v37
    v_xor_b32 v33, v33, v37
    v_lshlrev_b32 v33, 4, v33
    v_lshl_or_b32 v33, v35, 6, v33
    v_mul_u32_u24 v34, 1280, v34
    v_add_u32 v19, v33, v34
    v_subrev_u32 v19, 2048, v19
    v_add_u32 v33, 192, v0
    v_mul_u32_u24 v34, s11, v33
    v_lshrrev_b32 v34, 16, v34
    v_mul_u32_u24 v35, 20, v34
    v_sub_u32 v33, v33, v35
    v_lshrrev_b32 v35, 2, v33
    v_add_u32 v36, s10, v35
    v_and_b32 v36, 3, v36
    v_cmp_gt_u32 vcc, 4, v35
    v_and_b32 v33, 3, v33
    v_bfe_u32 v37, v34, 2, 1
    v_cndmask_b32 v35, v35, v36, vcc
    v_lshlrev_b32 v37, 1, v37
    v_xor_b32 v33, v33, v37
    v_lshlrev_b32 v33, 4, v33
    v_lshl_or_b32 v33, v35, 6, v33
    v_mul_u32_u24 v34, 1280, v34
    v_add_u32 v20, v33, v34
    s_waitcnt vmcnt(16)
    s_barrier
    s_xor_b32 s75, s75, 128
    s_add_u32 m0, s73, 49152
    s_nop 0
    buffer_load_dwordx4 v1, s[48:51], s75 offen offset:0  lds
    buffer_load_dwordx4 v2, s[48:51], s75 offen offset:1024  lds
    buffer_load_dwordx4 v3, s[48:51], s75 offen offset:2048  lds
    buffer_load_dwordx4 v4, s[48:51], s75 offen offset:3072  lds
    s_add_u32 s34, s34, 1
    s_cmp_eq_u32 s34, 10
    s_cselect_b32 s34, 0, s34
    s_lshl_b32 s76, s34, 7
    s_add_u32 s76, s76, s69
    s_lshl_b32 s75, s34, 19
    s_add_u32 s75, s75, s68
    s_add_u32 m0, s73, 65536
    s_nop 0
    buffer_load_dwordx4 v5, s[36:39], s76 offen offset:0  lds
    buffer_load_dwordx4 v6, s[36:39], s76 offen offset:1024  lds
    buffer_load_dwordx4 v7, s[36:39], s76 offen offset:2048  lds
    buffer_load_dwordx4 v8, s[36:39], s76 offen offset:3072  lds
    v_subrev_u32 v20, 3072, v20
    v_add_u32 v33, 256, v0
    v_mul_u32_u24 v34, s11, v33
    v_lshrrev_b32 v34, 16, v34
    v_mul_u32_u24 v35, 20, v34
    v_sub_u32 v33, v33, v35
    v_lshrrev_b32 v35, 2, v33
    v_add_u32 v36, s10, v35
    v_and_b32 v36, 3, v36
    v_cmp_gt_u32 vcc, 4, v35
    v_and_b32 v33, 3, v33
    v_bfe_u32 v37, v34, 2, 1
    v_cndmask_b32 v35, v35, v36, vcc
    v_lshlrev_b32 v37, 1, v37
    v_xor_b32 v33, v33, v37
    v_lshlrev_b32 v33, 4, v33
    v_lshl_or_b32 v33, v35, 6, v33
    v_mul_u32_u24 v34, 1280, v34
    v_add_u32 v21, v33, v34
    v_and_b32 v33, 15, v0
    v_lshrrev_b32 v34, 4, v0
    v_lshrrev_b32 v35, 1, v34
    v_bfe_u32 v36, v0, 1, 2
    v_xor_b32 v36, v36, v35
    v_lshlrev_b32 v36, 4, v36
    v_and_b32 v37, 1, v34
    v_lshl_or_b32 v36, v37, 3, v36
    v_lshl_or_b32 v36, v33, 6, v36
    s_add_u32 s10, s73, 16384
    v_add_u32 v47, s10, v36
    v_lshlrev_b32 v36, 3, v34
    v_lshl_or_b32 v36, v33, 5, v36
    s_add_u32 s11, s10, 2048
    v_add_u32 v48, s11, v36
    v_add_u32 v50, s11, v28
    v_lshrrev_b32 v33, 2, v0
    v_and_b32 v34, 3, v0
    v_bfe_u32 v35, v0, 3, 2
    v_xor_b32 v35, v35, v34
    v_lshlrev_b32 v35, 4, v35
    v_lshl_or_b32 v35, v33, 6, v35
    v_add_u32 v49, s10, v35
    v_mul_u32_u24 v33, 2560, v33
    v_lshl_or_b32 v51, v34, 4, v33
    v_add_u32 v52, 40960, v51
    v_lshrrev_b32 v33, 1, v0
    v_and_b32 v34, 1, v0
    v_mul_u32_u24 v33, 2560, v33
    v_lshl_or_b32 v33, v34, 4, v33
    v_mov_b32 v34, 1073741824
    v_cmp_gt_u32 vcc, 32, v0
    v_add_u32 v46, s73, v28
    s_lshl_b32 s10, s35, 10
    s_add_u32 s10, s10, 32768
    v_add_u32 v56, s10, v46
    v_mov_b32 v40, 0
    v_cndmask_b32 v53, v34, v33, vcc
    v_and_b32 v33, 1, v0
    v_lshlrev_b32 v33, 4, v33
    v_mov_b32 v34, 0x3f80
    v_lshlrev_b32 v33, v33, v34
    v_lshrrev_b32 v34, 4, v0
    v_bfe_u32 v35, v0, 2, 2
    v_cmp_eq_u32 vcc, v34, v35
    v_mov_b32 v41, 0
    v_and_b32 v35, 3, v0
    v_cndmask_b32 v33, v40, v33, vcc
    v_cmp_gt_u32 vcc, 2, v35
    v_mov_b32 v44, 0
    v_mov_b32 v45, 0
    v_cndmask_b32 v42, v40, v33, vcc
    v_cndmask_b32 v43, v33, v40, vcc
    v_mov_b32 v112, 0
    v_mov_b32 v113, 0
    v_mov_b32 v114, 0
    v_mov_b32 v115, 0
    v_mov_b32 v116, 0
    v_mov_b32 v117, 0
    v_mov_b32 v118, 0
    v_mov_b32 v119, 0
    v_mov_b32 v120, 0
    v_mov_b32 v121, 0
    v_mov_b32 v122, 0
    v_mov_b32 v123, 0
    v_mov_b32 v124, 0
    v_mov_b32 v125, 0
    v_mov_b32 v126, 0
    v_mov_b32 v127, 0
    v_mov_b32 v128, 0
    v_mov_b32 v129, 0
    v_mov_b32 v130, 0
    v_mov_b32 v131, 0
    v_mov_b32 v74, 0
    v_mov_b32 v75, 0
    v_mov_b32 v86, 0
    v_mov_b32 v87, 0
    v_mov_b32 v98, 0
    v_mov_b32 v99, 0
    v_mov_b32 v110, 0
    v_mov_b32 v111, 0
    s_waitcnt vmcnt(8)
    s_barrier
    s_add_u32 m0, s73, 0
    s_nop 0
    buffer_load_dwordx4 v1, s[48:51], s75 offen offset:0  lds
    buffer_load_dwordx4 v2, s[48:51], s75 offen offset:1024  lds
    buffer_load_dwordx4 v3, s[48:51], s75 offen offset:2048  lds
    buffer_load_dwordx4 v4, s[48:51], s75 offen offset:3072  lds
    s_xor_b32 s75, s75, 128
    s_add_u32 m0, s73, 16384
    s_nop 0
    buffer_load_dwordx4 v1, s[48:51], s75 offen offset:0  lds
    buffer_load_dwordx4 v2, s[48:51], s75 offen offset:1024  lds
    buffer_load_dwordx4 v3, s[48:51], s75 offen offset:2048  lds
    buffer_load_dwordx4 v4, s[48:51], s75 offen offset:3072  lds
    s_waitcnt vmcnt(12)
    s_barrier
    s_add_u32 s34, s34, 1
    s_cmp_eq_u32 s34, 10
    s_cselect_b32 s34, 0, s34
    s_lshl_b32 s76, s34, 7
    s_add_u32 s76, s76, s69
    s_lshl_b32 s75, s34, 19
    s_add_u32 s75, s75, s68
    s_add_u32 m0, s73, 81920
    s_nop 0
    buffer_load_dwordx4 v5, s[36:39], s76 offen offset:0  lds
    buffer_load_dwordx4 v6, s[36:39], s76 offen offset:1024  lds
    buffer_load_dwordx4 v7, s[36:39], s76 offen offset:2048  lds
    buffer_load_dwordx4 v8, s[36:39], s76 offen offset:3072  lds
    s_add_u32 m0, s73, 32768
    s_nop 0
    buffer_load_dwordx4 v1, s[48:51], s75 offen offset:0  lds
    buffer_load_dwordx4 v2, s[48:51], s75 offen offset:1024  lds
    buffer_load_dwordx4 v3, s[48:51], s75 offen offset:2048  lds
    buffer_load_dwordx4 v4, s[48:51], s75 offen offset:3072  lds
    s_add_u32 s78, s6, 0
    s_and_b32 s78, s78, 3
    s_mul_i32 s78, s78, 327680
    s_add_u32 s78, s78, s87
    buffer_load_dword v38, v55, s[52:55], s78 offen
    s_waitcnt vmcnt(13)
    s_barrier
    s_xor_b32 s75, s75, 128
    s_add_u32 m0, s73, 49152
    s_nop 0
    buffer_load_dwordx4 v1, s[48:51], s75 offen offset:0  lds
    buffer_load_dwordx4 v2, s[48:51], s75 offen offset:1024  lds
    buffer_load_dwordx4 v3, s[48:51], s75 offen offset:2048  lds
    buffer_load_dwordx4 v4, s[48:51], s75 offen offset:3072  lds
    s_waitcnt vmcnt(13)
    s_barrier
    s_lshl_b32 s77, s6, 1
    s_add_u32 s77, s77, 0
    s_and_b32 s77, s77, 7
    s_lshl_b32 s77, s77, 13
    s_add_u32 s77, s77, s71
    s_add_u32 m0, s73, 0
    s_nop 0
    buffer_load_dwordx4 v13, s[44:47], s77 offen offset:0  lds
    buffer_load_dwordx4 v14, s[44:47], s77 offen offset:1024  lds
    buffer_load_dwordx4 v15, s[44:47], s77 offen offset:2048  lds
    buffer_load_dwordx4 v16, s[44:47], s77 offen offset:3072  lds
    s_waitcnt vmcnt(9)
    s_barrier
    s_lshl_b32 s77, s6, 1
    s_add_u32 s77, s77, 0
    s_and_b32 s77, s77, 7
    s_lshl_b32 s77, s77, 13
    s_add_u32 s77, s77, s71
    s_add_u32 s77, s77, 128
    s_add_u32 m0, s73, 16384
    s_nop 0
    buffer_load_dwordx4 v13, s[44:47], s77 offen offset:0  lds
    buffer_load_dwordx4 v14, s[44:47], s77 offen offset:1024  lds
    buffer_load_dwordx4 v15, s[44:47], s77 offen offset:2048  lds
    buffer_load_dwordx4 v16, s[44:47], s77 offen offset:3072  lds
    s_waitcnt vmcnt(8)
    s_barrier
    s_barrier
    s_branch L_join
L_var2:
    s_add_u32 s34, s34, 1
    s_cmp_eq_u32 s34, 10
    s_cselect_b32 s34, 0, s34
    s_lshl_b32 s76, s34, 7
    s_add_u32 s76, s76, s69
    s_lshl_b32 s75, s34, 19
    s_add_u32 s75, s75, s68
    s_add_u32 m0, s73, 81920
    s_nop 0
    buffer_load_dwordx4 v5, s[36:39], s76 offen offset:0  lds
    buffer_load_dwordx4 v6, s[36:39], s76 offen offset:1024  lds
    buffer_load_dwordx4 v7, s[36:39], s76 offen offset:2048  lds
    buffer_load_dwordx4 v8, s[36:39], s76 offen offset:3072  lds
    s_add_u32 m0, s73, 32768
    s_nop 0
    buffer_load_dwordx4 v1, s[48:51], s75 offen offset:0  lds
    buffer_load_dwordx4 v2, s[48:51], s75 offen offset:1024  lds
    buffer_load_dwordx4 v3, s[48:51], s75 offen offset:2048  lds
    buffer_load_dwordx4 v4, s[48:51], s75 offen offset:3072  lds
    s_xor_b32 s75, s75, 128
    s_add_u32 m0, s73, 49152
    s_nop 0
    buffer_load_dwordx4 v1, s[48:51], s75 offen offset:0  lds
    buffer_load_dwordx4 v2, s[48:51], s75 offen offset:1024  lds
    buffer_load_dwordx4 v3, s[48:51], s75 offen offset:2048  lds
    buffer_load_dwordx4 v4, s[48:51], s75 offen offset:3072  lds
    s_waitcnt vmcnt(12)
    s_barrier
    s_add_u32 s34, s34, 1
    s_cmp_eq_u32 s34, 10
    s_cselect_b32 s34, 0, s34
    s_lshl_b32 s76, s34, 7
    s_add_u32 s76, s76, s69
    s_lshl_b32 s75, s34, 19
    s_add_u32 s75, s75, s68
    s_add_u32 m0, s73, 65536
    s_nop 0
    buffer_load_dwordx4 v5, s[36:39], s76 offen offset:0  lds
    buffer_load_dwordx4 v6, s[36:39], s76 offen offset:1024  lds
    buffer_load_dwordx4 v7, s[36:39], s76 offen offset:2048  lds
    buffer_load_dwordx4 v8, s[36:39], s76 offen offset:3072  lds
    s_add_u32 m0, s73, 0
    s_nop 0
    buffer_load_dwordx4 v1, s[48:51], s75 offen offset:0  lds
    buffer_load_dwordx4 v2, s[48:51], s75 offen offset:1024  lds
    buffer_load_dwordx4 v3, s[48:51], s75 offen offset:2048  lds
    buffer_load_dwordx4 v4, s[48:51], s75 offen offset:3072  lds
    s_waitcnt vmcnt(12)
    s_barrier
    s_xor_b32 s75, s75, 128
    s_add_u32 m0, s73, 16384
    s_nop 0
    buffer_load_dwordx4 v1, s[48:51], s75 offen offset:0  lds
    buffer_load_dwordx4 v2, s[48:51], s75 offen offset:1024  lds
    buffer_load_dwordx4 v3, s[48:51], s75 offen offset:2048  lds
    buffer_load_dwordx4 v4, s[48:51], s75 offen offset:3072  lds
    s_waitcnt vmcnt(12)
    s_barrier
    s_add_u32 s34, s34, 1
    s_cmp_eq_u32 s34, 10
    s_cselect_b32 s34, 0, s34
    s_lshl_b32 s76, s34, 7
    s_add_u32 s76, s76, s69
    s_lshl_b32 s75, s34, 19
    s_add_u32 s75, s75, s68
    s_add_u32 m0, s73, 81920
    s_nop 0
    buffer_load_dwordx4 v5, s[36:39], s76 offen offset:0  lds
    buffer_load_dwordx4 v6, s[36:39], s76 offen offset:1024  lds
    buffer_load_dwordx4 v7, s[36:39], s76 offen offset:2048  lds
    buffer_load_dwordx4 v8, s[36:39], s76 offen offset:3072  lds
    s_add_u32 m0, s73, 32768
    s_nop 0
    buffer_load_dwordx4 v1, s[48:51], s75 offen offset:0  lds
    buffer_load_dwordx4 v2, s[48:51], s75 offen offset:1024  lds
    buffer_load_dwordx4 v3, s[48:51], s75 offen offset:2048  lds
    buffer_load_dwordx4 v4, s[48:51], s75 offen offset:3072  lds
    s_waitcnt vmcnt(12)
    s_barrier
    s_xor_b32 s75, s75, 128
    s_add_u32 m0, s73, 49152
    s_nop 0
    buffer_load_dwordx4 v1, s[48:51], s75 offen offset:0  lds
    buffer_load_dwordx4 v2, s[48:51], s75 offen offset:1024  lds
    buffer_load_dwordx4 v3, s[48:51], s75 offen offset:2048  lds
    buffer_load_dwordx4 v4, s[48:51], s75 offen offset:3072  lds
    s_waitcnt vmcnt(12)
    s_barrier
    s_add_u32 s34, s34, 1
    s_cmp_eq_u32 s34, 10
    s_cselect_b32 s34, 0, s34
    s_lshl_b32 s76, s34, 7
    s_add_u32 s76, s76, s69
    s_lshl_b32 s75, s34, 19
    s_add_u32 s75, s75, s68
    s_add_u32 m0, s73, 65536
    s_nop 0
    buffer_load_dwordx4 v5, s[36:39], s76 offen offset:0  lds
    buffer_load_dwordx4 v6, s[36:39], s76 offen offset:1024  lds
    buffer_load_dwordx4 v7, s[36:39], s76 offen offset:2048  lds
    buffer_load_dwordx4 v8, s[36:39], s76 offen offset:3072  lds
    s_add_u32 m0, s73, 0
    s_nop 0
    buffer_load_dwordx4 v1, s[48:51], s75 offen offset:0  lds
    buffer_load_dwordx4 v2, s[48:51], s75 offen offset:1024  lds
    buffer_load_dwordx4 v3, s[48:51], s75 offen offset:2048  lds
    buffer_load_dwordx4 v4, s[48:51], s75 offen offset:3072  lds
    s_add_u32 s77, s70, 0
    s_lshl_b32 s78, s73, 2
    s_add_u32 m0, s78, 98304
    s_nop 0
    buffer_load_dwordx4 v9, s[40:43], s77 offen offset:0 nt lds
    buffer_load_dwordx4 v10, s[40:43], s77 offen offset:1024 nt lds
    buffer_load_dwordx4 v11, s[40:43], s77 offen offset:2048 nt lds
    buffer_load_dwordx4 v12, s[40:43], s77 offen offset:3072 nt lds
    s_add_u32 s77, s70, 4096
    s_lshl_b32 s78, s73, 2
    s_add_u32 m0, s78, 102400
    s_nop 0
    buffer_load_dwordx4 v9, s[40:43], s77 offen offset:0 nt lds
    buffer_load_dwordx4 v10, s[40:43], s77 offen offset:1024 nt lds
    buffer_load_dwordx4 v11, s[40:43], s77 offen offset:2048 nt lds
    buffer_load_dwordx4 v12, s[40:43], s77 offen offset:3072 nt lds
    s_waitcnt vmcnt(20)
    s_barrier
    s_waitcnt vmcnt(16)
    s_barrier
    s_xor_b32 s75, s75, 128
    s_add_u32 m0, s73, 16384
    s_nop 0
    buffer_load_dwordx4 v1, s[48:51], s75 offen offset:0  lds
    buffer_load_dwordx4 v2, s[48:51], s75 offen offset:1024  lds
    buffer_load_dwordx4 v3, s[48:51], s75 offen offset:2048  lds
    buffer_load_dwordx4 v4, s[48:51], s75 offen offset:3072  lds
    s_add_u32 s34, s34, 1
    s_cmp_eq_u32 s34, 10
    s_cselect_b32 s34, 0, s34
    s_lshl_b32 s76, s34, 7
    s_add_u32 s76, s76, s69
    s_lshl_b32 s75, s34, 19
    s_add_u32 s75, s75, s68
    s_add_u32 m0, s73, 81920
    s_nop 0
    buffer_load_dwordx4 v5, s[36:39], s76 offen offset:0  lds
    buffer_load_dwordx4 v6, s[36:39], s76 offen offset:1024  lds
    buffer_load_dwordx4 v7, s[36:39], s76 offen offset:2048  lds
    buffer_load_dwordx4 v8, s[36:39], s76 offen offset:3072  lds
    s_waitcnt vmcnt(16)
    s_barrier
    s_add_u32 m0, s73, 32768
    s_nop 0
    buffer_load_dwordx4 v1, s[48:51], s75 offen offset:0  lds
    buffer_load_dwordx4 v2, s[48:51], s75 offen offset:1024  lds
    buffer_load_dwordx4 v3, s[48:51], s75 offen offset:2048  lds
    buffer_load_dwordx4 v4, s[48:51], s75 offen offset:3072  lds
    s_xor_b32 s75, s75, 128
    s_add_u32 m0, s73, 49152
    s_nop 0
    buffer_load_dwordx4 v1, s[48:51], s75 offen offset:0  lds
    buffer_load_dwordx4 v2, s[48:51], s75 offen offset:1024  lds
    buffer_load_dwordx4 v3, s[48:51], s75 offen offset:2048  lds
    buffer_load_dwordx4 v4, s[48:51], s75 offen offset:3072  lds
    s_waitcnt vmcnt(12)
    s_barrier
    s_add_u32 s34, s34, 1
    s_cmp_eq_u32 s34, 10
    s_cselect_b32 s34, 0, s34
    s_lshl_b32 s76, s34, 7
    s_add_u32 s76, s76, s69
    s_lshl_b32 s75, s34, 19
    s_add_u32 s75, s75, s68
    s_add_u32 m0, s73, 65536
    s_nop 0
    buffer_load_dwordx4 v5, s[36:39], s76 offen offset:0  lds
    buffer_load_dwordx4 v6, s[36:39], s76 offen offset:1024  lds
    buffer_load_dwordx4 v7, s[36:39], s76 offen offset:2048  lds
    buffer_load_dwordx4 v8, s[36:39], s76 offen offset:3072  lds
    s_add_u32 m0, s73, 0
    s_nop 0
    buffer_load_dwordx4 v1, s[48:51], s75 offen offset:0  lds
    buffer_load_dwordx4 v2, s[48:51], s75 offen offset:1024  lds
    buffer_load_dwordx4 v3, s[48:51], s75 offen offset:2048  lds
    buffer_load_dwordx4 v4, s[48:51], s75 offen offset:3072  lds
    s_waitcnt vmcnt(12)
    s_barrier
    s_xor_b32 s75, s75, 128
    s_add_u32 m0, s73, 16384
    s_nop 0
    buffer_load_dwordx4 v1, s[48:51], s75 offen offset:0  lds
    buffer_load_dwordx4 v2, s[48:51], s75 offen offset:1024  lds
    buffer_load_dwordx4 v3, s[48:51], s75 offen offset:2048  lds
    buffer_load_dwordx4 v4, s[48:51], s75 offen offset:3072  lds
    s_waitcnt vmcnt(12)
    s_barrier
    s_add_u32 s34, s34, 1
    s_cmp_eq_u32 s34, 10
    s_cselect_b32 s34, 0, s34
    s_lshl_b32 s76, s34, 7
    s_add_u32 s76, s76, s69
    s_lshl_b32 s75, s34, 19
    s_add_u32 s75, s75, s68
    s_add_u32 m0, s73, 81920
    s_nop 0
    buffer_load_dwordx4 v5, s[36:39], s76 offen offset:0  lds
    buffer_load_dwordx4 v6, s[36:39], s76 offen offset:1024  lds
    buffer_load_dwordx4 v7, s[36:39], s76 offen offset:2048  lds
    buffer_load_dwordx4 v8, s[36:39], s76 offen offset:3072  lds
    s_add_u32 m0, s73, 32768
    s_nop 0
    buffer_load_dwordx4 v1, s[48:51], s75 offen offset:0  lds
    buffer_load_dwordx4 v2, s[48:51], s75 offen offset:1024  lds
    buffer_load_dwordx4 v3, s[48:51], s75 offen offset:2048  lds
    buffer_load_dwordx4 v4, s[48:51], s75 offen offset:3072  lds
    s_add_u32 s77, s70, 262144
    s_lshl_b32 s78, s73, 2
    s_add_u32 m0, s78, 106496
    s_nop 0
    buffer_load_dwordx4 v9, s[40:43], s77 offen offset:0 nt lds
    buffer_load_dwordx4 v10, s[40:43], s77 offen offset:1024 nt lds
    buffer_load_dwordx4 v11, s[40:43], s77 offen offset:2048 nt lds
    buffer_load_dwordx4 v12, s[40:43], s77 offen offset:3072 nt lds
    s_add_u32 s77, s70, 266240
    s_lshl_b32 s78, s73, 2
    s_add_u32 m0, s78, 110592
    s_nop 0
    buffer_load_dwordx4 v9, s[40:43], s77 offen offset:0 nt lds
    buffer_load_dwordx4 v10, s[40:43], s77 offen offset:1024 nt lds
    buffer_load_dwordx4 v11, s[40:43], s77 offen offset:2048 nt lds
    buffer_load_dwordx4 v12, s[40:43], s77 offen offset:3072 nt lds
    s_waitcnt vmcnt(20)
    s_barrier
    s_mov_b32 s58, 2621440
    s_mov_b32 s59, 0x00020000
    s_lshl_b32 s10, s7, 2
    s_add_u32 s10, s10, s3
    s_mul_i32 s10, s10, 81920
    s_mul_i32 s11, s9, 1280
    s_add_u32 s10, s10, s11
    s_mul_i32 s11, s86, 320
    s_add_u32 s10, s10, s11
    s_lshl_b32 s30, s35, 6
    s_add_u32 s90, s10, s30
    s_and_b32 s30, s35, 1
    s_mul_i32 s30, s30, 40960
    s_add_u32 s10, s10, s30
    s_lshr_b32 s30, s35, 1
    s_lshl_b32 s30, s30, 5
    s_add_u32 s10, s10, s30
    s_add_u32 s91, s10, 256
    s_lshl_b32 s10, s35, 6
    s_add_u32 s10, s10, s3
    s_mul_i32 s10, s10, 20480
    s_add_u32 s72, s10, s11
    s_mul_i32 s74, s3, 5120
    s_add_u32 s10, s35, 1
    s_movk_i32 s11, 3277
    v_add_u32 v33, 0, v0
    v_mul_u32_u24 v34, s11, v33
    v_lshrrev_b32 v34, 16, v34
    v_mul_u32_u24 v35, 20, v34
    v_sub_u32 v33, v33, v35
    v_lshrrev_b32 v35, 2, v33
    v_add_u32 v36, s10, v35
    v_and_b32 v36, 3, v36
    v_cmp_gt_u32 vcc, 4, v35
    v_and_b32 v33, 3, v33
    v_bfe_u32 v37, v34, 2, 1
    v_cndmask_b32 v35, v35, v36, vcc
    v_lshlrev_b32 v37, 1, v37
    v_xor_b32 v33, v33, v37
    v_lshlrev_b32 v33, 4, v33
    v_lshl_or_b32 v33, v35, 6, v33
    v_mul_u32_u24 v34, 1280, v34
    v_add_u32 v17, v33, v34
    v_add_u32 v33, 64, v0
    v_mul_u32_u24 v34, s11, v33
    v_lshrrev_b32 v34, 16, v34
    v_mul_u32_u24 v35, 20, v34
    v_sub_u32 v33, v33, v35
    v_lshrrev_b32 v35, 2, v33
    v_add_u32 v36, s10, v35
    v_and_b32 v36, 3, v36
    v_cmp_gt_u32 vcc, 4, v35
    v_and_b32 v33, 3, v33
    v_bfe_u32 v37, v34, 2, 1
    v_cndmask_b32 v35, v35, v36, vcc
    v_lshlrev_b32 v37, 1, v37
    v_xor_b32 v33, v33, v37
    v_lshlrev_b32 v33, 4, v33
    v_lshl_or_b32 v33, v35, 6, v33
    v_mul_u32_u24 v34, 1280, v34
    v_add_u32 v18, v33, v34
    v_subrev_u32 v18, 1024, v18
    v_add_u32 v33, 128, v0
    v_mul_u32_u24 v34, s11, v33
    v_lshrrev_b32 v34, 16, v34
    v_mul_u32_u24 v35, 20, v34
    v_sub_u32 v33, v33, v35
    v_lshrrev_b32 v35, 2, v33
    v_add_u32 v36, s10, v35
    v_and_b32 v36, 3, v36
    v_cmp_gt_u32 vcc, 4, v35
    v_and_b32 v33, 3, v33
    v_bfe_u32 v37, v34, 2, 1
    v_cndmask_b32 v35, v35, v36, vcc
    v_lshlrev_b32 v37, 1, v37
    v_xor_b32 v33, v33, v37
    v_lshlrev_b32 v33, 4, v33
    v_lshl_or_b32 v33, v35, 6, v33
    v_mul_u32_u24 v34, 1280, v34
    v_add_u32 v19, v33, v34
    v_subrev_u32 v19, 2048, v19
    v_add_u32 v33, 192, v0
    v_mul_u32_u24 v34, s11, v33
    v_lshrrev_b32 v34, 16, v34
    v_mul_u32_u24 v35, 20, v34
    v_sub_u32 v33, v33, v35
    v_lshrrev_b32 v35, 2, v33
    v_add_u32 v36, s10, v35
    v_and_b32 v36, 3, v36
    v_cmp_gt_u32 vcc, 4, v35
    v_and_b32 v33, 3, v33
    v_bfe_u32 v37, v34, 2, 1
    v_cndmask_b32 v35, v35, v36, vcc
    v_lshlrev_b32 v37, 1, v37
    v_xor_b32 v33, v33, v37
    v_lshlrev_b32 v33, 4, v33
    v_lshl_or_b32 v33, v35, 6, v33
    v_mul_u32_u24 v34, 1280, v34
    v_add_u32 v20, v33, v34
    s_waitcnt vmcnt(16)
    s_barrier
    s_xor_b32 s75, s75, 128
    s_add_u32 m0, s73, 49152
    s_nop 0
    buffer_load_dwordx4 v1, s[48:51], s75 offen offset:0  lds
    buffer_load_dwordx4 v2, s[48:51], s75 offen offset:1024  lds
    buffer_load_dwordx4 v3, s[48:51], s75 offen offset:2048  lds
    buffer_load_dwordx4 v4, s[48:51], s75 offen offset:3072  lds
    s_add_u32 s34, s34, 1
    s_cmp_eq_u32 s34, 10
    s_cselect_b32 s34, 0, s34
    s_lshl_b32 s76, s34, 7
    s_add_u32 s76, s76, s69
    s_lshl_b32 s75, s34, 19
    s_add_u32 s75, s75, s68
    s_add_u32 m0, s73, 65536
    s_nop 0
    buffer_load_dwordx4 v5, s[36:39], s76 offen offset:0  lds
    buffer_load_dwordx4 v6, s[36:39], s76 offen offset:1024  lds
    buffer_load_dwordx4 v7, s[36:39], s76 offen offset:2048  lds
    buffer_load_dwordx4 v8, s[36:39], s76 offen offset:3072  lds
    v_subrev_u32 v20, 3072, v20
    v_add_u32 v33, 256, v0
    v_mul_u32_u24 v34, s11, v33
    v_lshrrev_b32 v34, 16, v34
    v_mul_u32_u24 v35, 20, v34
    v_sub_u32 v33, v33, v35
    v_lshrrev_b32 v35, 2, v33
    v_add_u32 v36, s10, v35
    v_and_b32 v36, 3, v36
    v_cmp_gt_u32 vcc, 4, v35
    v_and_b32 v33, 3, v33
    v_bfe_u32 v37, v34, 2, 1
    v_cndmask_b32 v35, v35, v36, vcc
    v_lshlrev_b32 v37, 1, v37
    v_xor_b32 v33, v33, v37
    v_lshlrev_b32 v33, 4, v33
    v_lshl_or_b32 v33, v35, 6, v33
    v_mul_u32_u24 v34, 1280, v34
    v_add_u32 v21, v33, v34
    v_and_b32 v33, 15, v0
    v_lshrrev_b32 v34, 4, v0
    v_lshrrev_b32 v35, 1, v34
    v_bfe_u32 v36, v0, 1, 2
    v_xor_b32 v36, v36, v35
    v_lshlrev_b32 v36, 4, v36
    v_and_b32 v37, 1, v34
    v_lshl_or_b32 v36, v37, 3, v36
    v_lshl_or_b32 v36, v33, 6, v36
    s_add_u32 s10, s73, 16384
    v_add_u32 v47, s10, v36
    v_lshlrev_b32 v36, 3, v34
    v_lshl_or_b32 v36, v33, 5, v36
    s_add_u32 s11, s10, 2048
    v_add_u32 v48, s11, v36
    v_add_u32 v50, s11, v28
    v_lshrrev_b32 v33, 2, v0
    v_and_b32 v34, 3, v0
    v_bfe_u32 v35, v0, 3, 2
    v_xor_b32 v35, v35, v34
    v_lshlrev_b32 v35, 4, v35
    v_lshl_or_b32 v35, v33, 6, v35
    v_add_u32 v49, s10, v35
    v_mul_u32_u24 v33, 2560, v33
    v_lshl_or_b32 v51, v34, 4, v33
    v_add_u32 v52, 40960, v51
    v_lshrrev_b32 v33, 1, v0
    v_and_b32 v34, 1, v0
    v_mul_u32_u24 v33, 2560, v33
    v_lshl_or_b32 v33, v34, 4, v33
    v_mov_b32 v34, 1073741824
    v_cmp_gt_u32 vcc, 32, v0
    v_add_u32 v46, s73, v28
    s_lshl_b32 s10, s35, 10
    s_add_u32 s10, s10, 32768
    v_add_u32 v56, s10, v46
    v_mov_b32 v40, 0
    v_cndmask_b32 v53, v34, v33, vcc
    v_and_b32 v33, 1, v0
    v_lshlrev_b32 v33, 4, v33
    v_mov_b32 v34, 0x3f80
    v_lshlrev_b32 v33, v33, v34
    v_lshrrev_b32 v34, 4, v0
    v_bfe_u32 v35, v0, 2, 2
    v_cmp_eq_u32 vcc, v34, v35
    v_mov_b32 v41, 0
    v_and_b32 v35, 3, v0
    v_cndmask_b32 v33, v40, v33, vcc
    v_cmp_gt_u32 vcc, 2, v35
    v_mov_b32 v44, 0
    v_mov_b32 v45, 0
    v_cndmask_b32 v42, v40, v33, vcc
    v_cndmask_b32 v43, v33, v40, vcc
    v_mov_b32 v112, 0
    v_mov_b32 v113, 0
    v_mov_b32 v114, 0
    v_mov_b32 v115, 0
    v_mov_b32 v116, 0
    v_mov_b32 v117, 0
    v_mov_b32 v118, 0
    v_mov_b32 v119, 0
    v_mov_b32 v120, 0
    v_mov_b32 v121, 0
    v_mov_b32 v122, 0
    v_mov_b32 v123, 0
    v_mov_b32 v124, 0
    v_mov_b32 v125, 0
    v_mov_b32 v126, 0
    v_mov_b32 v127, 0
    v_mov_b32 v128, 0
    v_mov_b32 v129, 0
    v_mov_b32 v130, 0
    v_mov_b32 v131, 0
    v_mov_b32 v74, 0
    v_mov_b32 v75, 0
    v_mov_b32 v86, 0
    v_mov_b32 v87, 0
    v_mov_b32 v98, 0
    v_mov_b32 v99, 0
    v_mov_b32 v110, 0
    v_mov_b32 v111, 0
    s_waitcnt vmcnt(16)
    s_barrier
    s_add_u32 m0, s73, 0
    s_nop 0
    buffer_load_dwordx4 v1, s[48:51], s75 offen offset:0  lds
    buffer_load_dwordx4 v2, s[48:51], s75 offen offset:1024  lds
    buffer_load_dwordx4 v3, s[48:51], s75 offen offset:2048  lds
    buffer_load_dwordx4 v4, s[48:51], s75 offen offset:3072  lds
    s_xor_b32 s75, s75, 128
    s_add_u32 m0, s73, 16384
    s_nop 0
    buffer_load_dwordx4 v1, s[48:51], s75 offen offset:0  lds
    buffer_load_dwordx4 v2, s[48:51], s75 offen offset:1024  lds
    buffer_load_dwordx4 v3, s[48:51], s75 offen offset:2048  lds
    buffer_load_dwordx4 v4, s[48:51], s75 offen offset:3072  lds
    s_waitcnt vmcnt(12)
    s_barrier
    s_add_u32 s34, s34, 1
    s_cmp_eq_u32 s34, 10
    s_cselect_b32 s34, 0, s34
    s_lshl_b32 s76, s34, 7
    s_add_u32 s76, s76, s69
    s_lshl_b32 s75, s34, 19
    s_add_u32 s75, s75, s68
    s_add_u32 m0, s73, 81920
    s_nop 0
    buffer_load_dwordx4 v5, s[36:39], s76 offen offset:0  lds
    buffer_load_dwordx4 v6, s[36:39], s76 offen offset:1024  lds
    buffer_load_dwordx4 v7, s[36:39], s76 offen offset:2048  lds
    buffer_load_dwordx4 v8, s[36:39], s76 offen offset:3072  lds
    s_add_u32 m0, s73, 32768
    s_nop 0
    buffer_load_dwordx4 v1, s[48:51], s75 offen offset:0  lds
    buffer_load_dwordx4 v2, s[48:51], s75 offen offset:1024  lds
    buffer_load_dwordx4 v3, s[48:51], s75 offen offset:2048  lds
    buffer_load_dwordx4 v4, s[48:51], s75 offen offset:3072  lds
    s_add_u32 s78, s6, 0
    s_and_b32 s78, s78, 3
    s_mul_i32 s78, s78, 327680
    s_add_u32 s78, s78, s87
    buffer_load_dword v38, v55, s[52:55], s78 offen
    s_waitcnt vmcnt(13)
    s_barrier
    s_xor_b32 s75, s75, 128
    s_add_u32 m0, s73, 49152
    s_nop 0
    buffer_load_dwordx4 v1, s[48:51], s75 offen offset:0  lds
    buffer_load_dwordx4 v2, s[48:51], s75 offen offset:1024  lds
    buffer_load_dwordx4 v3, s[48:51], s75 offen offset:2048  lds
    buffer_load_dwordx4 v4, s[48:51], s75 offen offset:3072  lds
    s_waitcnt vmcnt(13)
    s_barrier
    s_lshl_b32 s77, s6, 1
    s_add_u32 s77, s77, 0
    s_and_b32 s77, s77, 7
    s_lshl_b32 s77, s77, 13
    s_add_u32 s77, s77, s71
    s_add_u32 m0, s73, 0
    s_nop 0
    buffer_load_dwordx4 v13, s[44:47], s77 offen offset:0  lds
    buffer_load_dwordx4 v14, s[44:47], s77 offen offset:1024  lds
    buffer_load_dwordx4 v15, s[44:47], s77 offen offset:2048  lds
    buffer_load_dwordx4 v16, s[44:47], s77 offen offset:3072  lds
    s_waitcnt vmcnt(9)
    s_barrier
    s_lshl_b32 s77, s6, 1
    s_add_u32 s77, s77, 0
    s_and_b32 s77, s77, 7
    s_lshl_b32 s77, s77, 13
    s_add_u32 s77, s77, s71
    s_add_u32 s77, s77, 128
    s_add_u32 m0, s73, 16384
    s_nop 0
    buffer_load_dwordx4 v13, s[44:47], s77 offen offset:0  lds
    buffer_load_dwordx4 v14, s[44:47], s77 offen offset:1024  lds
    buffer_load_dwordx4 v15, s[44:47], s77 offen offset:2048  lds
    buffer_load_dwordx4 v16, s[44:47], s77 offen offset:3072  lds
    s_waitcnt vmcnt(8)
    s_barrier
    s_barrier
    s_branch L_join
L_var3:
    s_add_u32 s34, s34, 1
    s_cmp_eq_u32 s34, 10
    s_cselect_b32 s34, 0, s34
    s_lshl_b32 s76, s34, 7
    s_add_u32 s76, s76, s69
    s_lshl_b32 s75, s34, 19
    s_add_u32 s75, s75, s68
    s_add_u32 m0, s73, 81920
    s_nop 0
    buffer_load_dwordx4 v5, s[36:39], s76 offen offset:0  lds
    buffer_load_dwordx4 v6, s[36:39], s76 offen offset:1024  lds
    buffer_load_dwordx4 v7, s[36:39], s76 offen offset:2048  lds
    buffer_load_dwordx4 v8, s[36:39], s76 offen offset:3072  lds
    s_add_u32 m0, s73, 32768
    s_nop 0
    buffer_load_dwordx4 v1, s[48:51], s75 offen offset:0  lds
    buffer_load_dwordx4 v2, s[48:51], s75 offen offset:1024  lds
    buffer_load_dwordx4 v3, s[48:51], s75 offen offset:2048  lds
    buffer_load_dwordx4 v4, s[48:51], s75 offen offset:3072  lds
    s_xor_b32 s75, s75, 128
    s_add_u32 m0, s73, 49152
    s_nop 0
    buffer_load_dwordx4 v1, s[48:51], s75 offen offset:0  lds
    buffer_load_dwordx4 v2, s[48:51], s75 offen offset:1024  lds
    buffer_load_dwordx4 v3, s[48:51], s75 offen offset:2048  lds
    buffer_load_dwordx4 v4, s[48:51], s75 offen offset:3072  lds
    s_waitcnt vmcnt(12)
    s_barrier
    s_add_u32 s34, s34, 1
    s_cmp_eq_u32 s34, 10
    s_cselect_b32 s34, 0, s34
    s_lshl_b32 s76, s34, 7
    s_add_u32 s76, s76, s69
    s_lshl_b32 s75, s34, 19
    s_add_u32 s75, s75, s68
    s_add_u32 m0, s73, 65536
    s_nop 0
    buffer_load_dwordx4 v5, s[36:39], s76 offen offset:0  lds
    buffer_load_dwordx4 v6, s[36:39], s76 offen offset:1024  lds
    buffer_load_dwordx4 v7, s[36:39], s76 offen offset:2048  lds
    buffer_load_dwordx4 v8, s[36:39], s76 offen offset:3072  lds
    s_add_u32 m0, s73, 0
    s_nop 0
    buffer_load_dwordx4 v1, s[48:51], s75 offen offset:0  lds
    buffer_load_dwordx4 v2, s[48:51], s75 offen offset:1024  lds
    buffer_load_dwordx4 v3, s[48:51], s75 offen offset:2048  lds
    buffer_load_dwordx4 v4, s[48:51], s75 offen offset:3072  lds
    s_waitcnt vmcnt(12)
    s_barrier
    s_xor_b32 s75, s75, 128
    s_add_u32 m0, s73, 16384
    s_nop 0
    buffer_load_dwordx4 v1, s[48:51], s75 offen offset:0  lds
    buffer_load_dwordx4 v2, s[48:51], s75 offen offset:1024  lds
    buffer_load_dwordx4 v3, s[48:51], s75 offen offset:2048  lds
    buffer_load_dwordx4 v4, s[48:51], s75 offen offset:3072  lds
    s_waitcnt vmcnt(12)
    s_barrier
    s_add_u32 s34, s34, 1
    s_cmp_eq_u32 s34, 10
    s_cselect_b32 s34, 0, s34
    s_lshl_b32 s76, s34, 7
    s_add_u32 s76, s76, s69
    s_lshl_b32 s75, s34, 19
    s_add_u32 s75, s75, s68
    s_add_u32 m0, s73, 81920
    s_nop 0
    buffer_load_dwordx4 v5, s[36:39], s76 offen offset:0  lds
    buffer_load_dwordx4 v6, s[36:39], s76 offen offset:1024  lds
    buffer_load_dwordx4 v7, s[36:39], s76 offen offset:2048  lds
    buffer_load_dwordx4 v8, s[36:39], s76 offen offset:3072  lds
    s_add_u32 m0, s73, 32768
    s_nop 0
    buffer_load_dwordx4 v1, s[48:51], s75 offen offset:0  lds
    buffer_load_dwordx4 v2, s[48:51], s75 offen offset:1024  lds
    buffer_load_dwordx4 v3, s[48:51], s75 offen offset:2048  lds
    buffer_load_dwordx4 v4, s[48:51], s75 offen offset:3072  lds
    s_waitcnt vmcnt(12)
    s_barrier
    s_xor_b32 s75, s75, 128
    s_add_u32 m0, s73, 49152
    s_nop 0
    buffer_load_dwordx4 v1, s[48:51], s75 offen offset:0  lds
    buffer_load_dwordx4 v2, s[48:51], s75 offen offset:1024  lds
    buffer_load_dwordx4 v3, s[48:51], s75 offen offset:2048  lds
    buffer_load_dwordx4 v4, s[48:51], s75 offen offset:3072  lds
    s_waitcnt vmcnt(12)
    s_barrier
    s_add_u32 s34, s34, 1
    s_cmp_eq_u32 s34, 10
    s_cselect_b32 s34, 0, s34
    s_lshl_b32 s76, s34, 7
    s_add_u32 s76, s76, s69
    s_lshl_b32 s75, s34, 19
    s_add_u32 s75, s75, s68
    s_add_u32 m0, s73, 65536
    s_nop 0
    buffer_load_dwordx4 v5, s[36:39], s76 offen offset:0  lds
    buffer_load_dwordx4 v6, s[36:39], s76 offen offset:1024  lds
    buffer_load_dwordx4 v7, s[36:39], s76 offen offset:2048  lds
    buffer_load_dwordx4 v8, s[36:39], s76 offen offset:3072  lds
    s_add_u32 m0, s73, 0
    s_nop 0
    buffer_load_dwordx4 v1, s[48:51], s75 offen offset:0  lds
    buffer_load_dwordx4 v2, s[48:51], s75 offen offset:1024  lds
    buffer_load_dwordx4 v3, s[48:51], s75 offen offset:2048  lds
    buffer_load_dwordx4 v4, s[48:51], s75 offen offset:3072  lds
    s_waitcnt vmcnt(12)
    s_barrier
    s_xor_b32 s75, s75, 128
    s_add_u32 m0, s73, 16384
    s_nop 0
    buffer_load_dwordx4 v1, s[48:51], s75 offen offset:0  lds
    buffer_load_dwordx4 v2, s[48:51], s75 offen offset:1024  lds
    buffer_load_dwordx4 v3, s[48:51], s75 offen offset:2048  lds
    buffer_load_dwordx4 v4, s[48:51], s75 offen offset:3072  lds
    s_add_u32 s77, s70, 0
    s_lshl_b32 s78, s73, 2
    s_add_u32 m0, s78, 98304
    s_nop 0
    buffer_load_dwordx4 v9, s[40:43], s77 offen offset:0 nt lds
    buffer_load_dwordx4 v10, s[40:43], s77 offen offset:1024 nt lds
    buffer_load_dwordx4 v11, s[40:43], s77 offen offset:2048 nt lds
    buffer_load_dwordx4 v12, s[40:43], s77 offen offset:3072 nt lds
    s_add_u32 s77, s70, 4096
    s_lshl_b32 s78, s73, 2
    s_add_u32 m0, s78, 102400
    s_nop 0
    buffer_load_dwordx4 v9, s[40:43], s77 offen offset:0 nt lds
    buffer_load_dwordx4 v10, s[40:43], s77 offen offset:1024 nt lds
    buffer_load_dwordx4 v11, s[40:43], s77 offen offset:2048 nt lds
    buffer_load_dwordx4 v12, s[40:43], s77 offen offset:3072 nt lds
    s_waitcnt vmcnt(20)
    s_barrier
    s_waitcnt vmcnt(12)
    s_barrier
    s_add_u32 s34, s34, 1
    s_cmp_eq_u32 s34, 10
    s_cselect_b32 s34, 0, s34
    s_lshl_b32 s76, s34, 7
    s_add_u32 s76, s76, s69
    s_lshl_b32 s75, s34, 19
    s_add_u32 s75, s75, s68
    s_add_u32 m0, s73, 81920
    s_nop 0
    buffer_load_dwordx4 v5, s[36:39], s76 offen offset:0  lds
    buffer_load_dwordx4 v6, s[36:39], s76 offen offset:1024  lds
    buffer_load_dwordx4 v7, s[36:39], s76 offen offset:2048  lds
    buffer_load_dwordx4 v8, s[36:39], s76 offen offset:3072  lds
    s_add_u32 m0, s73, 32768
    s_nop 0
    buffer_load_dwordx4 v1, s[48:51], s75 offen offset:0  lds
    buffer_load_dwordx4 v2, s[48:51], s75 offen offset:1024  lds
    buffer_load_dwordx4 v3, s[48:51], s75 offen offset:2048  lds
    buffer_load_dwordx4 v4, s[48:51], s75 offen offset:3072  lds
    s_waitcnt vmcnt(16)
    s_barrier
    s_xor_b32 s75, s75, 128
    s_add_u32 m0, s73, 49152
    s_nop 0
    buffer_load_dwordx4 v1, s[48:51], s75 offen offset:0  lds
    buffer_load_dwordx4 v2, s[48:51], s75 offen offset:1024  lds
    buffer_load_dwordx4 v3, s[48:51], s75 offen offset:2048  lds
    buffer_load_dwordx4 v4, s[48:51], s75 offen offset:3072  lds
    s_add_u32 s34, s34, 1
    s_cmp_eq_u32 s34, 10
    s_cselect_b32 s34, 0, s34
    s_lshl_b32 s76, s34, 7
    s_add_u32 s76, s76, s69
    s_lshl_b32 s75, s34, 19
    s_add_u32 s75, s75, s68
    s_add_u32 m0, s73, 65536
    s_nop 0
    buffer_load_dwordx4 v5, s[36:39], s76 offen offset:0  lds
    buffer_load_dwordx4 v6, s[36:39], s76 offen offset:1024  lds
    buffer_load_dwordx4 v7, s[36:39], s76 offen offset:2048  lds
    buffer_load_dwordx4 v8, s[36:39], s76 offen offset:3072  lds
    s_waitcnt vmcnt(8)
    s_barrier
    s_add_u32 m0, s73, 0
    s_nop 0
    buffer_load_dwordx4 v1, s[48:51], s75 offen offset:0  lds
    buffer_load_dwordx4 v2, s[48:51], s75 offen offset:1024  lds
    buffer_load_dwordx4 v3, s[48:51], s75 offen offset:2048  lds
    buffer_load_dwordx4 v4, s[48:51], s75 offen offset:3072  lds
    s_xor_b32 s75, s75, 128
    s_add_u32 m0, s73, 16384
    s_nop 0
    buffer_load_dwordx4 v1, s[48:51], s75 offen offset:0  lds
    buffer_load_dwordx4 v2, s[48:51], s75 offen offset:1024  lds
    buffer_load_dwordx4 v3, s[48:51], s75 offen offset:2048  lds
    buffer_load_dwordx4 v4, s[48:51], s75 offen offset:3072  lds
    s_waitcnt vmcnt(12)
    s_barrier
    s_add_u32 s34, s34, 1
    s_cmp_eq_u32 s34, 10
    s_cselect_b32 s34, 0, s34
    s_lshl_b32 s76, s34, 7
    s_add_u32 s76, s76, s69
    s_lshl_b32 s75, s34, 19
    s_add_u32 s75, s75, s68
    s_add_u32 m0, s73, 81920
    s_nop 0
    buffer_load_dwordx4 v5, s[36:39], s76 offen offset:0  lds
    buffer_load_dwordx4 v6, s[36:39], s76 offen offset:1024  lds
    buffer_load_dwordx4 v7, s[36:39], s76 offen offset:2048  lds
    buffer_load_dwordx4 v8, s[36:39], s76 offen offset:3072  lds
    s_add_u32 m0, s73, 32768
    s_nop 0
    buffer_load_dwordx4 v1, s[48:51], s75 offen offset:0  lds
    buffer_load_dwordx4 v2, s[48:51], s75 offen offset:1024  lds
    buffer_load_dwordx4 v3, s[48:51], s75 offen offset:2048  lds
    buffer_load_dwordx4 v4, s[48:51], s75 offen offset:3072  lds
    s_waitcnt vmcnt(12)
    s_barrier
    s_xor_b32 s75, s75, 128
    s_add_u32 m0, s73, 49152
    s_nop 0
    buffer_load_dwordx4 v1, s[48:51], s75 offen offset:0  lds
    buffer_load_dwordx4 v2, s[48:51], s75 offen offset:1024  lds
    buffer_load_dwordx4 v3, s[48:51], s75 offen offset:2048  lds
    buffer_load_dwordx4 v4, s[48:51], s75 offen offset:3072  lds
    s_add_u32 s77, s70, 262144
    s_lshl_b32 s78, s73, 2
    s_add_u32 m0, s78, 106496
    s_nop 0
    buffer_load_dwordx4 v9, s[40:43], s77 offen offset:0 nt lds
    buffer_load_dwordx4 v10, s[40:43], s77 offen offset:1024 nt lds
    buffer_load_dwordx4 v11, s[40:43], s77 offen offset:2048 nt lds
    buffer_load_dwordx4 v12, s[40:43], s77 offen offset:3072 nt lds
    s_add_u32 s77, s70, 266240
    s_lshl_b32 s78, s73, 2
    s_add_u32 m0, s78, 110592
    s_nop 0
    buffer_load_dwordx4 v9, s[40:43], s77 offen offset:0 nt lds
    buffer_load_dwordx4 v10, s[40:43], s77 offen offset:1024 nt lds
    buffer_load_dwordx4 v11, s[40:43], s77 offen offset:2048 nt lds
    buffer_load_dwordx4 v12, s[40:43], s77 offen offset:3072 nt lds
    s_mov_b32 s58, 2621440
    s_mov_b32 s59, 0x00020000
    s_lshl_b32 s10, s7, 2
    s_add_u32 s10, s10, s3
    s_mul_i32 s10, s10, 81920
    s_mul_i32 s11, s9, 1280
    s_add_u32 s10, s10, s11
    s_mul_i32 s11, s86, 320
    s_add_u32 s10, s10, s11
    s_lshl_b32 s30, s35, 6
    s_add_u32 s90, s10, s30
    s_and_b32 s30, s35, 1
    s_mul_i32 s30, s30, 40960
    s_add_u32 s10, s10, s30
    s_lshr_b32 s30, s35, 1
    s_lshl_b32 s30, s30, 5
    s_add_u32 s10, s10, s30
    s_add_u32 s91, s10, 256
    s_lshl_b32 s10, s35, 6
    s_add_u32 s10, s10, s3
    s_mul_i32 s10, s10, 20480
    s_add_u32 s72, s10, s11
    s_mul_i32 s74, s3, 5120
    s_add_u32 s10, s35, 1
    s_movk_i32 s11, 3277
    v_add_u32 v33, 0, v0
    v_mul_u32_u24 v34, s11, v33
    v_lshrrev_b32 v34, 16, v34
    v_mul_u32_u24 v35, 20, v34
    v_sub_u32 v33, v33, v35
    v_lshrrev_b32 v35, 2, v33
    v_add_u32 v36, s10, v35
    v_and_b32 v36, 3, v36
    v_cmp_gt_u32 vcc, 4, v35
    v_and_b32 v33, 3, v33
    v_bfe_u32 v37, v34, 2, 1
    v_cndmask_b32 v35, v35, v36, vcc
    v_lshlrev_b32 v37, 1, v37
    v_xor_b32 v33, v33, v37
    v_lshlrev_b32 v33, 4, v33
    v_lshl_or_b32 v33, v35, 6, v33
    v_mul_u32_u24 v34, 1280, v34
    v_add_u32 v17, v33, v34
    v_add_u32 v33, 64, v0
    v_mul_u32_u24 v34, s11, v33
    v_lshrrev_b32 v34, 16, v34
    v_mul_u32_u24 v35, 20, v34
    v_sub_u32 v33, v33, v35
    v_lshrrev_b32 v35, 2, v33
    v_add_u32 v36, s10, v35
    v_and_b32 v36, 3, v36
    v_cmp_gt_u32 vcc, 4, v35
    v_and_b32 v33, 3, v33
    v_bfe_u32 v37, v34, 2, 1
    v_cndmask_b32 v35, v35, v36, vcc
    v_lshlrev_b32 v37, 1, v37
    v_xor_b32 v33, v33, v37
    v_lshlrev_b32 v33, 4, v33
    v_lshl_or_b32 v33, v35, 6, v33
    v_mul_u32_u24 v34, 1280, v34
    v_add_u32 v18, v33, v34
    v_subrev_u32 v18, 1024, v18
    v_add_u32 v33, 128, v0
    v_mul_u32_u24 v34, s11, v33
    v_lshrrev_b32 v34, 16, v34
    v_mul_u32_u24 v35, 20, v34
    v_sub_u32 v33, v33, v35
    v_lshrrev_b32 v35, 2, v33
    v_add_u32 v36, s10, v35
    v_and_b32 v36, 3, v36
    v_cmp_gt_u32 vcc, 4, v35
    v_and_b32 v33, 3, v33
    v_bfe_u32 v37, v34, 2, 1
    v_cndmask_b32 v35, v35, v36, vcc
    v_lshlrev_b32 v37, 1, v37
    v_xor_b32 v33, v33, v37
    v_lshlrev_b32 v33, 4, v33
    v_lshl_or_b32 v33, v35, 6, v33
    v_mul_u32_u24 v34, 1280, v34
    v_add_u32 v19, v33, v34
    v_subrev_u32 v19, 2048, v19
    v_add_u32 v33, 192, v0
    v_mul_u32_u24 v34, s11, v33
    v_lshrrev_b32 v34, 16, v34
    v_mul_u32_u24 v35, 20, v34
    v_sub_u32 v33, v33, v35
    v_lshrrev_b32 v35, 2, v33
    v_add_u32 v36, s10, v35
    v_and_b32 v36, 3, v36
    v_cmp_gt_u32 vcc, 4, v35
    v_and_b32 v33, 3, v33
    v_bfe_u32 v37, v34, 2, 1
    v_cndmask_b32 v35, v35, v36, vcc
    v_lshlrev_b32 v37, 1, v37
    v_xor_b32 v33, v33, v37
    v_lshlrev_b32 v33, 4, v33
    v_lshl_or_b32 v33, v35, 6, v33
    v_mul_u32_u24 v34, 1280, v34
    v_add_u32 v20, v33, v34
    s_waitcnt vmcnt(20)
    s_barrier
    v_subrev_u32 v20, 3072, v20
    v_add_u32 v33, 256, v0
    v_mul_u32_u24 v34, s11, v33
    v_lshrrev_b32 v34, 16, v34
    v_mul_u32_u24 v35, 20, v34
    v_sub_u32 v33, v33, v35
    v_lshrrev_b32 v35, 2, v33
    v_add_u32 v36, s10, v35
    v_and_b32 v36, 3, v36
    v_cmp_gt_u32 vcc, 4, v35
    v_and_b32 v33, 3, v33
    v_bfe_u32 v37, v34, 2, 1
    v_cndmask_b32 v35, v35, v36, vcc
    v_lshlrev_b32 v37, 1, v37
    v_xor_b32 v33, v33, v37
    v_lshlrev_b32 v33, 4, v33
    v_lshl_or_b32 v33, v35, 6, v33
    v_mul_u32_u24 v34, 1280, v34
    v_add_u32 v21, v33, v34
    v_and_b32 v33, 15, v0
    v_lshrrev_b32 v34, 4, v0
    v_lshrrev_b32 v35, 1, v34
    v_bfe_u32 v36, v0, 1, 2
    v_xor_b32 v36, v36, v35
    v_lshlrev_b32 v36, 4, v36
    v_and_b32 v37, 1, v34
    v_lshl_or_b32 v36, v37, 3, v36
    v_lshl_or_b32 v36, v33, 6, v36
    s_add_u32 s10, s73, 16384
    v_add_u32 v47, s10, v36
    v_lshlrev_b32 v36, 3, v34
    v_lshl_or_b32 v36, v33, 5, v36
    s_add_u32 s11, s10, 2048
    v_add_u32 v48, s11, v36
    v_add_u32 v50, s11, v28
    v_lshrrev_b32 v33, 2, v0
    v_and_b32 v34, 3, v0
    v_bfe_u32 v35, v0, 3, 2
    v_xor_b32 v35, v35, v34
    v_lshlrev_b32 v35, 4, v35
    v_lshl_or_b32 v35, v33, 6, v35
    v_add_u32 v49, s10, v35
    v_mul_u32_u24 v33, 2560, v33
    v_lshl_or_b32 v51, v34, 4, v33
    v_add_u32 v52, 40960, v51
    v_lshrrev_b32 v33, 1, v0
    v_and_b32 v34, 1, v0
    v_mul_u32_u24 v33, 2560, v33
    v_lshl_or_b32 v33, v34, 4, v33
    v_mov_b32 v34, 1073741824
    v_cmp_gt_u32 vcc, 32, v0
    v_add_u32 v46, s73, v28
    s_lshl_b32 s10, s35, 10
    s_add_u32 s10, s10, 32768
    v_add_u32 v56, s10, v46
    v_mov_b32 v40, 0
    v_cndmask_b32 v53, v34, v33, vcc
    v_and_b32 v33, 1, v0
    v_lshlrev_b32 v33, 4, v33
    v_mov_b32 v34, 0x3f80
    v_lshlrev_b32 v33, v33, v34
    v_lshrrev_b32 v34, 4, v0
    v_bfe_u32 v35, v0, 2, 2
    v_cmp_eq_u32 vcc, v34, v35
    v_mov_b32 v41, 0
    v_and_b32 v35, 3, v0
    v_cndmask_b32 v33, v40, v33, vcc
    v_cmp_gt_u32 vcc, 2, v35
    v_mov_b32 v44, 0
    v_mov_b32 v45, 0
    v_cndmask_b32 v42, v40, v33, vcc
    v_cndmask_b32 v43, v33, v40, vcc
    v_mov_b32 v112, 0
    v_mov_b32 v113, 0
    v_mov_b32 v114, 0
    v_mov_b32 v115, 0
    v_mov_b32 v116, 0
    v_mov_b32 v117, 0
    v_mov_b32 v118, 0
    v_mov_b32 v119, 0
    v_mov_b32 v120, 0
    v_mov_b32 v121, 0
    v_mov_b32 v122, 0
    v_mov_b32 v123, 0
    v_mov_b32 v124, 0
    v_mov_b32 v125, 0
    v_mov_b32 v126, 0
    v_mov_b32 v127, 0
    v_mov_b32 v128, 0
    v_mov_b32 v129, 0
    v_mov_b32 v130, 0
    v_mov_b32 v131, 0
    v_mov_b32 v74, 0
    v_mov_b32 v75, 0
    v_mov_b32 v86, 0
    v_mov_b32 v87, 0
    v_mov_b32 v98, 0
    v_mov_b32 v99, 0
    v_mov_b32 v110, 0
    v_mov_b32 v111, 0
    s_waitcnt vmcnt(12)
    s_barrier
    s_add_u32 s34, s34, 1
    s_cmp_eq_u32 s34, 10
    s_cselect_b32 s34, 0, s34
    s_lshl_b32 s76, s34, 7
    s_add_u32 s76, s76, s69
    s_lshl_b32 s75, s34, 19
    s_add_u32 s75, s75, s68
    s_add_u32 m0, s73, 65536
    s_nop 0
    buffer_load_dwordx4 v5, s[36:39], s76 offen offset:0  lds
    buffer_load_dwordx4 v6, s[36:39], s76 offen offset:1024  lds
    buffer_load_dwordx4 v7, s[36:39], s76 offen offset:2048  lds
    buffer_load_dwordx4 v8, s[36:39], s76 offen offset:3072  lds
    s_add_u32 m0, s73, 0
    s_nop 0
    buffer_load_dwordx4 v1, s[48:51], s75 offen offset:0  lds
    buffer_load_dwordx4 v2, s[48:51], s75 offen offset:1024  lds
    buffer_load_dwordx4 v3, s[48:51], s75 offen offset:2048  lds
    buffer_load_dwordx4 v4, s[48:51], s75 offen offset:3072  lds
    s_waitcnt vmcnt(16)
    s_barrier
    s_xor_b32 s75, s75, 128
    s_add_u32 m0, s73, 16384
    s_nop 0
    buffer_load_dwordx4 v1, s[48:51], s75 offen offset:0  lds
    buffer_load_dwordx4 v2, s[48:51], s75 offen offset:1024  lds
    buffer_load_dwordx4 v3, s[48:51], s75 offen offset:2048  lds
    buffer_load_dwordx4 v4, s[48:51], s75 offen offset:3072  lds
    s_add_u32 s34, s34, 1
    s_cmp_eq_u32 s34, 10
    s_cselect_b32 s34, 0, s34
    s_lshl_b32 s76, s34, 7
    s_add_u32 s76, s76, s69
    s_lshl_b32 s75, s34, 19
    s_add_u32 s75, s75, s68
    s_add_u32 m0, s73, 81920
    s_nop 0
    buffer_load_dwordx4 v5, s[36:39], s76 offen offset:0  lds
    buffer_load_dwordx4 v6, s[36:39], s76 offen offset:1024  lds
    buffer_load_dwordx4 v7, s[36:39], s76 offen offset:2048  lds
    buffer_load_dwordx4 v8, s[36:39], s76 offen offset:3072  lds
    s_add_u32 s78, s6, 0
    s_and_b32 s78, s78, 3
    s_mul_i32 s78, s78, 327680
    s_add_u32 s78, s78, s87
    buffer_load_dword v38, v55, s[52:55], s78 offen
    s_waitcnt vmcnt(9)
    s_barrier
    s_add_u32 m0, s73, 32768
    s_nop 0
    buffer_load_dwordx4 v1, s[48:51], s75 offen offset:0  lds
    buffer_load_dwordx4 v2, s[48:51], s75 offen offset:1024  lds
    buffer_load_dwordx4 v3, s[48:51], s75 offen offset:2048  lds
    buffer_load_dwordx4 v4, s[48:51], s75 offen offset:3072  lds
    s_xor_b32 s75, s75, 128
    s_add_u32 m0, s73, 49152
    s_nop 0
    buffer_load_dwordx4 v1, s[48:51], s75 offen offset:0  lds
    buffer_load_dwordx4 v2, s[48:51], s75 offen offset:1024  lds
    buffer_load_dwordx4 v3, s[48:51], s75 offen offset:2048  lds
    buffer_load_dwordx4 v4, s[48:51], s75 offen offset:3072  lds
    s_waitcnt vmcnt(13)
    s_barrier
    s_lshl_b32 s77, s6, 1
    s_add_u32 s77, s77, 0
    s_and_b32 s77, s77, 7
    s_lshl_b32 s77, s77, 13
    s_add_u32 s77, s77, s71
    s_add_u32 m0, s73, 0
    s_nop 0
    buffer_load_dwordx4 v13, s[44:47], s77 offen offset:0  lds
    buffer_load_dwordx4 v14, s[44:47], s77 offen offset:1024  lds
    buffer_load_dwordx4 v15, s[44:47], s77 offen offset:2048  lds
    buffer_load_dwordx4 v16, s[44:47], s77 offen offset:3072  lds
    s_waitcnt vmcnt(8)
    s_barrier
    s_lshl_b32 s77, s6, 1
    s_add_u32 s77, s77, 0
    s_and_b32 s77, s77, 7
    s_lshl_b32 s77, s77, 13
    s_add_u32 s77, s77, s71
    s_add_u32 s77, s77, 128
    s_add_u32 m0, s73, 16384
    s_nop 0
    buffer_load_dwordx4 v13, s[44:47], s77 offen offset:0  lds
    buffer_load_dwordx4 v14, s[44:47], s77 offen offset:1024  lds
    buffer_load_dwordx4 v15, s[44:47], s77 offen offset:2048  lds
    buffer_load_dwordx4 v16, s[44:47], s77 offen offset:3072  lds
    s_waitcnt vmcnt(8)
    s_barrier
    s_barrier
    s_branch L_join
L_join:
    s_barrier
    s_lshl_b32 s77, s6, 1
    s_add_u32 s77, s77, 0
    s_and_b32 s77, s77, 7
    s_mul_i32 s77, s77, 163840
    s_add_u32 s77, s77, s72
    s_add_u32 m0, s74, 65536
    s_nop 0
    buffer_load_dwordx4 v17, s[52:55], s77 offen offset:0  lds
    buffer_load_dwordx4 v18, s[52:55], s77 offen offset:1024  lds
    buffer_load_dwordx4 v19, s[52:55], s77 offen offset:2048  lds
    buffer_load_dwordx4 v20, s[52:55], s77 offen offset:3072  lds
    s_add_u32 m0, s74, 69632
    s_nop 0
    buffer_load_dwordx4 v21, s[52:55], s77 offen offset:0  lds
    s_lshl_b32 s77, s6, 1
    s_add_u32 s77, s77, 1
    s_and_b32 s77, s77, 7
    s_lshl_b32 s77, s77, 13
    s_add_u32 s77, s77, s71
    s_add_u32 m0, s73, 32768
    s_nop 0
    buffer_load_dwordx4 v13, s[44:47], s77 offen offset:0  lds
    buffer_load_dwordx4 v14, s[44:47], s77 offen offset:1024  lds
    buffer_load_dwordx4 v15, s[44:47], s77 offen offset:2048  lds
    buffer_load_dwordx4 v16, s[44:47], s77 offen offset:3072  lds
    s_lshl_b32 s77, s6, 1
    s_add_u32 s77, s77, 0
    s_and_b32 s77, s77, 7
    s_mul_i32 s77, s77, 163840
    s_add_u32 s77, s77, s72
    s_add_u32 s77, s77, 81920
    s_add_u32 m0, s74, 86016
    s_nop 0
    buffer_load_dwordx4 v17, s[52:55], s77 offen offset:0  lds
    buffer_load_dwordx4 v18, s[52:55], s77 offen offset:1024  lds
    buffer_load_dwordx4 v19, s[52:55], s77 offen offset:2048  lds
    buffer_load_dwordx4 v20, s[52:55], s77 offen offset:3072  lds
    s_add_u32 m0, s74, 90112
    s_nop 0
    buffer_load_dwordx4 v21, s[52:55], s77 offen offset:0  lds
    s_waitcnt vmcnt(18)
    s_waitcnt vmcnt(9)
    s_barrier
    s_lshl_b32 s77, s6, 1
    s_add_u32 s77, s77, 1
    s_and_b32 s77, s77, 7
    s_mul_i32 s77, s77, 163840
    s_add_u32 s77, s77, s72
    s_add_u32 m0, s74, 106496
    s_nop 0
    buffer_load_dwordx4 v17, s[52:55], s77 offen offset:0  lds
    buffer_load_dwordx4 v18, s[52:55], s77 offen offset:1024  lds
    buffer_load_dwordx4 v19, s[52:55], s77 offen offset:2048  lds
    buffer_load_dwordx4 v20, s[52:55], s77 offen offset:3072  lds
    s_add_u32 m0, s74, 110592
    s_nop 0
    buffer_load_dwordx4 v21, s[52:55], s77 offen offset:0  lds
    s_lshl_b32 s77, s6, 1
    s_add_u32 s77, s77, 1
    s_and_b32 s77, s77, 7
    s_lshl_b32 s77, s77, 13
    s_add_u32 s77, s77, s71
    s_add_u32 s77, s77, 128
    s_add_u32 m0, s73, 49152
    s_nop 0
    buffer_load_dwordx4 v13, s[44:47], s77 offen offset:0  lds
    buffer_load_dwordx4 v14, s[44:47], s77 offen offset:1024  lds
    buffer_load_dwordx4 v15, s[44:47], s77 offen offset:2048  lds
    buffer_load_dwordx4 v16, s[44:47], s77 offen offset:3072  lds
    s_waitcnt vmcnt(9)
    s_barrier
    s_lshl_b32 s77, s6, 1
    s_add_u32 s77, s77, 1
    s_and_b32 s77, s77, 7
    s_mul_i32 s77, s77, 163840
    s_add_u32 s77, s77, s72
    s_add_u32 s77, s77, 81920
    s_add_u32 m0, s74, 126976
    s_nop 0
    buffer_load_dwordx4 v17, s[52:55], s77 offen offset:0  lds
    buffer_load_dwordx4 v18, s[52:55], s77 offen offset:1024  lds
    buffer_load_dwordx4 v19, s[52:55], s77 offen offset:2048  lds
    buffer_load_dwordx4 v20, s[52:55], s77 offen offset:3072  lds
    s_add_u32 m0, s74, 131072
    s_nop 0
    buffer_load_dwordx4 v21, s[52:55], s77 offen offset:0  lds
    s_lshl_b32 s77, s6, 1
    s_add_u32 s77, s77, 4
    s_and_b32 s77, s77, 7
    s_lshl_b32 s77, s77, 13
    s_add_u32 s77, s77, s71
    s_add_u32 m0, s73, 0
    s_nop 0
    buffer_load_dwordx4 v13, s[44:47], s77 offen offset:0  lds
    buffer_load_dwordx4 v14, s[44:47], s77 offen offset:1024  lds
    buffer_load_dwordx4 v15, s[44:47], s77 offen offset:2048  lds
    buffer_load_dwordx4 v16, s[44:47], s77 offen offset:3072  lds
    s_waitcnt vmcnt(13)
    s_barrier
    s_lshl_b32 s77, s6, 1
    s_add_u32 s77, s77, 4
    s_and_b32 s77, s77, 7
    s_mul_i32 s77, s77, 163840
    s_add_u32 s77, s77, s72
    s_add_u32 m0, s74, 65536
    s_nop 0
    buffer_load_dwordx4 v17, s[52:55], s77 offen offset:0  lds
    buffer_load_dwordx4 v18, s[52:55], s77 offen offset:1024  lds
    buffer_load_dwordx4 v19, s[52:55], s77 offen offset:2048  lds
    buffer_load_dwordx4 v20, s[52:55], s77 offen offset:3072  lds
    s_add_u32 m0, s74, 69632
    s_nop 0
    buffer_load_dwordx4 v21, s[52:55], s77 offen offset:0  lds
    s_lshl_b32 s77, s6, 1
    s_add_u32 s77, s77, 4
    s_and_b32 s77, s77, 7
    s_lshl_b32 s77, s77, 13
    s_add_u32 s77, s77, s71
    s_add_u32 s77, s77, 128
    s_add_u32 m0, s73, 16384
    s_nop 0
    buffer_load_dwordx4 v13, s[44:47], s77 offen offset:0  lds
    buffer_load_dwordx4 v14, s[44:47], s77 offen offset:1024  lds
    buffer_load_dwordx4 v15, s[44:47], s77 offen offset:2048  lds
    buffer_load_dwordx4 v16, s[44:47], s77 offen offset:3072  lds
    s_waitcnt vmcnt(18)
    s_waitcnt vmcnt(13)
    s_barrier
    s_lshl_b32 s77, s6, 1
    s_add_u32 s77, s77, 4
    s_and_b32 s77, s77, 7
    s_mul_i32 s77, s77, 163840
    s_add_u32 s77, s77, s72
    s_add_u32 s77, s77, 81920
    s_add_u32 m0, s74, 86016
    s_nop 0
    buffer_load_dwordx4 v17, s[52:55], s77 offen offset:0  lds
    buffer_load_dwordx4 v18, s[52:55], s77 offen offset:1024  lds
    buffer_load_dwordx4 v19, s[52:55], s77 offen offset:2048  lds
    buffer_load_dwordx4 v20, s[52:55], s77 offen offset:3072  lds
    s_add_u32 m0, s74, 90112
    s_nop 0
    buffer_load_dwordx4 v21, s[52:55], s77 offen offset:0  lds
    s_lshl_b32 s77, s6, 1
    s_add_u32 s77, s77, 5
    s_and_b32 s77, s77, 7
    s_lshl_b32 s77, s77, 13
    s_add_u32 s77, s77, s71
    s_add_u32 m0, s73, 32768
    s_nop 0
    buffer_load_dwordx4 v13, s[44:47], s77 offen offset:0  lds
    buffer_load_dwordx4 v14, s[44:47], s77 offen offset:1024  lds
    buffer_load_dwordx4 v15, s[44:47], s77 offen offset:2048  lds
    buffer_load_dwordx4 v16, s[44:47], s77 offen offset:3072  lds
    s_waitcnt vmcnt(18)
    s_waitcnt vmcnt(13)
    s_barrier
    s_lshl_b32 s77, s6, 1
    s_add_u32 s77, s77, 5
    s_and_b32 s77, s77, 7
    s_mul_i32 s77, s77, 163840
    s_add_u32 s77, s77, s72
    s_add_u32 m0, s74, 106496
    s_nop 0
    buffer_load_dwordx4 v17, s[52:55], s77 offen offset:0  lds
    buffer_load_dwordx4 v18, s[52:55], s77 offen offset:1024  lds
    buffer_load_dwordx4 v19, s[52:55], s77 offen offset:2048  lds
    buffer_load_dwordx4 v20, s[52:55], s77 offen offset:3072  lds
    s_add_u32 m0, s74, 110592
    s_nop 0
    buffer_load_dwordx4 v21, s[52:55], s77 offen offset:0  lds
    s_lshl_b32 s77, s6, 1
    s_add_u32 s77, s77, 5
    s_and_b32 s77, s77, 7
    s_lshl_b32 s77, s77, 13
    s_add_u32 s77, s77, s71
    s_add_u32 s77, s77, 128
    s_add_u32 m0, s73, 49152
    s_nop 0
    buffer_load_dwordx4 v13, s[44:47], s77 offen offset:0  lds
    buffer_load_dwordx4 v14, s[44:47], s77 offen offset:1024  lds
    buffer_load_dwordx4 v15, s[44:47], s77 offen offset:2048  lds
    buffer_load_dwordx4 v16, s[44:47], s77 offen offset:3072  lds
    s_add_u32 s78, s6, 1
    s_and_b32 s78, s78, 3
    s_mul_i32 s78, s78, 327680
    s_add_u32 s78, s78, s87
    buffer_load_dword v38, v55, s[52:55], s78 offen
    s_waitcnt vmcnt(19)
    s_waitcnt vmcnt(14)
    s_barrier
    s_waitcnt vmcnt(10)
    s_waitcnt vmcnt(5)
    s_barrier
    s_lshl_b32 s77, s6, 1
    s_add_u32 s77, s77, 5
    s_and_b32 s77, s77, 7
    s_mul_i32 s77, s77, 163840
    s_add_u32 s77, s77, s72
    s_add_u32 s77, s77, 81920
    s_add_u32 m0, s74, 126976
    s_nop 0
    buffer_load_dwordx4 v17, s[52:55], s77 offen offset:0  lds
    buffer_load_dwordx4 v18, s[52:55], s77 offen offset:1024  lds
    buffer_load_dwordx4 v19, s[52:55], s77 offen offset:2048  lds
    buffer_load_dwordx4 v20, s[52:55], s77 offen offset:3072  lds
    s_add_u32 m0, s74, 131072
    s_nop 0
    buffer_load_dwordx4 v21, s[52:55], s77 offen offset:0  lds
    s_lshl_b32 s77, s6, 1
    s_add_u32 s77, s77, 2
    s_and_b32 s77, s77, 7
    s_lshl_b32 s77, s77, 13
    s_add_u32 s77, s77, s71
    s_add_u32 m0, s73, 0
    s_nop 0
    buffer_load_dwordx4 v13, s[44:47], s77 offen offset:0  lds
    buffer_load_dwordx4 v14, s[44:47], s77 offen offset:1024  lds
    buffer_load_dwordx4 v15, s[44:47], s77 offen offset:2048  lds
    buffer_load_dwordx4 v16, s[44:47], s77 offen offset:3072  lds
    s_lshl_b32 s77, s6, 1
    s_add_u32 s77, s77, 2
    s_and_b32 s77, s77, 7
    s_mul_i32 s77, s77, 163840
    s_add_u32 s77, s77, s72
    s_add_u32 m0, s74, 65536
    s_nop 0
    buffer_load_dwordx4 v17, s[52:55], s77 offen offset:0  lds
    buffer_load_dwordx4 v18, s[52:55], s77 offen offset:1024  lds
    s_waitcnt vmcnt(12)
    s_waitcnt vmcnt(6)
    s_barrier
    buffer_load_dwordx4 v19, s[52:55], s77 offen offset:2048  lds
    buffer_load_dwordx4 v20, s[52:55], s77 offen offset:3072  lds
    s_add_u32 m0, s74, 69632
    s_nop 0
    buffer_load_dwordx4 v21, s[52:55], s77 offen offset:0  lds
    s_lshl_b32 s77, s6, 1
    s_add_u32 s77, s77, 2
    s_and_b32 s77, s77, 7
    s_lshl_b32 s77, s77, 13
    s_add_u32 s77, s77, s71
    s_add_u32 s77, s77, 128
    s_add_u32 m0, s73, 16384
    s_nop 0
    buffer_load_dwordx4 v13, s[44:47], s77 offen offset:0  lds
    buffer_load_dwordx4 v14, s[44:47], s77 offen offset:1024  lds
    buffer_load_dwordx4 v15, s[44:47], s77 offen offset:2048  lds
    buffer_load_dwordx4 v16, s[44:47], s77 offen offset:3072  lds
    s_lshl_b32 s77, s6, 1
    s_add_u32 s77, s77, 2
    s_and_b32 s77, s77, 7
    s_mul_i32 s77, s77, 163840
    s_add_u32 s77, s77, s72
    s_add_u32 s77, s77, 81920
    s_add_u32 m0, s74, 86016
    s_nop 0
    buffer_load_dwordx4 v17, s[52:55], s77 offen offset:0  lds
    buffer_load_dwordx4 v18, s[52:55], s77 offen offset:1024  lds
    buffer_load_dwordx4 v19, s[52:55], s77 offen offset:2048  lds
    buffer_load_dwordx4 v20, s[52:55], s77 offen offset:3072  lds
    s_waitcnt vmcnt(13)
    s_waitcnt vmcnt(8)
    s_barrier
    s_add_u32 m0, s74, 90112
    s_nop 0
    buffer_load_dwordx4 v21, s[52:55], s77 offen offset:0  lds
    s_lshl_b32 s77, s6, 1
    s_add_u32 s77, s77, 3
    s_and_b32 s77, s77, 7
    s_lshl_b32 s77, s77, 13
    s_add_u32 s77, s77, s71
    s_add_u32 m0, s73, 32768
    s_nop 0
    buffer_load_dwordx4 v13, s[44:47], s77 offen offset:0  lds
    buffer_load_dwordx4 v14, s[44:47], s77 offen offset:1024  lds
    buffer_load_dwordx4 v15, s[44:47], s77 offen offset:2048  lds
    buffer_load_dwordx4 v16, s[44:47], s77 offen offset:3072  lds
    s_lshl_b32 s77, s6, 1
    s_add_u32 s77, s77, 3
    s_and_b32 s77, s77, 7
    s_mul_i32 s77, s77, 163840
    s_add_u32 s77, s77, s72
    s_add_u32 m0, s74, 106496
    s_nop 0
    buffer_load_dwordx4 v17, s[52:55], s77 offen offset:0  lds
    buffer_load_dwordx4 v18, s[52:55], s77 offen offset:1024  lds
    buffer_load_dwordx4 v19, s[52:55], s77 offen offset:2048  lds
    buffer_load_dwordx4 v20, s[52:55], s77 offen offset:3072  lds
    s_add_u32 m0, s74, 110592
    s_nop 0
    buffer_load_dwordx4 v21, s[52:55], s77 offen offset:0  lds
    s_lshl_b32 s77, s6, 1
    s_add_u32 s77, s77, 3
    s_and_b32 s77, s77, 7
    s_lshl_b32 s77, s77, 13
    s_add_u32 s77, s77, s71
    s_add_u32 s77, s77, 128
    s_add_u32 m0, s73, 49152
    s_nop 0
    buffer_load_dwordx4 v13, s[44:47], s77 offen offset:0  lds
    s_waitcnt vmcnt(15)
    s_waitcnt vmcnt(10)
    s_barrier
    buffer_load_dwordx4 v14, s[44:47], s77 offen offset:1024  lds
    buffer_load_dwordx4 v15, s[44:47], s77 offen offset:2048  lds
    buffer_load_dwordx4 v16, s[44:47], s77 offen offset:3072  lds
    s_lshl_b32 s77, s6, 1
    s_add_u32 s77, s77, 3
    s_and_b32 s77, s77, 7
    s_mul_i32 s77, s77, 163840
    s_add_u32 s77, s77, s72
    s_add_u32 s77, s77, 81920
    s_add_u32 m0, s74, 126976
    s_nop 0
    buffer_load_dwordx4 v17, s[52:55], s77 offen offset:0  lds
    buffer_load_dwordx4 v18, s[52:55], s77 offen offset:1024  lds
    buffer_load_dwordx4 v19, s[52:55], s77 offen offset:2048  lds
    buffer_load_dwordx4 v20, s[52:55], s77 offen offset:3072  lds
    s_add_u32 m0, s74, 131072
    s_nop 0
    buffer_load_dwordx4 v21, s[52:55], s77 offen offset:0  lds
    s_lshl_b32 s77, s6, 1
    s_add_u32 s77, s77, 6
    s_and_b32 s77, s77, 7
    s_lshl_b32 s77, s77, 13
    s_add_u32 s77, s77, s71
    s_add_u32 m0, s73, 0
    s_nop 0
    buffer_load_dwordx4 v13, s[44:47], s77 offen offset:0  lds
    buffer_load_dwordx4 v14, s[44:47], s77 offen offset:1024  lds
    buffer_load_dwordx4 v15, s[44:47], s77 offen offset:2048  lds
    s_waitcnt vmcnt(17)
    s_waitcnt vmcnt(12)
    s_barrier
    buffer_load_dwordx4 v16, s[44:47], s77 offen offset:3072  lds
    s_lshl_b32 s77, s6, 1
    s_add_u32 s77, s77, 6
    s_and_b32 s77, s77, 7
    s_mul_i32 s77, s77, 163840
    s_add_u32 s77, s77, s72
    s_add_u32 m0, s74, 65536
    s_nop 0
    buffer_load_dwordx4 v17, s[52:55], s77 offen offset:0  lds
    buffer_load_dwordx4 v18, s[52:55], s77 offen offset:1024  lds
    buffer_load_dwordx4 v19, s[52:55], s77 offen offset:2048  lds
    buffer_load_dwordx4 v20, s[52:55], s77 offen offset:3072  lds
    s_add_u32 m0, s74, 69632
    s_nop 0
    buffer_load_dwordx4 v21, s[52:55], s77 offen offset:0  lds
    s_lshl_b32 s77, s6, 1
    s_add_u32 s77, s77, 6
    s_and_b32 s77, s77, 7
    s_lshl_b32 s77, s77, 13
    s_add_u32 s77, s77, s71
    s_add_u32 s77, s77, 128
    s_add_u32 m0, s73, 16384
    s_nop 0
    buffer_load_dwordx4 v13, s[44:47], s77 offen offset:0  lds
    buffer_load_dwordx4 v14, s[44:47], s77 offen offset:1024  lds
    buffer_load_dwordx4 v15, s[44:47], s77 offen offset:2048  lds
    buffer_load_dwordx4 v16, s[44:47], s77 offen offset:3072  lds
    s_waitcnt vmcnt(18)
    s_waitcnt vmcnt(13)
    s_barrier
    s_lshl_b32 s77, s6, 1
    s_add_u32 s77, s77, 6
    s_and_b32 s77, s77, 7
    s_mul_i32 s77, s77, 163840
    s_add_u32 s77, s77, s72
    s_add_u32 s77, s77, 81920
    s_add_u32 m0, s74, 86016
    s_nop 0
    buffer_load_dwordx4 v17, s[52:55], s77 offen offset:0  lds
    buffer_load_dwordx4 v18, s[52:55], s77 offen offset:1024  lds
    buffer_load_dwordx4 v19, s[52:55], s77 offen offset:2048  lds
    buffer_load_dwordx4 v20, s[52:55], s77 offen offset:3072  lds
    s_add_u32 m0, s74, 90112
    s_nop 0
    buffer_load_dwordx4 v21, s[52:55], s77 offen offset:0  lds
    s_lshl_b32 s77, s6, 1
    s_add_u32 s77, s77, 7
    s_and_b32 s77, s77, 7
    s_lshl_b32 s77, s77, 13
    s_add_u32 s77, s77, s71
    s_add_u32 m0, s73, 32768
    s_nop 0
    buffer_load_dwordx4 v13, s[44:47], s77 offen offset:0  lds
    buffer_load_dwordx4 v14, s[44:47], s77 offen offset:1024  lds
    buffer_load_dwordx4 v15, s[44:47], s77 offen offset:2048  lds
    buffer_load_dwordx4 v16, s[44:47], s77 offen offset:3072  lds
    s_waitcnt vmcnt(18)
    s_waitcnt vmcnt(13)
    s_waitcnt vmcnt(9)
    s_barrier
    s_lshl_b32 s77, s6, 1
    s_add_u32 s77, s77, 7
    s_and_b32 s77, s77, 7
    s_mul_i32 s77, s77, 163840
    s_add_u32 s77, s77, s72
    s_add_u32 m0, s74, 106496
    s_nop 0
    buffer_load_dwordx4 v17, s[52:55], s77 offen offset:0  lds
    buffer_load_dwordx4 v18, s[52:55], s77 offen offset:1024  lds
    buffer_load_dwordx4 v19, s[52:55], s77 offen offset:2048  lds
    buffer_load_dwordx4 v20, s[52:55], s77 offen offset:3072  lds
    s_add_u32 m0, s74, 110592
    s_nop 0
    buffer_load_dwordx4 v21, s[52:55], s77 offen offset:0  lds
    s_lshl_b32 s77, s6, 1
    s_add_u32 s77, s77, 7
    s_and_b32 s77, s77, 7
    s_lshl_b32 s77, s77, 13
    s_add_u32 s77, s77, s71
    s_add_u32 s77, s77, 128
    s_add_u32 m0, s73, 49152
    s_nop 0
    buffer_load_dwordx4 v13, s[44:47], s77 offen offset:0  lds
    buffer_load_dwordx4 v14, s[44:47], s77 offen offset:1024  lds
    buffer_load_dwordx4 v15, s[44:47], s77 offen offset:2048  lds
    buffer_load_dwordx4 v16, s[44:47], s77 offen offset:3072  lds
    s_waitcnt vmcnt(9)
    s_barrier
    s_lshl_b32 s77, s6, 1
    s_add_u32 s77, s77, 7
    s_and_b32 s77, s77, 7
    s_mul_i32 s77, s77, 163840
    s_add_u32 s77, s77, s72
    s_add_u32 s77, s77, 81920
    s_add_u32 m0, s74, 126976
    s_nop 0
    buffer_load_dwordx4 v17, s[52:55], s77 offen offset:0  lds
    buffer_load_dwordx4 v18, s[52:55], s77 offen offset:1024  lds
    buffer_load_dwordx4 v19, s[52:55], s77 offen offset:2048  lds
    buffer_load_dwordx4 v20, s[52:55], s77 offen offset:3072  lds
    s_add_u32 m0, s74, 131072
    s_nop 0
    buffer_load_dwordx4 v21, s[52:55], s77 offen offset:0  lds
    s_waitcnt vmcnt(5)
    s_barrier
    s_waitcnt vmcnt(0)
    s_barrier
    s_barrier
    buffer_load_dword v32, v22, s[64:67], s98 offen sc1
    s_waitcnt vmcnt(0)
    v_cmp_ne_u32 vcc, 0, v32
    s_nop 0
    s_and_b32 s77, vcc_lo, 1
    s_cmp_lg_u32 s77, 1
    s_cbranch_scc1 L_spin0
L_back0:
    s_add_u32 s77, s35, 7
    s_and_b32 s77, s77, 3
    s_lshl_b32 s77, s77, 14
    s_add_u32 s77, s77, s80
    buffer_load_dwordx4 v[64:67], v28, s[64:67], s77 offen offset:0 sc1
    buffer_load_dwordx4 v[68:71], v28, s[64:67], s77 offen offset:1024 sc1
    buffer_load_dwordx2 v[72:73], v29, s[64:67], s77 offen offset:2048 sc1
    v_cmp_ne_u32 vcc, 0, v32
    s_nop 0
    s_and_b32 s77, vcc_lo, 2
    s_cmp_lg_u32 s77, 2
    s_cbranch_scc1 L_spin1
L_back1:
    s_add_u32 s77, s35, 6
    s_and_b32 s77, s77, 3
    s_lshl_b32 s77, s77, 14
    s_add_u32 s77, s77, s80
    buffer_load_dwordx4 v[76:79], v28, s[64:67], s77 offen offset:0 sc1
    buffer_load_dwordx4 v[80:83], v28, s[64:67], s77 offen offset:1024 sc1
    buffer_load_dwordx2 v[84:85], v29, s[64:67], s77 offen offset:2048 sc1
    v_cmp_ne_u32 vcc, 0, v32
    s_nop 0
    s_and_b32 s77, vcc_lo, 4
    s_cmp_lg_u32 s77, 4
    s_cbranch_scc1 L_spin2
L_back2:
    s_add_u32 s77, s35, 5
    s_and_b32 s77, s77, 3
    s_lshl_b32 s77, s77, 14
    s_add_u32 s77, s77, s80
    buffer_load_dwordx4 v[88:91], v28, s[64:67], s77 offen offset:0 sc1
    buffer_load_dwordx4 v[92:95], v28, s[64:67], s77 offen offset:1024 sc1
    buffer_load_dwordx2 v[96:97], v29, s[64:67], s77 offen offset:2048 sc1
    s_barrier
    ds_read_b128 v[132:135], v46 offset:0
    ds_read_b128 v[136:139], v46 offset:1024
    ds_read_b128 v[140:143], v46 offset:2048
    ds_read_b128 v[144:147], v46 offset:3072
    ds_read_b128 v[148:151], v56
    s_waitcnt vmcnt(8)
    v_mfma_f32_16x16x32_bf16 v[112:115], v[42:45], v[64:67], v[112:115]
    v_mfma_f32_16x16x32_bf16 v[116:119], v[40:43], v[64:67], v[116:119]
    s_waitcnt vmcnt(7)
    v_mfma_f32_16x16x32_bf16 v[120:123], v[42:45], v[68:71], v[120:123]
    v_mfma_f32_16x16x32_bf16 v[124:127], v[40:43], v[68:71], v[124:127]
    s_waitcnt vmcnt(6)
    v_mfma_f32_16x16x32_bf16 v[128:131], v[42:45], v[72:75], v[128:131]
    s_waitcnt vmcnt(5)
    v_mfma_f32_16x16x32_bf16 v[112:115], v[42:45], v[76:79], v[112:115]
    v_mfma_f32_16x16x32_bf16 v[116:119], v[40:43], v[76:79], v[116:119]
    s_waitcnt vmcnt(4)
    v_mfma_f32_16x16x32_bf16 v[120:123], v[42:45], v[80:83], v[120:123]
    v_mfma_f32_16x16x32_bf16 v[124:127], v[40:43], v[80:83], v[124:127]
    s_waitcnt vmcnt(3)
    v_mfma_f32_16x16x32_bf16 v[128:131], v[42:45], v[84:87], v[128:131]
    s_nop 7
    s_waitcnt lgkmcnt(4)
    v_add_f32 v112, v112, v132
    v_add_f32 v113, v113, v133
    v_add_f32 v114, v114, v134
    v_add_f32 v115, v115, v135
    s_waitcnt lgkmcnt(3)
    v_add_f32 v116, v116, v136
    v_add_f32 v117, v117, v137
    v_add_f32 v118, v118, v138
    v_add_f32 v119, v119, v139
    s_waitcnt lgkmcnt(2)
    v_add_f32 v120, v120, v140
    v_add_f32 v121, v121, v141
    v_add_f32 v122, v122, v142
    v_add_f32 v123, v123, v143
    s_waitcnt lgkmcnt(1)
    v_add_f32 v124, v124, v144
    v_add_f32 v125, v125, v145
    v_add_f32 v126, v126, v146
    v_add_f32 v127, v127, v147
    s_waitcnt lgkmcnt(0)
    v_add_f32 v128, v128, v148
    v_add_f32 v129, v129, v149
    v_add_f32 v130, v130, v150
    v_add_f32 v131, v131, v151
    v_xor_b32 v33, 32, v47
    s_waitcnt vmcnt(2)
    v_mfma_f32_16x16x32_bf16 v[112:115], v[42:45], v[88:91], v[112:115]
    v_mfma_f32_16x16x32_bf16 v[116:119], v[40:43], v[88:91], v[116:119]
    s_waitcnt vmcnt(1)
    v_mfma_f32_16x16x32_bf16 v[120:123], v[42:45], v[92:95], v[120:123]
    v_mfma_f32_16x16x32_bf16 v[124:127], v[40:43], v[92:95], v[124:127]
    s_waitcnt vmcnt(0)
    v_mfma_f32_16x16x32_bf16 v[128:131], v[42:45], v[96:99], v[128:131]
    s_nop 1
    v_cvt_pk_bf16_f32 v152, v112, v113
    v_cvt_pk_bf16_f32 v153, v114, v115
    ds_write_b64 v47, v[152:153] offset:0
    v_cvt_pk_bf16_f32 v154, v116, v117
    v_cvt_pk_bf16_f32 v155, v118, v119
    ds_write_b64 v47, v[154:155] offset:1024
    v_cvt_pk_bf16_f32 v156, v120, v121
    v_cvt_pk_bf16_f32 v157, v122, v123
    ds_write_b64 v33, v[156:157] offset:0
    v_cvt_pk_bf16_f32 v158, v124, v125
    v_cvt_pk_bf16_f32 v159, v126, v127
    ds_write_b64 v33, v[158:159] offset:1024
    v_cvt_pk_bf16_f32 v160, v128, v129
    v_cvt_pk_bf16_f32 v161, v130, v131
    ds_write_b64 v48, v[160:161]
    ds_read_b128 v[64:67], v49
    ds_read_b128 v[68:71], v49 offset:1024
    ds_read_b128 v[76:79], v50
    s_waitcnt lgkmcnt(2)
    buffer_store_dwordx4 v[64:67], v51, s[56:59], s90 offen sc1
    s_waitcnt lgkmcnt(1)
    buffer_store_dwordx4 v[68:71], v52, s[56:59], s90 offen sc1
    s_waitcnt lgkmcnt(0)
    buffer_store_dwordx4 v[76:79], v53, s[56:59], s91 offen sc1
L_end:
    s_endpgm
L_spin0:
    s_mov_b32 s88, 0
L_spin0a:
    buffer_load_dword v32, v22, s[64:67], s98 offen sc1
    s_waitcnt vmcnt(0)
    v_cmp_ne_u32 vcc, 0, v32
    s_add_u32 s88, s88, 1
    s_cmp_gt_u32 s88, 400000
    s_cbranch_scc1 L_back0
    s_and_b32 s77, vcc_lo, 1
    s_cmp_lg_u32 s77, 1
    s_cbranch_scc1 L_spin0a
    s_branch L_back0
L_spin1:
    s_mov_b32 s88, 0
L_spin1a:
    buffer_load_dword v32, v22, s[64:67], s98 offen sc1
    s_waitcnt vmcnt(0)
    v_cmp_ne_u32 vcc, 0, v32
    s_add_u32 s88, s88, 1
    s_cmp_gt_u32 s88, 400000
    s_cbranch_scc1 L_back1
    s_and_b32 s77, vcc_lo, 2
    s_cmp_lg_u32 s77, 2
    s_cbranch_scc1 L_spin1a
    s_branch L_back1
L_spin2:
    s_mov_b32 s88, 0
L_spin2a:
    buffer_load_dword v32, v22, s[64:67], s98 offen sc1
    s_waitcnt vmcnt(0)
    v_cmp_ne_u32 vcc, 0, v32
    s_add_u32 s88, s88, 1
    s_cmp_gt_u32 s88, 400000
    s_cbranch_scc1 L_back2
    s_and_b32 s77, vcc_lo, 4
    s_cmp_lg_u32 s77, 4
    s_cbranch_scc1 L_spin2a
    s_branch L_back2
L_hs_spin:
    s_mov_b32 s88, 0
L_hs_spin1:
    buffer_load_dword v35, v30, s[60:63], s76 offen sc1
    s_waitcnt vmcnt(0)
    v_readfirstlane_b32 s78, v35
    s_add_u32 s88, s88, 1
    s_cmp_gt_u32 s88, 400000
    s_cbranch_scc1 L_hsc
    s_cmp_lt_u32 s78, 16
    s_cbranch_scc1 L_hs_spin1
    s_branch L_hsc
L_spin3:
    s_mov_b32 s88, 0
L_spin3a:
    s_add_u32 s77, s6, 2
    s_and_b32 s77, s77, 3
    s_lshl_b32 s77, s77, 12
    s_add_u32 s77, s77, s83
    buffer_load_dwordx4 v[56:59], v28, s[64:67], s77 offen offset:0 sc1
    buffer_load_dwordx4 v[60:63], v28, s[64:67], s77 offen offset:1024 sc1
    buffer_load_dwordx4 v[2:5], v28, s[64:67], s77 offen offset:2048 sc1
    buffer_load_dwordx4 v[6:9], v28, s[64:67], s77 offen offset:3072 sc1
    s_waitcnt vmcnt(0)
    v_max3_u32 v33, v56, v57, v58
    v_max3_u32 v33, v33, v59, v60
    v_max3_u32 v33, v33, v61, v62
    v_max3_u32 v33, v33, v63, v2
    v_max3_u32 v33, v33, v3, v4
    v_max3_u32 v33, v33, v5, v6
    v_max3_u32 v33, v33, v7, v8
    v_max_u32 v33, v33, v9
    v_cmp_eq_u32 vcc, -1, v33
    s_add_u32 s88, s88, 1
    s_cmp_gt_u32 s88, 400000
    s_cbranch_scc1 L_back3
    s_cbranch_vccnz L_spin3a
    s_branch L_back3
L_spin4:
    s_mov_b32 s88, 0
L_spin4a:
    s_add_u32 s77, s6, 1
    s_and_b32 s77, s77, 3
    s_lshl_b32 s77, s77, 12
    s_add_u32 s77, s77, s83
    buffer_load_dwordx4 v[40:43], v28, s[64:67], s77 offen offset:0 sc1
    buffer_load_dwordx4 v[44:47], v28, s[64:67], s77 offen offset:1024 sc1
    buffer_load_dwordx4 v[48:51], v28, s[64:67], s77 offen offset:2048 sc1
    buffer_load_dwordx4 v[52:55], v28, s[64:67], s77 offen offset:3072 sc1
    s_waitcnt vmcnt(0)
    v_max3_u32 v33, v40, v41, v42
    v_max3_u32 v33, v33, v43, v44
    v_max3_u32 v33, v33, v45, v46
    v_max3_u32 v33, v33, v47, v48
    v_max3_u32 v33, v33, v49, v50
    v_max3_u32 v33, v33, v51, v52
    v_max3_u32 v33, v33, v53, v54
    v_max_u32 v33, v33, v55
    v_cmp_eq_u32 vcc, -1, v33
    s_add_u32 s88, s88, 1
    s_cmp_gt_u32 s88, 400000
    s_cbranch_scc1 L_back4
    s_cbranch_vccnz L_spin4a
    s_branch L_back4
L_spin5:
    s_mov_b32 s88, 0
L_spin5a:
    s_add_u32 s77, s6, 3
    s_and_b32 s77, s77, 3
    s_lshl_b32 s77, s77, 12
    s_add_u32 s77, s77, s83
    buffer_load_dwordx4 v[56:59], v28, s[64:67], s77 offen offset:0 sc1
    buffer_load_dwordx4 v[60:63], v28, s[64:67], s77 offen offset:1024 sc1
    buffer_load_dwordx4 v[2:5], v28, s[64:67], s77 offen offset:2048 sc1
    buffer_load_dwordx4 v[6:9], v28, s[64:67], s77 offen offset:3072 sc1
    s_waitcnt vmcnt(0)
    v_max3_u32 v33, v56, v57, v58
    v_max3_u32 v33, v33, v59, v60
    v_max3_u32 v33, v33, v61, v62
    v_max3_u32 v33, v33, v63, v2
    v_max3_u32 v33, v33, v3, v4
    v_max3_u32 v33, v33, v5, v6
    v_max3_u32 v33, v33, v7, v8
    v_max_u32 v33, v33, v9
    v_cmp_eq_u32 vcc, -1, v33
    s_add_u32 s88, s88, 1
    s_cmp_gt_u32 s88, 400000
    s_cbranch_scc1 L_back5
    s_cbranch_vccnz L_spin5a
    s_branch L_back5
L_compute:
    s_and_b32 s35, s2, 3
    s_bfe_u32 s6, s2, 0x20003
    s_lshr_b32 s7, s2, 5
    s_and_b32 s3, s31, 3
    s_lshl_b32 s73, s3, 12
    v_lshlrev_b32 v28, 4, v0
    v_and_b32 v33, 15, v0
    v_lshrrev_b32 v34, 4, v0
    v_bfe_u32 v35, v0, 2, 2
    v_and_b32 v36, 3, v0
    v_and_b32 v38, 1, v34
    v_lshl_or_b32 v37, v38, 2, v35
    s_and_b32 s10, s3, 1
    s_lshl_b32 s11, s10, 2
    v_lshl_add_u32 v40, v34, 3, v35
    v_lshlrev_b32 v40, 8, v40
    v_lshl_or_b32 v40, v36, 3, v40
    v_xor_b32 v41, s11, v37
    v_lshl_or_b32 v1, v41, 5, v40
    v_xor_b32 v2, 32, v1
    v_xor_b32 v3, 64, v1
    v_xor_b32 v4, 0x60, v1
    v_lshrrev_b32 v41, 1, v33
    v_xor_b32 v41, v41, v34
    v_lshlrev_b32 v41, 4, v41
    v_lshl_or_b32 v41, v33, 7, v41
    s_lshr_b32 s11, s3, 1
    s_lshl_b32 s30, s11, 13
    s_add_u32 s75, s30, 65536
    v_add_u32 v5, s75, v41
    v_xor_b32 v6, 64, v5
    s_lshl_b32 s10, s10, 11
    s_add_u32 s10, s10, s30
    s_add_u32 s10, s10, 147456
    v_add_u32 v15, s10, v28
    s_add_u32 s10, s73, 147456
    v_add_u32 v16, s10, v28
    v_add_u32 v17, s73, v28
    v_lshrrev_b32 v40, 1, v34
    v_xor_b32 v40, v40, v33
    v_lshlrev_b32 v40, 4, v40
    v_lshl_or_b32 v40, v38, 3, v40
    v_lshl_or_b32 v40, v33, 8, v40
    s_lshl_b32 s10, s73, 2
    s_add_u32 s10, s10, 98304
    v_add_u32 v40, s10, v40
    v_mov_b32 v7, v40
    s_load_dwordx2 s[60:61], s[0:1], 88
    s_load_dwordx2 s[64:65], s[0:1], 96
    v_xor_b32 v8, 32, v7
    v_xor_b32 v9, 64, v7
    v_xor_b32 v10, 96, v7
    v_xor_b32 v11, 128, v7
    v_xor_b32 v12, 160, v7
    v_xor_b32 v13, 192, v7
    v_xor_b32 v14, 224, v7
    s_mov_b32 s84, 1040356334
    s_mov_b32 s85, 1040356334
    s_waitcnt lgkmcnt(0)
    s_mov_b32 s66, 268435456
    s_mov_b32 s67, 0x00020000
    s_lshl_b32 s10, s9, 3
    s_add_u32 s10, s10, s7
    s_lshl_b32 s8, s10, 2
    s_add_u32 s8, s8, s6
    s_lshl_b32 s10, s8, 18
    s_add_u32 s10, s10, s73
    s_lshl_b32 s11, s35, 14
    s_add_u32 s79, s10, s11
    s_lshl_b32 s11, s35, 16
    s_add_u32 s80, s10, s11
    s_lshl_b32 s10, s9, 3
    s_add_u32 s10, s10, s7
    s_lshl_b32 s10, s10, 7
    s_lshl_b32 s11, s35, 3
    s_add_u32 s10, s10, s11
    s_lshl_b32 s11, s3, 5
    s_add_u32 s11, s11, s10
    s_lshl_b32 s11, s11, 11
    s_add_u32 s83, s11, 16777216
    s_lshr_b32 s11, s3, 1
    s_lshl_b32 s11, s11, 6
    s_add_u32 s10, s10, s11
    s_lshl_b32 s11, s6, 1
    s_add_u32 s10, s10, s11
    s_and_b32 s11, s3, 1
    s_add_u32 s10, s10, s11
    s_lshl_b32 s10, s10, 11
    s_add_u32 s81, s10, 16777216
    s_lshl_b32 s10, s8, 13
    s_lshl_b32 s11, s3, 9
    s_add_u32 s10, s10, s11
    s_add_u32 s82, s10, 20971520
    s_lshl_b32 s11, s35, 11
    s_add_u32 s98, s82, s11
    v_mov_b32 v33, 1073741824
    v_cmp_eq_u32 vcc, 0, v0
    v_mov_b32 v35, 0
    v_mov_b32 v31, 1
    v_cndmask_b32 v30, v33, v35, vcc
    v_lshlrev_b32 v29, 3, v0
    s_mov_b32 s62, 256
    s_mov_b32 s63, 0x00020000
    s_lshl_b32 s10, s3, 3
    s_add_u32 s89, s6, s10
    s_lshr_b32 s76, s8, 2
    s_lshl_b32 s76, s76, 4
    s_add_u32 s75, s81, 65536
    v_mov_b32 v35, 1073741824
    v_cmp_gt_u32 vcc, 24, v0
    v_mov_b32 v18, -1
    v_mov_b32 v19, -1
    v_cndmask_b32 v36, v35, v28, vcc
    v_mov_b32 v20, -1
    v_mov_b32 v21, -1
    v_mov_b32 v22, 0
    v_mov_b32 v23, 0
    v_mov_b32 v24, 0
    v_mov_b32 v25, 0
    s_barrier
    ds_read_b64_tr_b16 v[40:41], v1 offset:0
    ds_read_b64_tr_b16 v[42:43], v1 offset:1024
    ds_read_b128 v[64:67], v5 offset:0
    ds_read_b64_tr_b16 v[44:45], v1 offset:8192
    ds_read_b64_tr_b16 v[46:47], v1 offset:9216
    ds_read_b128 v[68:71], v6 offset:0
    ds_read_b128 v[72:75], v5 offset:2048
    ds_read_b128 v[76:79], v6 offset:2048
    ds_read_b128 v[80:83], v5 offset:4096
    ds_read_b128 v[84:87], v6 offset:4096
    ds_read_b128 v[88:91], v5 offset:6144
    ds_read_b128 v[92:95], v6 offset:6144
    ds_read_b64_tr_b16 v[48:49], v2 offset:0
    ds_read_b64_tr_b16 v[50:51], v2 offset:1024
    ds_read_b64_tr_b16 v[52:53], v2 offset:8192
    ds_read_b64_tr_b16 v[54:55], v2 offset:9216
    s_waitcnt lgkmcnt(11)
    v_mfma_f32_16x16x32_bf16 v[128:131], v[40:43], v[64:67], 0
    ds_read_b64_tr_b16 v[56:57], v3 offset:0
    s_waitcnt lgkmcnt(11)
    v_mfma_f32_16x16x32_bf16 v[128:131], v[44:47], v[68:71], v[128:131]
    ds_read_b64_tr_b16 v[58:59], v3 offset:1024
    s_waitcnt lgkmcnt(11)
    v_mfma_f32_16x16x32_bf16 v[132:135], v[40:43], v[72:75], 0
    ds_read_b64_tr_b16 v[60:61], v3 offset:8192
    s_waitcnt lgkmcnt(11)
    v_mfma_f32_16x16x32_bf16 v[132:135], v[44:47], v[76:79], v[132:135]
    ds_read_b64_tr_b16 v[62:63], v3 offset:9216
    s_waitcnt lgkmcnt(11)
    v_mfma_f32_16x16x32_bf16 v[136:139], v[40:43], v[80:83], 0
    s_waitcnt lgkmcnt(10)
    v_mfma_f32_16x16x32_bf16 v[136:139], v[44:47], v[84:87], v[136:139]
    s_waitcnt lgkmcnt(9)
    v_mfma_f32_16x16x32_bf16 v[140:143], v[40:43], v[88:91], 0
    s_waitcnt lgkmcnt(8)
    v_mfma_f32_16x16x32_bf16 v[140:143], v[44:47], v[92:95], v[140:143]
    s_waitcnt lgkmcnt(4)
    v_mfma_f32_16x16x32_bf16 v[144:147], v[48:51], v[64:67], 0
    ds_read_b64_tr_b16 v[40:41], v4 offset:0
    v_mfma_f32_16x16x32_bf16 v[144:147], v[52:55], v[68:71], v[144:147]
    ds_read_b64_tr_b16 v[42:43], v4 offset:1024
    v_mfma_f32_16x16x32_bf16 v[148:151], v[48:51], v[72:75], 0
    ds_read_b64_tr_b16 v[44:45], v4 offset:8192
    v_mfma_f32_16x16x32_bf16 v[148:151], v[52:55], v[76:79], v[148:151]
    ds_read_b64_tr_b16 v[46:47], v4 offset:9216
    v_mfma_f32_16x16x32_bf16 v[152:155], v[48:51], v[80:83], 0
    v_mfma_f32_16x16x32_bf16 v[152:155], v[52:55], v[84:87], v[152:155]
    v_mfma_f32_16x16x32_bf16 v[156:159], v[48:51], v[88:91], 0
    v_mfma_f32_16x16x32_bf16 v[156:159], v[52:55], v[92:95], v[156:159]
    s_waitcnt lgkmcnt(4)
    v_mfma_f32_16x16x32_bf16 v[160:163], v[56:59], v[64:67], 0
    v_mfma_f32_16x16x32_bf16 v[160:163], v[60:63], v[68:71], v[160:163]
    s_waitcnt lgkmcnt(0)
    s_barrier
    ds_read_b64_tr_b16 v[48:49], v1 offset:16384
    v_mfma_f32_16x16x32_bf16 v[164:167], v[56:59], v[72:75], 0
    ds_read_b64_tr_b16 v[50:51], v1 offset:17408
    v_mfma_f32_16x16x32_bf16 v[164:167], v[60:63], v[76:79], v[164:167]
    ds_read_b64_tr_b16 v[52:53], v1 offset:24576
    v_mfma_f32_16x16x32_bf16 v[168:171], v[56:59], v[80:83], 0
    ds_read_b64_tr_b16 v[54:55], v1 offset:25600
    v_mfma_f32_16x16x32_bf16 v[168:171], v[60:63], v[84:87], v[168:171]
    v_mfma_f32_16x16x32_bf16 v[172:175], v[56:59], v[88:91], 0
    v_mfma_f32_16x16x32_bf16 v[172:175], v[60:63], v[92:95], v[172:175]
    v_mfma_f32_16x16x32_bf16 v[176:179], v[40:43], v[64:67], 0
    ds_read_b64_tr_b16 v[56:57], v2 offset:16384
    v_mfma_f32_16x16x32_bf16 v[176:179], v[44:47], v[68:71], v[176:179]
    ds_read_b64_tr_b16 v[58:59], v2 offset:17408
    v_mfma_f32_16x16x32_bf16 v[180:183], v[40:43], v[72:75], 0
    ds_read_b64_tr_b16 v[60:61], v2 offset:24576
    v_mfma_f32_16x16x32_bf16 v[180:183], v[44:47], v[76:79], v[180:183]
    ds_read_b64_tr_b16 v[62:63], v2 offset:25600
    v_mfma_f32_16x16x32_bf16 v[184:187], v[40:43], v[80:83], 0
    v_mfma_f32_16x16x32_bf16 v[184:187], v[44:47], v[84:87], v[184:187]
    v_mfma_f32_16x16x32_bf16 v[188:191], v[40:43], v[88:91], 0
    v_mfma_f32_16x16x32_bf16 v[188:191], v[44:47], v[92:95], v[188:191]
    s_waitcnt lgkmcnt(4)
    v_mfma_f32_16x16x32_bf16 v[192:195], v[48:51], v[64:67], 0
    ds_read_b64_tr_b16 v[40:41], v3 offset:16384
    v_mfma_f32_16x16x32_bf16 v[192:195], v[52:55], v[68:71], v[192:195]
    ds_read_b64_tr_b16 v[42:43], v3 offset:17408
    v_mfma_f32_16x16x32_bf16 v[196:199], v[48:51], v[72:75], 0
    ds_read_b64_tr_b16 v[44:45], v3 offset:24576
    v_mfma_f32_16x16x32_bf16 v[196:199], v[52:55], v[76:79], v[196:199]
    ds_read_b64_tr_b16 v[46:47], v3 offset:25600
    v_mfma_f32_16x16x32_bf16 v[200:203], v[48:51], v[80:83], 0
    v_mfma_f32_16x16x32_bf16 v[200:203], v[52:55], v[84:87], v[200:203]
    v_mfma_f32_16x16x32_bf16 v[204:207], v[48:51], v[88:91], 0
    v_mfma_f32_16x16x32_bf16 v[204:207], v[52:55], v[92:95], v[204:207]
    s_waitcnt lgkmcnt(4)
    v_mfma_f32_16x16x32_bf16 v[208:211], v[56:59], v[64:67], 0
    ds_read_b64_tr_b16 v[48:49], v4 offset:16384
    v_mfma_f32_16x16x32_bf16 v[208:211], v[60:63], v[68:71], v[208:211]
    ds_read_b64_tr_b16 v[50:51], v4 offset:17408
    v_mfma_f32_16x16x32_bf16 v[212:215], v[56:59], v[72:75], 0
    ds_read_b64_tr_b16 v[52:53], v4 offset:24576
    v_mfma_f32_16x16x32_bf16 v[212:215], v[60:63], v[76:79], v[212:215]
    ds_read_b64_tr_b16 v[54:55], v4 offset:25600
    v_mfma_f32_16x16x32_bf16 v[216:219], v[56:59], v[80:83], 0
    v_mfma_f32_16x16x32_bf16 v[216:219], v[60:63], v[84:87], v[216:219]
    v_mfma_f32_16x16x32_bf16 v[220:223], v[56:59], v[88:91], 0
    v_mfma_f32_16x16x32_bf16 v[220:223], v[60:63], v[92:95], v[220:223]
    s_waitcnt lgkmcnt(4)
    v_mfma_f32_16x16x32_bf16 v[224:227], v[40:43], v[64:67], 0
    v_mfma_f32_16x16x32_bf16 v[224:227], v[44:47], v[68:71], v[224:227]
    s_waitcnt lgkmcnt(0)
    s_barrier
    ds_read_b64_tr_b16 v[56:57], v1 offset:32768
    v_mfma_f32_16x16x32_bf16 v[228:231], v[40:43], v[72:75], 0
    ds_read_b64_tr_b16 v[58:59], v1 offset:33792
    v_mfma_f32_16x16x32_bf16 v[228:231], v[44:47], v[76:79], v[228:231]
    ds_read_b64_tr_b16 v[60:61], v1 offset:40960
    v_mfma_f32_16x16x32_bf16 v[232:235], v[40:43], v[80:83], 0
    ds_read_b64_tr_b16 v[62:63], v1 offset:41984
    v_mfma_f32_16x16x32_bf16 v[232:235], v[44:47], v[84:87], v[232:235]
    ds_read_b128 v[96:99], v5 offset:16384
    v_mfma_f32_16x16x32_bf16 v[236:239], v[40:43], v[88:91], 0
    ds_read_b128 v[100:103], v6 offset:16384
    v_mfma_f32_16x16x32_bf16 v[236:239], v[44:47], v[92:95], v[236:239]
    ds_read_b128 v[104:107], v5 offset:18432
    v_mfma_f32_16x16x32_bf16 v[240:243], v[48:51], v[64:67], 0
    ds_read_b64_tr_b16 v[40:41], v2 offset:32768
    v_mfma_f32_16x16x32_bf16 v[240:243], v[52:55], v[68:71], v[240:243]
    ds_read_b64_tr_b16 v[42:43], v2 offset:33792
    v_mfma_f32_16x16x32_bf16 v[244:247], v[48:51], v[72:75], 0
    ds_read_b64_tr_b16 v[44:45], v2 offset:40960
    v_mfma_f32_16x16x32_bf16 v[244:247], v[52:55], v[76:79], v[244:247]
    ds_read_b64_tr_b16 v[46:47], v2 offset:41984
    v_mfma_f32_16x16x32_bf16 v[248:251], v[48:51], v[80:83], 0
    ds_read_b128 v[108:111], v6 offset:18432
    v_mfma_f32_16x16x32_bf16 v[248:251], v[52:55], v[84:87], v[248:251]
    ds_read_b128 v[112:115], v5 offset:20480
    v_mfma_f32_16x16x32_bf16 v[252:255], v[48:51], v[88:91], 0
    ds_read_b128 v[116:119], v6 offset:20480
    v_mfma_f32_16x16x32_bf16 v[252:255], v[52:55], v[92:95], v[252:255]
    ds_read_b128 v[120:123], v5 offset:22528
    s_waitcnt lgkmcnt(10)
    v_mfma_f32_16x16x32_bf16 v[128:131], v[56:59], v[96:99], v[128:131]
    ds_read_b64_tr_b16 v[48:49], v3 offset:32768
    ds_read_b128 v[124:127], v6 offset:22528
    s_waitcnt lgkmcnt(11)
    v_mfma_f32_16x16x32_bf16 v[128:131], v[60:63], v[100:103], v[128:131]
    ds_read_b64_tr_b16 v[50:51], v3 offset:33792
    s_waitcnt lgkmcnt(11)
    v_mfma_f32_16x16x32_bf16 v[132:135], v[56:59], v[104:107], v[132:135]
    ds_read_b64_tr_b16 v[52:53], v3 offset:40960
    s_waitcnt lgkmcnt(7)
    v_mfma_f32_16x16x32_bf16 v[132:135], v[60:63], v[108:111], v[132:135]
    ds_read_b64_tr_b16 v[54:55], v3 offset:41984
    s_waitcnt lgkmcnt(7)
    v_mfma_f32_16x16x32_bf16 v[136:139], v[56:59], v[112:115], v[136:139]
    buffer_store_dwordx4 v[18:21], v28, s[64:67], s81 offen offset:0 sc1
    s_waitcnt lgkmcnt(6)
    v_mfma_f32_16x16x32_bf16 v[136:139], v[60:63], v[116:119], v[136:139]
    s_waitcnt lgkmcnt(5)
    v_mfma_f32_16x16x32_bf16 v[140:143], v[56:59], v[120:123], v[140:143]
    s_waitcnt lgkmcnt(3)
    v_mfma_f32_16x16x32_bf16 v[140:143], v[60:63], v[124:127], v[140:143]
    v_mfma_f32_16x16x32_bf16 v[144:147], v[40:43], v[96:99], v[144:147]
    ds_read_b64_tr_b16 v[56:57], v4 offset:32768
    v_mfma_f32_16x16x32_bf16 v[144:147], v[44:47], v[100:103], v[144:147]
    ds_read_b64_tr_b16 v[58:59], v4 offset:33792
    v_mfma_f32_16x16x32_bf16 v[148:151], v[40:43], v[104:107], v[148:151]
    ds_read_b64_tr_b16 v[60:61], v4 offset:40960
    v_mfma_f32_16x16x32_bf16 v[148:151], v[44:47], v[108:111], v[148:151]
    ds_read_b64_tr_b16 v[62:63], v4 offset:41984
    v_mfma_f32_16x16x32_bf16 v[152:155], v[40:43], v[112:115], v[152:155]
    v_mfma_f32_16x16x32_bf16 v[152:155], v[44:47], v[116:119], v[152:155]
    v_mfma_f32_16x16x32_bf16 v[156:159], v[40:43], v[120:123], v[156:159]
    v_mfma_f32_16x16x32_bf16 v[156:159], v[44:47], v[124:127], v[156:159]
    s_waitcnt lgkmcnt(4)
    v_mfma_f32_16x16x32_bf16 v[160:163], v[48:51], v[96:99], v[160:163]
    v_mfma_f32_16x16x32_bf16 v[160:163], v[52:55], v[100:103], v[160:163]
    s_waitcnt lgkmcnt(0)
    s_barrier
    ds_read_b64_tr_b16 v[40:41], v1 offset:49152
    v_mfma_f32_16x16x32_bf16 v[164:167], v[48:51], v[104:107], v[164:167]
    ds_read_b64_tr_b16 v[42:43], v1 offset:50176
    v_mfma_f32_16x16x32_bf16 v[164:167], v[52:55], v[108:111], v[164:167]
    ds_read_b64_tr_b16 v[44:45], v1 offset:57344
    v_mfma_f32_16x16x32_bf16 v[168:171], v[48:51], v[112:115], v[168:171]
    ds_read_b64_tr_b16 v[46:47], v1 offset:58368
    v_mfma_f32_16x16x32_bf16 v[168:171], v[52:55], v[116:119], v[168:171]
    v_mfma_f32_16x16x32_bf16 v[172:175], v[48:51], v[120:123], v[172:175]
    v_mfma_f32_16x16x32_bf16 v[172:175], v[52:55], v[124:127], v[172:175]
    v_mfma_f32_16x16x32_bf16 v[176:179], v[56:59], v[96:99], v[176:179]
    ds_read_b64_tr_b16 v[48:49], v2 offset:49152
    v_mfma_f32_16x16x32_bf16 v[176:179], v[60:63], v[100:103], v[176:179]
    ds_read_b64_tr_b16 v[50:51], v2 offset:50176
    v_mfma_f32_16x16x32_bf16 v[180:183], v[56:59], v[104:107], v[180:183]
    ds_read_b64_tr_b16 v[52:53], v2 offset:57344
    v_mfma_f32_16x16x32_bf16 v[180:183], v[60:63], v[108:111], v[180:183]
    ds_read_b64_tr_b16 v[54:55], v2 offset:58368
    v_mfma_f32_16x16x32_bf16 v[184:187], v[56:59], v[112:115], v[184:187]
    v_mfma_f32_16x16x32_bf16 v[184:187], v[60:63], v[116:119], v[184:187]
    buffer_store_dwordx4 v[18:21], v28, s[64:67], s81 offen offset:1024 sc1
    v_mfma_f32_16x16x32_bf16 v[188:191], v[56:59], v[120:123], v[188:191]
    v_mfma_f32_16x16x32_bf16 v[188:191], v[60:63], v[124:127], v[188:191]
    s_waitcnt lgkmcnt(4)
    v_mfma_f32_16x16x32_bf16 v[192:195], v[40:43], v[96:99], v[192:195]
    ds_read_b64_tr_b16 v[56:57], v3 offset:49152
    v_mfma_f32_16x16x32_bf16 v[192:195], v[44:47], v[100:103], v[192:195]
    ds_read_b64_tr_b16 v[58:59], v3 offset:50176
    v_mfma_f32_16x16x32_bf16 v[196:199], v[40:43], v[104:107], v[196:199]
    ds_read_b64_tr_b16 v[60:61], v3 offset:57344
    v_mfma_f32_16x16x32_bf16 v[196:199], v[44:47], v[108:111], v[196:199]
    ds_read_b64_tr_b16 v[62:63], v3 offset:58368
    v_mfma_f32_16x16x32_bf16 v[200:203], v[40:43], v[112:115], v[200:203]
    v_mfma_f32_16x16x32_bf16 v[200:203], v[44:47], v[116:119], v[200:203]
    v_mfma_f32_16x16x32_bf16 v[204:207], v[40:43], v[120:123], v[204:207]
    v_mfma_f32_16x16x32_bf16 v[204:207], v[44:47], v[124:127], v[204:207]
    s_waitcnt lgkmcnt(4)
    v_mfma_f32_16x16x32_bf16 v[208:211], v[48:51], v[96:99], v[208:211]
    ds_read_b64_tr_b16 v[40:41], v4 offset:49152
    v_mfma_f32_16x16x32_bf16 v[208:211], v[52:55], v[100:103], v[208:211]
    ds_read_b64_tr_b16 v[42:43], v4 offset:50176
    v_mfma_f32_16x16x32_bf16 v[212:215], v[48:51], v[104:107], v[212:215]
    ds_read_b64_tr_b16 v[44:45], v4 offset:57344
    v_mfma_f32_16x16x32_bf16 v[212:215], v[52:55], v[108:111], v[212:215]
    ds_read_b64_tr_b16 v[46:47], v4 offset:58368
    v_mfma_f32_16x16x32_bf16 v[216:219], v[48:51], v[112:115], v[216:219]
    v_mfma_f32_16x16x32_bf16 v[216:219], v[52:55], v[116:119], v[216:219]
    v_mfma_f32_16x16x32_bf16 v[220:223], v[48:51], v[120:123], v[220:223]
    v_mfma_f32_16x16x32_bf16 v[220:223], v[52:55], v[124:127], v[220:223]
    s_waitcnt lgkmcnt(4)
    v_mfma_f32_16x16x32_bf16 v[224:227], v[56:59], v[96:99], v[224:227]
    v_mfma_f32_16x16x32_bf16 v[224:227], v[60:63], v[100:103], v[224:227]
    s_waitcnt lgkmcnt(0)
    s_barrier
    ds_read_b64_tr_b16 v[48:49], v1 offset:0
    v_mfma_f32_16x16x32_bf16 v[228:231], v[56:59], v[104:107], v[228:231]
    ds_read_b64_tr_b16 v[50:51], v1 offset:1024
    v_mfma_f32_16x16x32_bf16 v[228:231], v[60:63], v[108:111], v[228:231]
    ds_read_b64_tr_b16 v[52:53], v1 offset:8192
    v_mfma_f32_16x16x32_bf16 v[232:235], v[56:59], v[112:115], v[232:235]
    ds_read_b64_tr_b16 v[54:55], v1 offset:9216
    v_mfma_f32_16x16x32_bf16 v[232:235], v[60:63], v[116:119], v[232:235]
    ds_read_b128 v[64:67], v5 offset:0
    v_mfma_f32_16x16x32_bf16 v[236:239], v[56:59], v[120:123], v[236:239]
    ds_read_b128 v[68:71], v6 offset:0
    v_mfma_f32_16x16x32_bf16 v[236:239], v[60:63], v[124:127], v[236:239]
    ds_read_b128 v[72:75], v5 offset:2048
    buffer_store_dwordx4 v[18:21], v28, s[64:67], s75 offen offset:0 sc1
    v_mfma_f32_16x16x32_bf16 v[240:243], v[40:43], v[96:99], v[240:243]
    ds_read_b64_tr_b16 v[56:57], v2 offset:0
    v_mfma_f32_16x16x32_bf16 v[240:243], v[44:47], v[100:103], v[240:243]
    ds_read_b64_tr_b16 v[58:59], v2 offset:1024
    v_mfma_f32_16x16x32_bf16 v[244:247], v[40:43], v[104:107], v[244:247]
    ds_read_b64_tr_b16 v[60:61], v2 offset:8192
    v_mfma_f32_16x16x32_bf16 v[244:247], v[44:47], v[108:111], v[244:247]
    ds_read_b64_tr_b16 v[62:63], v2 offset:9216
    v_mfma_f32_16x16x32_bf16 v[248:251], v[40:43], v[112:115], v[248:251]
    ds_read_b128 v[76:79], v6 offset:2048
    v_mfma_f32_16x16x32_bf16 v[248:251], v[44:47], v[116:119], v[248:251]
    ds_read_b128 v[80:83], v5 offset:4096
    v_mfma_f32_16x16x32_bf16 v[252:255], v[40:43], v[120:123], v[252:255]
    ds_read_b128 v[84:87], v6 offset:4096
    v_mfma_f32_16x16x32_bf16 v[252:255], v[44:47], v[124:127], v[252:255]
    ds_read_b128 v[88:91], v5 offset:6144
    s_waitcnt lgkmcnt(10)
    v_mfma_f32_16x16x32_bf16 v[128:131], v[48:51], v[64:67], v[128:131]
    ds_read_b64_tr_b16 v[40:41], v3 offset:0
    ds_read_b128 v[92:95], v6 offset:6144
    s_waitcnt lgkmcnt(11)
    v_mfma_f32_16x16x32_bf16 v[128:131], v[52:55], v[68:71], v[128:131]
    ds_read_b64_tr_b16 v[42:43], v3 offset:1024
    s_waitcnt lgkmcnt(11)
    v_mfma_f32_16x16x32_bf16 v[132:135], v[48:51], v[72:75], v[132:135]
    ds_read_b64_tr_b16 v[44:45], v3 offset:8192
    s_waitcnt lgkmcnt(7)
    v_mfma_f32_16x16x32_bf16 v[132:135], v[52:55], v[76:79], v[132:135]
    ds_read_b64_tr_b16 v[46:47], v3 offset:9216
    s_waitcnt lgkmcnt(7)
    v_mfma_f32_16x16x32_bf16 v[136:139], v[48:51], v[80:83], v[136:139]
    s_waitcnt lgkmcnt(6)
    v_mfma_f32_16x16x32_bf16 v[136:139], v[52:55], v[84:87], v[136:139]
    s_waitcnt lgkmcnt(5)
    v_mfma_f32_16x16x32_bf16 v[140:143], v[48:51], v[88:91], v[140:143]
    s_waitcnt lgkmcnt(3)
    v_mfma_f32_16x16x32_bf16 v[140:143], v[52:55], v[92:95], v[140:143]
    v_mfma_f32_16x16x32_bf16 v[144:147], v[56:59], v[64:67], v[144:147]
    ds_read_b64_tr_b16 v[48:49], v4 offset:0
    v_mfma_f32_16x16x32_bf16 v[144:147], v[60:63], v[68:71], v[144:147]
    ds_read_b64_tr_b16 v[50:51], v4 offset:1024
    v_mfma_f32_16x16x32_bf16 v[148:151], v[56:59], v[72:75], v[148:151]
    ds_read_b64_tr_b16 v[52:53], v4 offset:8192
    v_mfma_f32_16x16x32_bf16 v[148:151], v[60:63], v[76:79], v[148:151]
    ds_read_b64_tr_b16 v[54:55], v4 offset:9216
    v_mfma_f32_16x16x32_bf16 v[152:155], v[56:59], v[80:83], v[152:155]
    v_mfma_f32_16x16x32_bf16 v[152:155], v[60:63], v[84:87], v[152:155]
    v_mfma_f32_16x16x32_bf16 v[156:159], v[56:59], v[88:91], v[156:159]
    v_mfma_f32_16x16x32_bf16 v[156:159], v[60:63], v[92:95], v[156:159]
    s_waitcnt lgkmcnt(4)
    v_mfma_f32_16x16x32_bf16 v[160:163], v[40:43], v[64:67], v[160:163]
    v_mfma_f32_16x16x32_bf16 v[160:163], v[44:47], v[68:71], v[160:163]
    s_waitcnt lgkmcnt(0)
    s_barrier
    ds_read_b64_tr_b16 v[56:57], v1 offset:16384
    buffer_store_dwordx4 v[18:21], v28, s[64:67], s75 offen offset:1024 sc1
    v_mfma_f32_16x16x32_bf16 v[164:167], v[40:43], v[72:75], v[164:167]
    ds_read_b64_tr_b16 v[58:59], v1 offset:17408
    v_mfma_f32_16x16x32_bf16 v[164:167], v[44:47], v[76:79], v[164:167]
    ds_read_b64_tr_b16 v[60:61], v1 offset:24576
    v_mfma_f32_16x16x32_bf16 v[168:171], v[40:43], v[80:83], v[168:171]
    ds_read_b64_tr_b16 v[62:63], v1 offset:25600
    v_mfma_f32_16x16x32_bf16 v[168:171], v[44:47], v[84:87], v[168:171]
    v_mfma_f32_16x16x32_bf16 v[172:175], v[40:43], v[88:91], v[172:175]
    v_mfma_f32_16x16x32_bf16 v[172:175], v[44:47], v[92:95], v[172:175]
    v_mfma_f32_16x16x32_bf16 v[176:179], v[48:51], v[64:67], v[176:179]
    ds_read_b64_tr_b16 v[40:41], v2 offset:16384
    v_mfma_f32_16x16x32_bf16 v[176:179], v[52:55], v[68:71], v[176:179]
    ds_read_b64_tr_b16 v[42:43], v2 offset:17408
    v_mfma_f32_16x16x32_bf16 v[180:183], v[48:51], v[72:75], v[180:183]
    ds_read_b64_tr_b16 v[44:45], v2 offset:24576
    v_mfma_f32_16x16x32_bf16 v[180:183], v[52:55], v[76:79], v[180:183]
    ds_read_b64_tr_b16 v[46:47], v2 offset:25600
    v_mfma_f32_16x16x32_bf16 v[184:187], v[48:51], v[80:83], v[184:187]
    v_mfma_f32_16x16x32_bf16 v[184:187], v[52:55], v[84:87], v[184:187]
    v_mfma_f32_16x16x32_bf16 v[188:191], v[48:51], v[88:91], v[188:191]
    v_mfma_f32_16x16x32_bf16 v[188:191], v[52:55], v[92:95], v[188:191]
    s_waitcnt lgkmcnt(4)
    v_mfma_f32_16x16x32_bf16 v[192:195], v[56:59], v[64:67], v[192:195]
    ds_read_b64_tr_b16 v[48:49], v3 offset:16384
    v_mfma_f32_16x16x32_bf16 v[192:195], v[60:63], v[68:71], v[192:195]
    ds_read_b64_tr_b16 v[50:51], v3 offset:17408
    v_mfma_f32_16x16x32_bf16 v[196:199], v[56:59], v[72:75], v[196:199]
    ds_read_b64_tr_b16 v[52:53], v3 offset:24576
    v_mfma_f32_16x16x32_bf16 v[196:199], v[60:63], v[76:79], v[196:199]
    ds_read_b64_tr_b16 v[54:55], v3 offset:25600
    v_mfma_f32_16x16x32_bf16 v[200:203], v[56:59], v[80:83], v[200:203]
    v_mfma_f32_16x16x32_bf16 v[200:203], v[60:63], v[84:87], v[200:203]
    v_mfma_f32_16x16x32_bf16 v[204:207], v[56:59], v[88:91], v[204:207]
    v_mfma_f32_16x16x32_bf16 v[204:207], v[60:63], v[92:95], v[204:207]
    s_waitcnt lgkmcnt(4)
    v_mfma_f32_16x16x32_bf16 v[208:211], v[40:43], v[64:67], v[208:211]
    ds_read_b64_tr_b16 v[56:57], v4 offset:16384
    v_mfma_f32_16x16x32_bf16 v[208:211], v[44:47], v[68:71], v[208:211]
    ds_read_b64_tr_b16 v[58:59], v4 offset:17408
    v_mfma_f32_16x16x32_bf16 v[212:215], v[40:43], v[72:75], v[212:215]
    ds_read_b64_tr_b16 v[60:61], v4 offset:24576
    v_mfma_f32_16x16x32_bf16 v[212:215], v[44:47], v[76:79], v[212:215]
    ds_read_b64_tr_b16 v[62:63], v4 offset:25600
    buffer_store_dwordx4 v[22:25], v36, s[64:67], s98 offen sc1
    v_mfma_f32_16x16x32_bf16 v[216:219], v[40:43], v[80:83], v[216:219]
    v_mfma_f32_16x16x32_bf16 v[216:219], v[44:47], v[84:87], v[216:219]
    v_mfma_f32_16x16x32_bf16 v[220:223], v[40:43], v[88:91], v[220:223]
    v_mfma_f32_16x16x32_bf16 v[220:223], v[44:47], v[92:95], v[220:223]
    s_waitcnt lgkmcnt(4)
    v_mfma_f32_16x16x32_bf16 v[224:227], v[48:51], v[64:67], v[224:227]
    v_mfma_f32_16x16x32_bf16 v[224:227], v[52:55], v[68:71], v[224:227]
    s_waitcnt lgkmcnt(0)
    s_barrier
    ds_read_b64_tr_b16 v[40:41], v1 offset:32768
    v_mfma_f32_16x16x32_bf16 v[228:231], v[48:51], v[72:75], v[228:231]
    ds_read_b64_tr_b16 v[42:43], v1 offset:33792
    v_mfma_f32_16x16x32_bf16 v[228:231], v[52:55], v[76:79], v[228:231]
    ds_read_b64_tr_b16 v[44:45], v1 offset:40960
    v_mfma_f32_16x16x32_bf16 v[232:235], v[48:51], v[80:83], v[232:235]
    ds_read_b64_tr_b16 v[46:47], v1 offset:41984
    v_mfma_f32_16x16x32_bf16 v[232:235], v[52:55], v[84:87], v[232:235]
    ds_read_b128 v[96:99], v5 offset:16384
    v_mfma_f32_16x16x32_bf16 v[236:239], v[48:51], v[88:91], v[236:239]
    ds_read_b128 v[100:103], v6 offset:16384
    v_mfma_f32_16x16x32_bf16 v[236:239], v[52:55], v[92:95], v[236:239]
    ds_read_b128 v[104:107], v5 offset:18432
    v_mfma_f32_16x16x32_bf16 v[240:243], v[56:59], v[64:67], v[240:243]
    ds_read_b64_tr_b16 v[48:49], v2 offset:32768
    v_mfma_f32_16x16x32_bf16 v[240:243], v[60:63], v[68:71], v[240:243]
    ds_read_b64_tr_b16 v[50:51], v2 offset:33792
    v_mfma_f32_16x16x32_bf16 v[244:247], v[56:59], v[72:75], v[244:247]
    ds_read_b64_tr_b16 v[52:53], v2 offset:40960
    v_mfma_f32_16x16x32_bf16 v[244:247], v[60:63], v[76:79], v[244:247]
    ds_read_b64_tr_b16 v[54:55], v2 offset:41984
    v_mfma_f32_16x16x32_bf16 v[248:251], v[56:59], v[80:83], v[248:251]
    ds_read_b128 v[108:111], v6 offset:18432
    v_mfma_f32_16x16x32_bf16 v[248:251], v[60:63], v[84:87], v[248:251]
    ds_read_b128 v[112:115], v5 offset:20480
    v_mfma_f32_16x16x32_bf16 v[252:255], v[56:59], v[88:91], v[252:255]
    ds_read_b128 v[116:119], v6 offset:20480
    v_mfma_f32_16x16x32_bf16 v[252:255], v[60:63], v[92:95], v[252:255]
    ds_read_b128 v[120:123], v5 offset:22528
    s_waitcnt lgkmcnt(10)
    v_mfma_f32_16x16x32_bf16 v[128:131], v[40:43], v[96:99], v[128:131]
    ds_read_b64_tr_b16 v[56:57], v3 offset:32768
    ds_read_b128 v[124:127], v6 offset:22528
    s_waitcnt lgkmcnt(11)
    v_mfma_f32_16x16x32_bf16 v[128:131], v[44:47], v[100:103], v[128:131]
    ds_read_b64_tr_b16 v[58:59], v3 offset:33792
    s_waitcnt lgkmcnt(11)
    v_mfma_f32_16x16x32_bf16 v[132:135], v[40:43], v[104:107], v[132:135]
    ds_read_b64_tr_b16 v[60:61], v3 offset:40960
    s_waitcnt lgkmcnt(7)
    v_mfma_f32_16x16x32_bf16 v[132:135], v[44:47], v[108:111], v[132:135]
    ds_read_b64_tr_b16 v[62:63], v3 offset:41984
    s_waitcnt lgkmcnt(7)
    v_mfma_f32_16x16x32_bf16 v[136:139], v[40:43], v[112:115], v[136:139]
    s_waitcnt lgkmcnt(6)
    v_mfma_f32_16x16x32_bf16 v[136:139], v[44:47], v[116:119], v[136:139]
    s_waitcnt lgkmcnt(5)
    v_mfma_f32_16x16x32_bf16 v[140:143], v[40:43], v[120:123], v[140:143]
    s_waitcnt lgkmcnt(3)
    v_mfma_f32_16x16x32_bf16 v[140:143], v[44:47], v[124:127], v[140:143]
    v_mfma_f32_16x16x32_bf16 v[144:147], v[48:51], v[96:99], v[144:147]
    ds_read_b64_tr_b16 v[40:41], v4 offset:32768
    v_mfma_f32_16x16x32_bf16 v[144:147], v[52:55], v[100:103], v[144:147]
    ds_read_b64_tr_b16 v[42:43], v4 offset:33792
    v_mfma_f32_16x16x32_bf16 v[148:151], v[48:51], v[104:107], v[148:151]
    ds_read_b64_tr_b16 v[44:45], v4 offset:40960
    v_mfma_f32_16x16x32_bf16 v[148:151], v[52:55], v[108:111], v[148:151]
    ds_read_b64_tr_b16 v[46:47], v4 offset:41984
    v_mfma_f32_16x16x32_bf16 v[152:155], v[48:51], v[112:115], v[152:155]
    v_mfma_f32_16x16x32_bf16 v[152:155], v[52:55], v[116:119], v[152:155]
    v_mfma_f32_16x16x32_bf16 v[156:159], v[48:51], v[120:123], v[156:159]
    v_mfma_f32_16x16x32_bf16 v[156:159], v[52:55], v[124:127], v[156:159]
    s_waitcnt lgkmcnt(4)
    v_mfma_f32_16x16x32_bf16 v[160:163], v[56:59], v[96:99], v[160:163]
    v_mfma_f32_16x16x32_bf16 v[160:163], v[60:63], v[100:103], v[160:163]
    s_waitcnt lgkmcnt(0)
    s_barrier
    ds_read_b64_tr_b16 v[48:49], v1 offset:49152
    v_mfma_f32_16x16x32_bf16 v[164:167], v[56:59], v[104:107], v[164:167]
    ds_read_b64_tr_b16 v[50:51], v1 offset:50176
    v_mfma_f32_16x16x32_bf16 v[164:167], v[60:63], v[108:111], v[164:167]
    ds_read_b64_tr_b16 v[52:53], v1 offset:57344
    v_mfma_f32_16x16x32_bf16 v[168:171], v[56:59], v[112:115], v[168:171]
    ds_read_b64_tr_b16 v[54:55], v1 offset:58368
    v_mfma_f32_16x16x32_bf16 v[168:171], v[60:63], v[116:119], v[168:171]
    v_mfma_f32_16x16x32_bf16 v[172:175], v[56:59], v[120:123], v[172:175]
    v_mfma_f32_16x16x32_bf16 v[172:175], v[60:63], v[124:127], v[172:175]
    v_mfma_f32_16x16x32_bf16 v[176:179], v[40:43], v[96:99], v[176:179]
    ds_read_b64_tr_b16 v[56:57], v2 offset:49152
    v_mfma_f32_16x16x32_bf16 v[176:179], v[44:47], v[100:103], v[176:179]
    ds_read_b64_tr_b16 v[58:59], v2 offset:50176
    v_mfma_f32_16x16x32_bf16 v[180:183], v[40:43], v[104:107], v[180:183]
    ds_read_b64_tr_b16 v[60:61], v2 offset:57344
    v_mfma_f32_16x16x32_bf16 v[180:183], v[44:47], v[108:111], v[180:183]
    ds_read_b64_tr_b16 v[62:63], v2 offset:58368
    v_mfma_f32_16x16x32_bf16 v[184:187], v[40:43], v[112:115], v[184:187]
    v_mfma_f32_16x16x32_bf16 v[184:187], v[44:47], v[116:119], v[184:187]
    v_mfma_f32_16x16x32_bf16 v[188:191], v[40:43], v[120:123], v[188:191]
    v_mfma_f32_16x16x32_bf16 v[188:191], v[44:47], v[124:127], v[188:191]
    s_waitcnt lgkmcnt(4)
    v_mfma_f32_16x16x32_bf16 v[192:195], v[48:51], v[96:99], v[192:195]
    ds_read_b64_tr_b16 v[40:41], v3 offset:49152
    v_mfma_f32_16x16x32_bf16 v[192:195], v[52:55], v[100:103], v[192:195]
    ds_read_b64_tr_b16 v[42:43], v3 offset:50176
    v_mfma_f32_16x16x32_bf16 v[196:199], v[48:51], v[104:107], v[196:199]
    ds_read_b64_tr_b16 v[44:45], v3 offset:57344
    v_mfma_f32_16x16x32_bf16 v[196:199], v[52:55], v[108:111], v[196:199]
    ds_read_b64_tr_b16 v[46:47], v3 offset:58368
    v_mfma_f32_16x16x32_bf16 v[200:203], v[48:51], v[112:115], v[200:203]
    v_mfma_f32_16x16x32_bf16 v[200:203], v[52:55], v[116:119], v[200:203]
    v_mfma_f32_16x16x32_bf16 v[204:207], v[48:51], v[120:123], v[204:207]
    v_mfma_f32_16x16x32_bf16 v[204:207], v[52:55], v[124:127], v[204:207]
    s_waitcnt lgkmcnt(4)
    v_mfma_f32_16x16x32_bf16 v[208:211], v[56:59], v[96:99], v[208:211]
    ds_read_b64_tr_b16 v[48:49], v4 offset:49152
    v_mfma_f32_16x16x32_bf16 v[208:211], v[60:63], v[100:103], v[208:211]
    ds_read_b64_tr_b16 v[50:51], v4 offset:50176
    v_mfma_f32_16x16x32_bf16 v[212:215], v[56:59], v[104:107], v[212:215]
    ds_read_b64_tr_b16 v[52:53], v4 offset:57344
    v_mfma_f32_16x16x32_bf16 v[212:215], v[60:63], v[108:111], v[212:215]
    ds_read_b64_tr_b16 v[54:55], v4 offset:58368
    v_mfma_f32_16x16x32_bf16 v[216:219], v[56:59], v[112:115], v[216:219]
    v_mfma_f32_16x16x32_bf16 v[216:219], v[60:63], v[116:119], v[216:219]
    v_mfma_f32_16x16x32_bf16 v[220:223], v[56:59], v[120:123], v[220:223]
    v_mfma_f32_16x16x32_bf16 v[220:223], v[60:63], v[124:127], v[220:223]
    s_waitcnt lgkmcnt(4)
    v_mfma_f32_16x16x32_bf16 v[224:227], v[40:43], v[96:99], v[224:227]
    v_mfma_f32_16x16x32_bf16 v[224:227], v[44:47], v[100:103], v[224:227]
    s_waitcnt vmcnt(0)
    s_waitcnt lgkmcnt(0)
    s_barrier
    ds_read_b64_tr_b16 v[56:57], v1 offset:0
    v_mfma_f32_16x16x32_bf16 v[228:231], v[40:43], v[104:107], v[228:231]
    ds_read_b64_tr_b16 v[58:59], v1 offset:1024
    v_mfma_f32_16x16x32_bf16 v[228:231], v[44:47], v[108:111], v[228:231]
    ds_read_b64_tr_b16 v[60:61], v1 offset:8192
    v_mfma_f32_16x16x32_bf16 v[232:235], v[40:43], v[112:115], v[232:235]
    ds_read_b64_tr_b16 v[62:63], v1 offset:9216
    v_mfma_f32_16x16x32_bf16 v[232:235], v[44:47], v[116:119], v[232:235]
    ds_read_b128 v[64:67], v5 offset:0
    v_mfma_f32_16x16x32_bf16 v[236:239], v[40:43], v[120:123], v[236:239]
    ds_read_b128 v[68:71], v6 offset:0
    v_mfma_f32_16x16x32_bf16 v[236:239], v[44:47], v[124:127], v[236:239]
    ds_read_b128 v[72:75], v5 offset:2048
    v_mfma_f32_16x16x32_bf16 v[240:243], v[48:51], v[96:99], v[240:243]
    ds_read_b64_tr_b16 v[40:41], v2 offset:0
    v_mfma_f32_16x16x32_bf16 v[240:243], v[52:55], v[100:103], v[240:243]
    ds_read_b64_tr_b16 v[42:43], v2 offset:1024
    v_mfma_f32_16x16x32_bf16 v[244:247], v[48:51], v[104:107], v[244:247]
    ds_read_b64_tr_b16 v[44:45], v2 offset:8192
    v_mfma_f32_16x16x32_bf16 v[244:247], v[52:55], v[108:111], v[244:247]
    ds_read_b64_tr_b16 v[46:47], v2 offset:9216
    v_mfma_f32_16x16x32_bf16 v[248:251], v[48:51], v[112:115], v[248:251]
    ds_read_b128 v[76:79], v6 offset:2048
    v_mfma_f32_16x16x32_bf16 v[248:251], v[52:55], v[116:119], v[248:251]
    ds_read_b128 v[80:83], v5 offset:4096
    v_mfma_f32_16x16x32_bf16 v[252:255], v[48:51], v[120:123], v[252:255]
    ds_read_b128 v[84:87], v6 offset:4096
    v_mfma_f32_16x16x32_bf16 v[252:255], v[52:55], v[124:127], v[252:255]
    ds_read_b128 v[88:91], v5 offset:6144
    s_waitcnt lgkmcnt(10)
    v_mfma_f32_16x16x32_bf16 v[128:131], v[56:59], v[64:67], v[128:131]
    ds_read_b64_tr_b16 v[48:49], v3 offset:0
    ds_read_b128 v[92:95], v6 offset:6144
    s_waitcnt lgkmcnt(11)
    v_mfma_f32_16x16x32_bf16 v[128:131], v[60:63], v[68:71], v[128:131]
    ds_read_b64_tr_b16 v[50:51], v3 offset:1024
    s_waitcnt lgkmcnt(11)
    v_mfma_f32_16x16x32_bf16 v[132:135], v[56:59], v[72:75], v[132:135]
    ds_read_b64_tr_b16 v[52:53], v3 offset:8192
    s_waitcnt lgkmcnt(7)
    v_mfma_f32_16x16x32_bf16 v[132:135], v[60:63], v[76:79], v[132:135]
    ds_read_b64_tr_b16 v[54:55], v3 offset:9216
    s_waitcnt lgkmcnt(7)
    v_mfma_f32_16x16x32_bf16 v[136:139], v[56:59], v[80:83], v[136:139]
    s_waitcnt lgkmcnt(6)
    v_mfma_f32_16x16x32_bf16 v[136:139], v[60:63], v[84:87], v[136:139]
    s_cmp_lg_u32 s89, 0
    s_cbranch_scc1 L_hs0
    buffer_atomic_add v31, v30, s[60:63], s76 offen sc1
L_hs0:
    s_waitcnt lgkmcnt(5)
    v_mfma_f32_16x16x32_bf16 v[140:143], v[56:59], v[88:91], v[140:143]
    s_waitcnt lgkmcnt(3)
    v_mfma_f32_16x16x32_bf16 v[140:143], v[60:63], v[92:95], v[140:143]
    v_mfma_f32_16x16x32_bf16 v[144:147], v[40:43], v[64:67], v[144:147]
    ds_read_b64_tr_b16 v[56:57], v4 offset:0
    v_mfma_f32_16x16x32_bf16 v[144:147], v[44:47], v[68:71], v[144:147]
    ds_read_b64_tr_b16 v[58:59], v4 offset:1024
    v_mfma_f32_16x16x32_bf16 v[148:151], v[40:43], v[72:75], v[148:151]
    ds_read_b64_tr_b16 v[60:61], v4 offset:8192
    v_mfma_f32_16x16x32_bf16 v[148:151], v[44:47], v[76:79], v[148:151]
    ds_read_b64_tr_b16 v[62:63], v4 offset:9216
    v_mfma_f32_16x16x32_bf16 v[152:155], v[40:43], v[80:83], v[152:155]
    v_mfma_f32_16x16x32_bf16 v[152:155], v[44:47], v[84:87], v[152:155]
    v_mfma_f32_16x16x32_bf16 v[156:159], v[40:43], v[88:91], v[156:159]
    v_mfma_f32_16x16x32_bf16 v[156:159], v[44:47], v[92:95], v[156:159]
    s_waitcnt lgkmcnt(4)
    v_mfma_f32_16x16x32_bf16 v[160:163], v[48:51], v[64:67], v[160:163]
    v_mfma_f32_16x16x32_bf16 v[160:163], v[52:55], v[68:71], v[160:163]
    s_waitcnt lgkmcnt(0)
    s_barrier
    ds_read_b64_tr_b16 v[40:41], v1 offset:16384
    v_mfma_f32_16x16x32_bf16 v[164:167], v[48:51], v[72:75], v[164:167]
    ds_read_b64_tr_b16 v[42:43], v1 offset:17408
    v_mfma_f32_16x16x32_bf16 v[164:167], v[52:55], v[76:79], v[164:167]
    ds_read_b64_tr_b16 v[44:45], v1 offset:24576
    v_mfma_f32_16x16x32_bf16 v[168:171], v[48:51], v[80:83], v[168:171]
    ds_read_b64_tr_b16 v[46:47], v1 offset:25600
    v_mfma_f32_16x16x32_bf16 v[168:171], v[52:55], v[84:87], v[168:171]
    v_mfma_f32_16x16x32_bf16 v[172:175], v[48:51], v[88:91], v[172:175]
    v_mfma_f32_16x16x32_bf16 v[172:175], v[52:55], v[92:95], v[172:175]
    v_mfma_f32_16x16x32_bf16 v[176:179], v[56:59], v[64:67], v[176:179]
    ds_read_b64_tr_b16 v[48:49], v2 offset:16384
    v_mfma_f32_16x16x32_bf16 v[176:179], v[60:63], v[68:71], v[176:179]
    ds_read_b64_tr_b16 v[50:51], v2 offset:17408
    v_mfma_f32_16x16x32_bf16 v[180:183], v[56:59], v[72:75], v[180:183]
    ds_read_b64_tr_b16 v[52:53], v2 offset:24576
    v_mfma_f32_16x16x32_bf16 v[180:183], v[60:63], v[76:79], v[180:183]
    ds_read_b64_tr_b16 v[54:55], v2 offset:25600
    v_mfma_f32_16x16x32_bf16 v[184:187], v[56:59], v[80:83], v[184:187]
    v_mfma_f32_16x16x32_bf16 v[184:187], v[60:63], v[84:87], v[184:187]
    v_mfma_f32_16x16x32_bf16 v[188:191], v[56:59], v[88:91], v[188:191]
    v_mfma_f32_16x16x32_bf16 v[188:191], v[60:63], v[92:95], v[188:191]
    s_waitcnt lgkmcnt(4)
    v_mfma_f32_16x16x32_bf16 v[192:195], v[40:43], v[64:67], v[192:195]
    ds_read_b64_tr_b16 v[56:57], v3 offset:16384
    v_mfma_f32_16x16x32_bf16 v[192:195], v[44:47], v[68:71], v[192:195]
    ds_read_b64_tr_b16 v[58:59], v3 offset:17408
    v_mfma_f32_16x16x32_bf16 v[196:199], v[40:43], v[72:75], v[196:199]
    ds_read_b64_tr_b16 v[60:61], v3 offset:24576
    v_mfma_f32_16x16x32_bf16 v[196:199], v[44:47], v[76:79], v[196:199]
    ds_read_b64_tr_b16 v[62:63], v3 offset:25600
    v_mfma_f32_16x16x32_bf16 v[200:203], v[40:43], v[80:83], v[200:203]
    v_mfma_f32_16x16x32_bf16 v[200:203], v[44:47], v[84:87], v[200:203]
    s_cmp_lg_u32 s89, 1
    s_cbranch_scc1 L_hs1
    buffer_atomic_add v31, v30, s[60:63], s76 offen sc1
L_hs1:
    v_mfma_f32_16x16x32_bf16 v[204:207], v[40:43], v[88:91], v[204:207]
    v_mfma_f32_16x16x32_bf16 v[204:207], v[44:47], v[92:95], v[204:207]
    s_waitcnt lgkmcnt(4)
    v_mfma_f32_16x16x32_bf16 v[208:211], v[48:51], v[64:67], v[208:211]
    ds_read_b64_tr_b16 v[40:41], v4 offset:16384
    v_mfma_f32_16x16x32_bf16 v[208:211], v[52:55], v[68:71], v[208:211]
    ds_read_b64_tr_b16 v[42:43], v4 offset:17408
    v_mfma_f32_16x16x32_bf16 v[212:215], v[48:51], v[72:75], v[212:215]
    ds_read_b64_tr_b16 v[44:45], v4 offset:24576
    v_mfma_f32_16x16x32_bf16 v[212:215], v[52:55], v[76:79], v[212:215]
    ds_read_b64_tr_b16 v[46:47], v4 offset:25600
    v_mfma_f32_16x16x32_bf16 v[216:219], v[48:51], v[80:83], v[216:219]
    v_mfma_f32_16x16x32_bf16 v[216:219], v[52:55], v[84:87], v[216:219]
    v_mfma_f32_16x16x32_bf16 v[220:223], v[48:51], v[88:91], v[220:223]
    v_mfma_f32_16x16x32_bf16 v[220:223], v[52:55], v[92:95], v[220:223]
    s_waitcnt lgkmcnt(4)
    v_mfma_f32_16x16x32_bf16 v[224:227], v[56:59], v[64:67], v[224:227]
    v_mfma_f32_16x16x32_bf16 v[224:227], v[60:63], v[68:71], v[224:227]
    s_waitcnt lgkmcnt(0)
    s_barrier
    ds_read_b64_tr_b16 v[48:49], v1 offset:32768
    v_mfma_f32_16x16x32_bf16 v[228:231], v[56:59], v[72:75], v[228:231]
    ds_read_b64_tr_b16 v[50:51], v1 offset:33792
    v_mfma_f32_16x16x32_bf16 v[228:231], v[60:63], v[76:79], v[228:231]
    ds_read_b64_tr_b16 v[52:53], v1 offset:40960
    v_mfma_f32_16x16x32_bf16 v[232:235], v[56:59], v[80:83], v[232:235]
    ds_read_b64_tr_b16 v[54:55], v1 offset:41984
    v_mfma_f32_16x16x32_bf16 v[232:235], v[60:63], v[84:87], v[232:235]
    ds_read_b128 v[96:99], v5 offset:16384
    v_mfma_f32_16x16x32_bf16 v[236:239], v[56:59], v[88:91], v[236:239]
    ds_read_b128 v[100:103], v6 offset:16384
    v_mfma_f32_16x16x32_bf16 v[236:239], v[60:63], v[92:95], v[236:239]
    ds_read_b128 v[104:107], v5 offset:18432
    v_mfma_f32_16x16x32_bf16 v[240:243], v[40:43], v[64:67], v[240:243]
    ds_read_b64_tr_b16 v[56:57], v2 offset:32768
    v_mfma_f32_16x16x32_bf16 v[240:243], v[44:47], v[68:71], v[240:243]
    ds_read_b64_tr_b16 v[58:59], v2 offset:33792
    v_mfma_f32_16x16x32_bf16 v[244:247], v[40:43], v[72:75], v[244:247]
    ds_read_b64_tr_b16 v[60:61], v2 offset:40960
    v_mfma_f32_16x16x32_bf16 v[244:247], v[44:47], v[76:79], v[244:247]
    ds_read_b64_tr_b16 v[62:63], v2 offset:41984
    v_mfma_f32_16x16x32_bf16 v[248:251], v[40:43], v[80:83], v[248:251]
    ds_read_b128 v[108:111], v6 offset:18432
    v_mfma_f32_16x16x32_bf16 v[248:251], v[44:47], v[84:87], v[248:251]
    ds_read_b128 v[112:115], v5 offset:20480
    v_mfma_f32_16x16x32_bf16 v[252:255], v[40:43], v[88:91], v[252:255]
    ds_read_b128 v[116:119], v6 offset:20480
    v_mfma_f32_16x16x32_bf16 v[252:255], v[44:47], v[92:95], v[252:255]
    ds_read_b128 v[120:123], v5 offset:22528
    s_waitcnt lgkmcnt(10)
    v_mfma_f32_16x16x32_bf16 v[128:131], v[48:51], v[96:99], v[128:131]
    ds_read_b64_tr_b16 v[40:41], v3 offset:32768
    ds_read_b128 v[124:127], v6 offset:22528
    s_waitcnt lgkmcnt(11)
    v_mfma_f32_16x16x32_bf16 v[128:131], v[52:55], v[100:103], v[128:131]
    ds_read_b64_tr_b16 v[42:43], v3 offset:33792
    s_waitcnt lgkmcnt(11)
    v_mfma_f32_16x16x32_bf16 v[132:135], v[48:51], v[104:107], v[132:135]
    ds_read_b64_tr_b16 v[44:45], v3 offset:40960
    s_waitcnt lgkmcnt(7)
    v_mfma_f32_16x16x32_bf16 v[132:135], v[52:55], v[108:111], v[132:135]
    ds_read_b64_tr_b16 v[46:47], v3 offset:41984
    s_waitcnt lgkmcnt(7)
    v_mfma_f32_16x16x32_bf16 v[136:139], v[48:51], v[112:115], v[136:139]
    s_waitcnt lgkmcnt(6)
    v_mfma_f32_16x16x32_bf16 v[136:139], v[52:55], v[116:119], v[136:139]
    s_cmp_lg_u32 s89, 2
    s_cbranch_scc1 L_hs2
    buffer_atomic_add v31, v30, s[60:63], s76 offen sc1
L_hs2:
    s_waitcnt lgkmcnt(5)
    v_mfma_f32_16x16x32_bf16 v[140:143], v[48:51], v[120:123], v[140:143]
    s_waitcnt lgkmcnt(3)
    v_mfma_f32_16x16x32_bf16 v[140:143], v[52:55], v[124:127], v[140:143]
    v_mfma_f32_16x16x32_bf16 v[144:147], v[56:59], v[96:99], v[144:147]
    ds_read_b64_tr_b16 v[48:49], v4 offset:32768
    v_mfma_f32_16x16x32_bf16 v[144:147], v[60:63], v[100:103], v[144:147]
    ds_read_b64_tr_b16 v[50:51], v4 offset:33792
    v_mfma_f32_16x16x32_bf16 v[148:151], v[56:59], v[104:107], v[148:151]
    ds_read_b64_tr_b16 v[52:53], v4 offset:40960
    v_mfma_f32_16x16x32_bf16 v[148:151], v[60:63], v[108:111], v[148:151]
    ds_read_b64_tr_b16 v[54:55], v4 offset:41984
    v_mfma_f32_16x16x32_bf16 v[152:155], v[56:59], v[112:115], v[152:155]
    v_mfma_f32_16x16x32_bf16 v[152:155], v[60:63], v[116:119], v[152:155]
    v_mfma_f32_16x16x32_bf16 v[156:159], v[56:59], v[120:123], v[156:159]
    v_mfma_f32_16x16x32_bf16 v[156:159], v[60:63], v[124:127], v[156:159]
    s_waitcnt lgkmcnt(4)
    v_mfma_f32_16x16x32_bf16 v[160:163], v[40:43], v[96:99], v[160:163]
    v_mfma_f32_16x16x32_bf16 v[160:163], v[44:47], v[100:103], v[160:163]
    s_waitcnt lgkmcnt(0)
    s_barrier
    ds_read_b64_tr_b16 v[56:57], v1 offset:49152
    v_mfma_f32_16x16x32_bf16 v[164:167], v[40:43], v[104:107], v[164:167]
    ds_read_b64_tr_b16 v[58:59], v1 offset:50176
    v_mfma_f32_16x16x32_bf16 v[164:167], v[44:47], v[108:111], v[164:167]
    ds_read_b64_tr_b16 v[60:61], v1 offset:57344
    v_mfma_f32_16x16x32_bf16 v[168:171], v[40:43], v[112:115], v[168:171]
    ds_read_b64_tr_b16 v[62:63], v1 offset:58368
    v_mfma_f32_16x16x32_bf16 v[168:171], v[44:47], v[116:119], v[168:171]
    v_mfma_f32_16x16x32_bf16 v[172:175], v[40:43], v[120:123], v[172:175]
    v_mfma_f32_16x16x32_bf16 v[172:175], v[44:47], v[124:127], v[172:175]
    v_mfma_f32_16x16x32_bf16 v[176:179], v[48:51], v[96:99], v[176:179]
    ds_read_b64_tr_b16 v[40:41], v2 offset:49152
    v_mfma_f32_16x16x32_bf16 v[176:179], v[52:55], v[100:103], v[176:179]
    ds_read_b64_tr_b16 v[42:43], v2 offset:50176
    v_mfma_f32_16x16x32_bf16 v[180:183], v[48:51], v[104:107], v[180:183]
    ds_read_b64_tr_b16 v[44:45], v2 offset:57344
    v_mfma_f32_16x16x32_bf16 v[180:183], v[52:55], v[108:111], v[180:183]
    ds_read_b64_tr_b16 v[46:47], v2 offset:58368
    v_mfma_f32_16x16x32_bf16 v[184:187], v[48:51], v[112:115], v[184:187]
    v_mfma_f32_16x16x32_bf16 v[184:187], v[52:55], v[116:119], v[184:187]
    v_mfma_f32_16x16x32_bf16 v[188:191], v[48:51], v[120:123], v[188:191]
    v_mfma_f32_16x16x32_bf16 v[188:191], v[52:55], v[124:127], v[188:191]
    s_waitcnt lgkmcnt(4)
    v_mfma_f32_16x16x32_bf16 v[192:195], v[56:59], v[96:99], v[192:195]
    ds_read_b64_tr_b16 v[48:49], v3 offset:49152
    v_mfma_f32_16x16x32_bf16 v[192:195], v[60:63], v[100:103], v[192:195]
    ds_read_b64_tr_b16 v[50:51], v3 offset:50176
    v_mfma_f32_16x16x32_bf16 v[196:199], v[56:59], v[104:107], v[196:199]
    ds_read_b64_tr_b16 v[52:53], v3 offset:57344
    v_mfma_f32_16x16x32_bf16 v[196:199], v[60:63], v[108:111], v[196:199]
    ds_read_b64_tr_b16 v[54:55], v3 offset:58368
    v_mfma_f32_16x16x32_bf16 v[200:203], v[56:59], v[112:115], v[200:203]
    v_mfma_f32_16x16x32_bf16 v[200:203], v[60:63], v[116:119], v[200:203]
    s_cmp_lg_u32 s89, 3
    s_cbranch_scc1 L_hs3
    buffer_atomic_add v31, v30, s[60:63], s76 offen sc1
L_hs3:
    v_mfma_f32_16x16x32_bf16 v[204:207], v[56:59], v[120:123], v[204:207]
    v_mfma_f32_16x16x32_bf16 v[204:207], v[60:63], v[124:127], v[204:207]
    s_waitcnt lgkmcnt(4)
    v_mfma_f32_16x16x32_bf16 v[208:211], v[40:43], v[96:99], v[208:211]
    ds_read_b64_tr_b16 v[56:57], v4 offset:49152
    v_mfma_f32_16x16x32_bf16 v[208:211], v[44:47], v[100:103], v[208:211]
    ds_read_b64_tr_b16 v[58:59], v4 offset:50176
    v_mfma_f32_16x16x32_bf16 v[212:215], v[40:43], v[104:107], v[212:215]
    ds_read_b64_tr_b16 v[60:61], v4 offset:57344
    v_mfma_f32_16x16x32_bf16 v[212:215], v[44:47], v[108:111], v[212:215]
    ds_read_b64_tr_b16 v[62:63], v4 offset:58368
    v_mfma_f32_16x16x32_bf16 v[216:219], v[40:43], v[112:115], v[216:219]
    v_mfma_f32_16x16x32_bf16 v[216:219], v[44:47], v[116:119], v[216:219]
    v_mfma_f32_16x16x32_bf16 v[220:223], v[40:43], v[120:123], v[220:223]
    v_mfma_f32_16x16x32_bf16 v[220:223], v[44:47], v[124:127], v[220:223]
    s_waitcnt lgkmcnt(4)
    v_mfma_f32_16x16x32_bf16 v[224:227], v[48:51], v[96:99], v[224:227]
    v_mfma_f32_16x16x32_bf16 v[224:227], v[52:55], v[100:103], v[224:227]
    s_waitcnt lgkmcnt(0)
    s_barrier
    ds_read_b64_tr_b16 v[40:41], v1 offset:0
    v_mfma_f32_16x16x32_bf16 v[228:231], v[48:51], v[104:107], v[228:231]
    ds_read_b64_tr_b16 v[42:43], v1 offset:1024
    v_mfma_f32_16x16x32_bf16 v[228:231], v[52:55], v[108:111], v[228:231]
    ds_read_b64_tr_b16 v[44:45], v1 offset:8192
    v_mfma_f32_16x16x32_bf16 v[232:235], v[48:51], v[112:115], v[232:235]
    ds_read_b64_tr_b16 v[46:47], v1 offset:9216
    v_mfma_f32_16x16x32_bf16 v[232:235], v[52:55], v[116:119], v[232:235]
    ds_read_b128 v[64:67], v5 offset:0
    v_mfma_f32_16x16x32_bf16 v[236:239], v[48:51], v[120:123], v[236:239]
    ds_read_b128 v[68:71], v6 offset:0
    v_mfma_f32_16x16x32_bf16 v[236:239], v[52:55], v[124:127], v[236:239]
    ds_read_b128 v[72:75], v5 offset:2048
    v_mfma_f32_16x16x32_bf16 v[240:243], v[56:59], v[96:99], v[240:243]
    ds_read_b64_tr_b16 v[48:49], v2 offset:0
    v_mfma_f32_16x16x32_bf16 v[240:243], v[60:63], v[100:103], v[240:243]
    ds_read_b64_tr_b16 v[50:51], v2 offset:1024
    v_mfma_f32_16x16x32_bf16 v[244:247], v[56:59], v[104:107], v[244:247]
    ds_read_b64_tr_b16 v[52:53], v2 offset:8192
    v_mfma_f32_16x16x32_bf16 v[244:247], v[60:63], v[108:111], v[244:247]
    ds_read_b64_tr_b16 v[54:55], v2 offset:9216
    v_mfma_f32_16x16x32_bf16 v[248:251], v[56:59], v[112:115], v[248:251]
    ds_read_b128 v[76:79], v6 offset:2048
    v_mfma_f32_16x16x32_bf16 v[248:251], v[60:63], v[116:119], v[248:251]
    ds_read_b128 v[80:83], v5 offset:4096
    v_mfma_f32_16x16x32_bf16 v[252:255], v[56:59], v[120:123], v[252:255]
    ds_read_b128 v[84:87], v6 offset:4096
    v_mfma_f32_16x16x32_bf16 v[252:255], v[60:63], v[124:127], v[252:255]
    ds_read_b128 v[88:91], v5 offset:6144
    s_waitcnt lgkmcnt(10)
    v_mfma_f32_16x16x32_bf16 v[128:131], v[40:43], v[64:67], v[128:131]
    ds_read_b64_tr_b16 v[56:57], v3 offset:0
    ds_read_b128 v[92:95], v6 offset:6144
    s_waitcnt lgkmcnt(11)
    v_mfma_f32_16x16x32_bf16 v[128:131], v[44:47], v[68:71], v[128:131]
    ds_read_b64_tr_b16 v[58:59], v3 offset:1024
    s_waitcnt lgkmcnt(11)
    v_mfma_f32_16x16x32_bf16 v[132:135], v[40:43], v[72:75], v[132:135]
    ds_read_b64_tr_b16 v[60:61], v3 offset:8192
    s_waitcnt lgkmcnt(7)
    v_mfma_f32_16x16x32_bf16 v[132:135], v[44:47], v[76:79], v[132:135]
    ds_read_b64_tr_b16 v[62:63], v3 offset:9216
    s_waitcnt lgkmcnt(7)
    v_mfma_f32_16x16x32_bf16 v[136:139], v[40:43], v[80:83], v[136:139]
    s_waitcnt lgkmcnt(6)
    v_mfma_f32_16x16x32_bf16 v[136:139], v[44:47], v[84:87], v[136:139]
    s_waitcnt lgkmcnt(5)
    v_mfma_f32_16x16x32_bf16 v[140:143], v[40:43], v[88:91], v[140:143]
    s_waitcnt lgkmcnt(3)
    v_mfma_f32_16x16x32_bf16 v[140:143], v[44:47], v[92:95], v[140:143]
    v_mfma_f32_16x16x32_bf16 v[144:147], v[48:51], v[64:67], v[144:147]
    ds_read_b64_tr_b16 v[40:41], v4 offset:0
    v_mfma_f32_16x16x32_bf16 v[144:147], v[52:55], v[68:71], v[144:147]
    ds_read_b64_tr_b16 v[42:43], v4 offset:1024
    v_mfma_f32_16x16x32_bf16 v[148:151], v[48:51], v[72:75], v[148:151]
    ds_read_b64_tr_b16 v[44:45], v4 offset:8192
    v_mfma_f32_16x16x32_bf16 v[148:151], v[52:55], v[76:79], v[148:151]
    ds_read_b64_tr_b16 v[46:47], v4 offset:9216
    v_mfma_f32_16x16x32_bf16 v[152:155], v[48:51], v[80:83], v[152:155]
    v_mfma_f32_16x16x32_bf16 v[152:155], v[52:55], v[84:87], v[152:155]
    v_mfma_f32_16x16x32_bf16 v[156:159], v[48:51], v[88:91], v[156:159]
    v_mfma_f32_16x16x32_bf16 v[156:159], v[52:55], v[92:95], v[156:159]
    s_waitcnt lgkmcnt(4)
    v_mfma_f32_16x16x32_bf16 v[160:163], v[56:59], v[64:67], v[160:163]
    v_mfma_f32_16x16x32_bf16 v[160:163], v[60:63], v[68:71], v[160:163]
    s_waitcnt lgkmcnt(0)
    s_barrier
    ds_read_b64_tr_b16 v[48:49], v1 offset:16384
    v_mfma_f32_16x16x32_bf16 v[164:167], v[56:59], v[72:75], v[164:167]
    ds_read_b64_tr_b16 v[50:51], v1 offset:17408
    v_mfma_f32_16x16x32_bf16 v[164:167], v[60:63], v[76:79], v[164:167]
    ds_read_b64_tr_b16 v[52:53], v1 offset:24576
    v_mfma_f32_16x16x32_bf16 v[168:171], v[56:59], v[80:83], v[168:171]
    ds_read_b64_tr_b16 v[54:55], v1 offset:25600
    v_mfma_f32_16x16x32_bf16 v[168:171], v[60:63], v[84:87], v[168:171]
    v_mfma_f32_16x16x32_bf16 v[172:175], v[56:59], v[88:91], v[172:175]
    v_mfma_f32_16x16x32_bf16 v[172:175], v[60:63], v[92:95], v[172:175]
    v_mfma_f32_16x16x32_bf16 v[176:179], v[40:43], v[64:67], v[176:179]
    ds_read_b64_tr_b16 v[56:57], v2 offset:16384
    v_mfma_f32_16x16x32_bf16 v[176:179], v[44:47], v[68:71], v[176:179]
    ds_read_b64_tr_b16 v[58:59], v2 offset:17408
    v_mfma_f32_16x16x32_bf16 v[180:183], v[40:43], v[72:75], v[180:183]
    ds_read_b64_tr_b16 v[60:61], v2 offset:24576
    v_mfma_f32_16x16x32_bf16 v[180:183], v[44:47], v[76:79], v[180:183]
    ds_read_b64_tr_b16 v[62:63], v2 offset:25600
    v_mfma_f32_16x16x32_bf16 v[184:187], v[40:43], v[80:83], v[184:187]
    v_mfma_f32_16x16x32_bf16 v[184:187], v[44:47], v[84:87], v[184:187]
    v_mfma_f32_16x16x32_bf16 v[188:191], v[40:43], v[88:91], v[188:191]
    v_mfma_f32_16x16x32_bf16 v[188:191], v[44:47], v[92:95], v[188:191]
    s_waitcnt lgkmcnt(4)
    v_mfma_f32_16x16x32_bf16 v[192:195], v[48:51], v[64:67], v[192:195]
    ds_read_b64_tr_b16 v[40:41], v3 offset:16384
    v_mfma_f32_16x16x32_bf16 v[192:195], v[52:55], v[68:71], v[192:195]
    ds_read_b64_tr_b16 v[42:43], v3 offset:17408
    v_mfma_f32_16x16x32_bf16 v[196:199], v[48:51], v[72:75], v[196:199]
    ds_read_b64_tr_b16 v[44:45], v3 offset:24576
    v_mfma_f32_16x16x32_bf16 v[196:199], v[52:55], v[76:79], v[196:199]
    ds_read_b64_tr_b16 v[46:47], v3 offset:25600
    v_mfma_f32_16x16x32_bf16 v[200:203], v[48:51], v[80:83], v[200:203]
    v_mfma_f32_16x16x32_bf16 v[200:203], v[52:55], v[84:87], v[200:203]
    v_mfma_f32_16x16x32_bf16 v[204:207], v[48:51], v[88:91], v[204:207]
    v_mfma_f32_16x16x32_bf16 v[204:207], v[52:55], v[92:95], v[204:207]
    s_waitcnt lgkmcnt(4)
    v_mfma_f32_16x16x32_bf16 v[208:211], v[56:59], v[64:67], v[208:211]
    ds_read_b64_tr_b16 v[48:49], v4 offset:16384
    v_mfma_f32_16x16x32_bf16 v[208:211], v[60:63], v[68:71], v[208:211]
    ds_read_b64_tr_b16 v[50:51], v4 offset:17408
    v_mfma_f32_16x16x32_bf16 v[212:215], v[56:59], v[72:75], v[212:215]
    ds_read_b64_tr_b16 v[52:53], v4 offset:24576
    v_mfma_f32_16x16x32_bf16 v[212:215], v[60:63], v[76:79], v[212:215]
    ds_read_b64_tr_b16 v[54:55], v4 offset:25600
    v_mfma_f32_16x16x32_bf16 v[216:219], v[56:59], v[80:83], v[216:219]
    v_mfma_f32_16x16x32_bf16 v[216:219], v[60:63], v[84:87], v[216:219]
    v_mfma_f32_16x16x32_bf16 v[220:223], v[56:59], v[88:91], v[220:223]
    v_mfma_f32_16x16x32_bf16 v[220:223], v[60:63], v[92:95], v[220:223]
    s_waitcnt lgkmcnt(4)
    v_mfma_f32_16x16x32_bf16 v[224:227], v[40:43], v[64:67], v[224:227]
    v_mfma_f32_16x16x32_bf16 v[224:227], v[44:47], v[68:71], v[224:227]
    s_waitcnt lgkmcnt(0)
    s_barrier
    ds_read_b64_tr_b16 v[56:57], v1 offset:32768
    v_mfma_f32_16x16x32_bf16 v[228:231], v[40:43], v[72:75], v[228:231]
    ds_read_b64_tr_b16 v[58:59], v1 offset:33792
    v_mfma_f32_16x16x32_bf16 v[228:231], v[44:47], v[76:79], v[228:231]
    ds_read_b64_tr_b16 v[60:61], v1 offset:40960
    v_mfma_f32_16x16x32_bf16 v[232:235], v[40:43], v[80:83], v[232:235]
    ds_read_b64_tr_b16 v[62:63], v1 offset:41984
    v_mfma_f32_16x16x32_bf16 v[232:235], v[44:47], v[84:87], v[232:235]
    ds_read_b128 v[96:99], v5 offset:16384
    v_mfma_f32_16x16x32_bf16 v[236:239], v[40:43], v[88:91], v[236:239]
    ds_read_b128 v[100:103], v6 offset:16384
    v_mfma_f32_16x16x32_bf16 v[236:239], v[44:47], v[92:95], v[236:239]
    ds_read_b128 v[104:107], v5 offset:18432
    v_mfma_f32_16x16x32_bf16 v[240:243], v[48:51], v[64:67], v[240:243]
    ds_read_b64_tr_b16 v[40:41], v2 offset:32768
    v_mfma_f32_16x16x32_bf16 v[240:243], v[52:55], v[68:71], v[240:243]
    ds_read_b64_tr_b16 v[42:43], v2 offset:33792
    v_mfma_f32_16x16x32_bf16 v[244:247], v[48:51], v[72:75], v[244:247]
    ds_read_b64_tr_b16 v[44:45], v2 offset:40960
    v_mfma_f32_16x16x32_bf16 v[244:247], v[52:55], v[76:79], v[244:247]
    ds_read_b64_tr_b16 v[46:47], v2 offset:41984
    v_mfma_f32_16x16x32_bf16 v[248:251], v[48:51], v[80:83], v[248:251]
    ds_read_b128 v[108:111], v6 offset:18432
    v_mfma_f32_16x16x32_bf16 v[248:251], v[52:55], v[84:87], v[248:251]
    ds_read_b128 v[112:115], v5 offset:20480
    v_mfma_f32_16x16x32_bf16 v[252:255], v[48:51], v[88:91], v[252:255]
    ds_read_b128 v[116:119], v6 offset:20480
    v_mfma_f32_16x16x32_bf16 v[252:255], v[52:55], v[92:95], v[252:255]
    ds_read_b128 v[120:123], v5 offset:22528
    s_waitcnt lgkmcnt(10)
    v_mfma_f32_16x16x32_bf16 v[128:131], v[56:59], v[96:99], v[128:131]
    ds_read_b64_tr_b16 v[48:49], v3 offset:32768
    ds_read_b128 v[124:127], v6 offset:22528
    v_lshrrev_b32 v36, 2, v0
    v_bfe_u32 v37, v0, 3, 2
    s_waitcnt lgkmcnt(11)
    v_mfma_f32_16x16x32_bf16 v[128:131], v[60:63], v[100:103], v[128:131]
    ds_read_b64_tr_b16 v[50:51], v3 offset:33792
    v_lshlrev_b32 v37, 5, v37
    s_waitcnt lgkmcnt(11)
    v_mfma_f32_16x16x32_bf16 v[132:135], v[56:59], v[104:107], v[132:135]
    ds_read_b64_tr_b16 v[52:53], v3 offset:40960
    v_and_b32 v38, 3, v0
    s_waitcnt lgkmcnt(7)
    v_mfma_f32_16x16x32_bf16 v[132:135], v[60:63], v[108:111], v[132:135]
    ds_read_b64_tr_b16 v[54:55], v3 offset:41984
    v_lshl_or_b32 v37, v38, 3, v37
    s_waitcnt lgkmcnt(7)
    v_mfma_f32_16x16x32_bf16 v[136:139], v[56:59], v[112:115], v[136:139]
    v_lshl_or_b32 v37, v36, 7, v37
    s_waitcnt lgkmcnt(6)
    v_mfma_f32_16x16x32_bf16 v[136:139], v[60:63], v[116:119], v[136:139]
    v_add_u32 v23, s73, v37
    v_xor_b32 v24, 32, v23
    s_waitcnt lgkmcnt(5)
    v_mfma_f32_16x16x32_bf16 v[140:143], v[56:59], v[120:123], v[140:143]
    v_xor_b32 v25, 64, v23
    s_waitcnt lgkmcnt(3)
    v_mfma_f32_16x16x32_bf16 v[140:143], v[60:63], v[124:127], v[140:143]
    v_xor_b32 v26, 0x60, v23
    v_mfma_f32_16x16x32_bf16 v[144:147], v[40:43], v[96:99], v[144:147]
    ds_read_b64_tr_b16 v[56:57], v4 offset:32768
    v_mul_u32_u24 v36, 320, v36
    v_mfma_f32_16x16x32_bf16 v[144:147], v[44:47], v[100:103], v[144:147]
    ds_read_b64_tr_b16 v[58:59], v4 offset:33792
    v_lshl_add_u32 v36, v38, 3, v36
    v_mfma_f32_16x16x32_bf16 v[148:151], v[40:43], v[104:107], v[148:151]
    ds_read_b64_tr_b16 v[60:61], v4 offset:40960
    v_add_u32 v36, 65536, v36
    v_bfe_u32 v38, v0, 4, 1
    v_mfma_f32_16x16x32_bf16 v[148:151], v[44:47], v[108:111], v[148:151]
    ds_read_b64_tr_b16 v[62:63], v4 offset:41984
    v_lshlrev_b32 v38, 5, v38
    v_mfma_f32_16x16x32_bf16 v[152:155], v[40:43], v[112:115], v[152:155]
    v_add_u32 v19, v36, v38
    v_mfma_f32_16x16x32_bf16 v[152:155], v[44:47], v[116:119], v[152:155]
    v_sub_u32 v20, v36, v38
    v_mfma_f32_16x16x32_bf16 v[156:159], v[40:43], v[120:123], v[156:159]
    v_add_u32 v21, 61440, v19
    v_mfma_f32_16x16x32_bf16 v[156:159], v[44:47], v[124:127], v[156:159]
    v_add_u32 v22, 61440, v20
    s_waitcnt lgkmcnt(4)
    v_mfma_f32_16x16x32_bf16 v[160:163], v[48:51], v[96:99], v[160:163]
    v_mfma_f32_16x16x32_bf16 v[160:163], v[52:55], v[100:103], v[160:163]
    s_waitcnt lgkmcnt(0)
    s_barrier
    ds_read_b64_tr_b16 v[40:41], v1 offset:49152
    v_mfma_f32_16x16x32_bf16 v[164:167], v[48:51], v[104:107], v[164:167]
    ds_read_b64_tr_b16 v[42:43], v1 offset:50176
    v_mfma_f32_16x16x32_bf16 v[164:167], v[52:55], v[108:111], v[164:167]
    ds_read_b64_tr_b16 v[44:45], v1 offset:57344
    v_mfma_f32_16x16x32_bf16 v[168:171], v[48:51], v[112:115], v[168:171]
    ds_read_b64_tr_b16 v[46:47], v1 offset:58368
    v_mfma_f32_16x16x32_bf16 v[168:171], v[52:55], v[116:119], v[168:171]
    v_mfma_f32_16x16x32_bf16 v[172:175], v[48:51], v[120:123], v[172:175]
    v_mfma_f32_16x16x32_bf16 v[172:175], v[52:55], v[124:127], v[172:175]
    v_mfma_f32_16x16x32_bf16 v[176:179], v[56:59], v[96:99], v[176:179]
    ds_read_b64_tr_b16 v[48:49], v2 offset:49152
    v_mfma_f32_16x16x32_bf16 v[176:179], v[60:63], v[100:103], v[176:179]
    ds_read_b64_tr_b16 v[50:51], v2 offset:50176
    v_mfma_f32_16x16x32_bf16 v[180:183], v[56:59], v[104:107], v[180:183]
    ds_read_b64_tr_b16 v[52:53], v2 offset:57344
    v_mfma_f32_16x16x32_bf16 v[180:183], v[60:63], v[108:111], v[180:183]
    ds_read_b64_tr_b16 v[54:55], v2 offset:58368
    v_mfma_f32_16x16x32_bf16 v[184:187], v[56:59], v[112:115], v[184:187]
    v_mfma_f32_16x16x32_bf16 v[184:187], v[60:63], v[116:119], v[184:187]
    v_mfma_f32_16x16x32_bf16 v[188:191], v[56:59], v[120:123], v[188:191]
    v_mfma_f32_16x16x32_bf16 v[188:191], v[60:63], v[124:127], v[188:191]
    s_waitcnt lgkmcnt(4)
    v_mfma_f32_16x16x32_bf16 v[192:195], v[40:43], v[96:99], v[192:195]
    ds_read_b64_tr_b16 v[56:57], v3 offset:49152
    v_mfma_f32_16x16x32_bf16 v[192:195], v[44:47], v[100:103], v[192:195]
    ds_read_b64_tr_b16 v[58:59], v3 offset:50176
    v_mfma_f32_16x16x32_bf16 v[196:199], v[40:43], v[104:107], v[196:199]
    ds_read_b64_tr_b16 v[60:61], v3 offset:57344
    v_mfma_f32_16x16x32_bf16 v[196:199], v[44:47], v[108:111], v[196:199]
    ds_read_b64_tr_b16 v[62:63], v3 offset:58368
    v_mfma_f32_16x16x32_bf16 v[200:203], v[40:43], v[112:115], v[200:203]
    v_mfma_f32_16x16x32_bf16 v[200:203], v[44:47], v[116:119], v[200:203]
    v_mfma_f32_16x16x32_bf16 v[204:207], v[40:43], v[120:123], v[204:207]
    v_mfma_f32_16x16x32_bf16 v[204:207], v[44:47], v[124:127], v[204:207]
    s_waitcnt lgkmcnt(4)
    v_mfma_f32_16x16x32_bf16 v[208:211], v[48:51], v[96:99], v[208:211]
    ds_read_b64_tr_b16 v[40:41], v4 offset:49152
    v_mfma_f32_16x16x32_bf16 v[208:211], v[52:55], v[100:103], v[208:211]
    ds_read_b64_tr_b16 v[42:43], v4 offset:50176
    v_mfma_f32_16x16x32_bf16 v[212:215], v[48:51], v[104:107], v[212:215]
    ds_read_b64_tr_b16 v[44:45], v4 offset:57344
    v_mfma_f32_16x16x32_bf16 v[212:215], v[52:55], v[108:111], v[212:215]
    ds_read_b64_tr_b16 v[46:47], v4 offset:58368
    v_mfma_f32_16x16x32_bf16 v[216:219], v[48:51], v[112:115], v[216:219]
    v_mfma_f32_16x16x32_bf16 v[216:219], v[52:55], v[116:119], v[216:219]
    v_mfma_f32_16x16x32_bf16 v[220:223], v[48:51], v[120:123], v[220:223]
    v_mfma_f32_16x16x32_bf16 v[220:223], v[52:55], v[124:127], v[220:223]
    s_waitcnt lgkmcnt(4)
    v_mfma_f32_16x16x32_bf16 v[224:227], v[56:59], v[96:99], v[224:227]
    v_mfma_f32_16x16x32_bf16 v[224:227], v[60:63], v[100:103], v[224:227]
    s_waitcnt lgkmcnt(0)
    s_barrier
    ds_read_b64_tr_b16 v[48:49], v1 offset:0
    v_mfma_f32_16x16x32_bf16 v[228:231], v[56:59], v[104:107], v[228:231]
    ds_read_b64_tr_b16 v[50:51], v1 offset:1024
    v_mfma_f32_16x16x32_bf16 v[228:231], v[60:63], v[108:111], v[228:231]
    ds_read_b64_tr_b16 v[52:53], v1 offset:8192
    v_mfma_f32_16x16x32_bf16 v[232:235], v[56:59], v[112:115], v[232:235]
    ds_read_b64_tr_b16 v[54:55], v1 offset:9216
    v_mfma_f32_16x16x32_bf16 v[232:235], v[60:63], v[116:119], v[232:235]
    ds_read_b128 v[64:67], v5 offset:0
    v_mfma_f32_16x16x32_bf16 v[236:239], v[56:59], v[120:123], v[236:239]
    ds_read_b128 v[68:71], v6 offset:0
    v_mfma_f32_16x16x32_bf16 v[236:239], v[60:63], v[124:127], v[236:239]
    ds_read_b128 v[72:75], v5 offset:2048
    v_mfma_f32_16x16x32_bf16 v[240:243], v[40:43], v[96:99], v[240:243]
    ds_read_b64_tr_b16 v[56:57], v2 offset:0
    v_mfma_f32_16x16x32_bf16 v[240:243], v[44:47], v[100:103], v[240:243]
    ds_read_b64_tr_b16 v[58:59], v2 offset:1024
    v_mfma_f32_16x16x32_bf16 v[244:247], v[40:43], v[104:107], v[244:247]
    ds_read_b64_tr_b16 v[60:61], v2 offset:8192
    v_mfma_f32_16x16x32_bf16 v[244:247], v[44:47], v[108:111], v[244:247]
    ds_read_b64_tr_b16 v[62:63], v2 offset:9216
    v_mfma_f32_16x16x32_bf16 v[248:251], v[40:43], v[112:115], v[248:251]
    ds_read_b128 v[76:79], v6 offset:2048
    v_mfma_f32_16x16x32_bf16 v[248:251], v[44:47], v[116:119], v[248:251]
    ds_read_b128 v[80:83], v5 offset:4096
    v_mfma_f32_16x16x32_bf16 v[252:255], v[40:43], v[120:123], v[252:255]
    ds_read_b128 v[84:87], v6 offset:4096
    v_mfma_f32_16x16x32_bf16 v[252:255], v[44:47], v[124:127], v[252:255]
    ds_read_b128 v[88:91], v5 offset:6144
    s_waitcnt lgkmcnt(10)
    v_mfma_f32_16x16x32_bf16 v[128:131], v[48:51], v[64:67], v[128:131]
    ds_read_b64_tr_b16 v[40:41], v3 offset:0
    ds_read_b128 v[92:95], v6 offset:6144
    s_waitcnt lgkmcnt(11)
    v_mfma_f32_16x16x32_bf16 v[128:131], v[52:55], v[68:71], v[128:131]
    ds_read_b64_tr_b16 v[42:43], v3 offset:1024
    s_waitcnt lgkmcnt(11)
    v_mfma_f32_16x16x32_bf16 v[132:135], v[48:51], v[72:75], v[132:135]
    ds_read_b64_tr_b16 v[44:45], v3 offset:8192
    s_waitcnt lgkmcnt(7)
    v_mfma_f32_16x16x32_bf16 v[132:135], v[52:55], v[76:79], v[132:135]
    ds_read_b64_tr_b16 v[46:47], v3 offset:9216
    s_waitcnt lgkmcnt(7)
    v_mfma_f32_16x16x32_bf16 v[136:139], v[48:51], v[80:83], v[136:139]
    s_waitcnt lgkmcnt(6)
    v_mfma_f32_16x16x32_bf16 v[136:139], v[52:55], v[84:87], v[136:139]
    s_cmp_lg_u32 s3, 0
    s_cbranch_scc1 L_hsl
    buffer_load_dword v35, v30, s[60:63], s76 offen sc1
L_hsl:
    s_waitcnt lgkmcnt(5)
    v_mfma_f32_16x16x32_bf16 v[140:143], v[48:51], v[88:91], v[140:143]
    s_waitcnt lgkmcnt(3)
    v_mfma_f32_16x16x32_bf16 v[140:143], v[52:55], v[92:95], v[140:143]
    v_mfma_f32_16x16x32_bf16 v[144:147], v[56:59], v[64:67], v[144:147]
    ds_read_b64_tr_b16 v[48:49], v4 offset:0
    v_mfma_f32_16x16x32_bf16 v[144:147], v[60:63], v[68:71], v[144:147]
    ds_read_b64_tr_b16 v[50:51], v4 offset:1024
    v_mfma_f32_16x16x32_bf16 v[148:151], v[56:59], v[72:75], v[148:151]
    ds_read_b64_tr_b16 v[52:53], v4 offset:8192
    v_mfma_f32_16x16x32_bf16 v[148:151], v[60:63], v[76:79], v[148:151]
    ds_read_b64_tr_b16 v[54:55], v4 offset:9216
    v_mfma_f32_16x16x32_bf16 v[152:155], v[56:59], v[80:83], v[152:155]
    v_mfma_f32_16x16x32_bf16 v[152:155], v[60:63], v[84:87], v[152:155]
    v_mfma_f32_16x16x32_bf16 v[156:159], v[56:59], v[88:91], v[156:159]
    v_mfma_f32_16x16x32_bf16 v[156:159], v[60:63], v[92:95], v[156:159]
    s_waitcnt lgkmcnt(4)
    v_mfma_f32_16x16x32_bf16 v[160:163], v[40:43], v[64:67], v[160:163]
    v_mfma_f32_16x16x32_bf16 v[160:163], v[44:47], v[68:71], v[160:163]
    s_waitcnt lgkmcnt(0)
    s_barrier
    ds_read_b64_tr_b16 v[56:57], v1 offset:16384
    v_mfma_f32_16x16x32_bf16 v[164:167], v[40:43], v[72:75], v[164:167]
    ds_read_b64_tr_b16 v[58:59], v1 offset:17408
    v_mfma_f32_16x16x32_bf16 v[164:167], v[44:47], v[76:79], v[164:167]
    ds_read_b64_tr_b16 v[60:61], v1 offset:24576
    v_mfma_f32_16x16x32_bf16 v[168:171], v[40:43], v[80:83], v[168:171]
    ds_read_b64_tr_b16 v[62:63], v1 offset:25600
    v_mfma_f32_16x16x32_bf16 v[168:171], v[44:47], v[84:87], v[168:171]
    v_mfma_f32_16x16x32_bf16 v[172:175], v[40:43], v[88:91], v[172:175]
    v_mfma_f32_16x16x32_bf16 v[172:175], v[44:47], v[92:95], v[172:175]
    v_mfma_f32_16x16x32_bf16 v[176:179], v[48:51], v[64:67], v[176:179]
    ds_read_b64_tr_b16 v[40:41], v2 offset:16384
    v_mfma_f32_16x16x32_bf16 v[176:179], v[52:55], v[68:71], v[176:179]
    ds_read_b64_tr_b16 v[42:43], v2 offset:17408
    v_mfma_f32_16x16x32_bf16 v[180:183], v[48:51], v[72:75], v[180:183]
    ds_read_b64_tr_b16 v[44:45], v2 offset:24576
    v_mfma_f32_16x16x32_bf16 v[180:183], v[52:55], v[76:79], v[180:183]
    ds_read_b64_tr_b16 v[46:47], v2 offset:25600
    v_mfma_f32_16x16x32_bf16 v[184:187], v[48:51], v[80:83], v[184:187]
    v_mfma_f32_16x16x32_bf16 v[184:187], v[52:55], v[84:87], v[184:187]
    v_mfma_f32_16x16x32_bf16 v[188:191], v[48:51], v[88:91], v[188:191]
    v_mfma_f32_16x16x32_bf16 v[188:191], v[52:55], v[92:95], v[188:191]
    s_waitcnt lgkmcnt(4)
    v_mfma_f32_16x16x32_bf16 v[192:195], v[56:59], v[64:67], v[192:195]
    ds_read_b64_tr_b16 v[48:49], v3 offset:16384
    v_mfma_f32_16x16x32_bf16 v[192:195], v[60:63], v[68:71], v[192:195]
    ds_read_b64_tr_b16 v[50:51], v3 offset:17408
    v_mfma_f32_16x16x32_bf16 v[196:199], v[56:59], v[72:75], v[196:199]
    ds_read_b64_tr_b16 v[52:53], v3 offset:24576
    v_mfma_f32_16x16x32_bf16 v[196:199], v[60:63], v[76:79], v[196:199]
    ds_read_b64_tr_b16 v[54:55], v3 offset:25600
    v_mfma_f32_16x16x32_bf16 v[200:203], v[56:59], v[80:83], v[200:203]
    v_mfma_f32_16x16x32_bf16 v[200:203], v[60:63], v[84:87], v[200:203]
    v_mfma_f32_16x16x32_bf16 v[204:207], v[56:59], v[88:91], v[204:207]
    v_mfma_f32_16x16x32_bf16 v[204:207], v[60:63], v[92:95], v[204:207]
    s_waitcnt lgkmcnt(4)
    v_mfma_f32_16x16x32_bf16 v[208:211], v[40:43], v[64:67], v[208:211]
    ds_read_b64_tr_b16 v[56:57], v4 offset:16384
    v_mfma_f32_16x16x32_bf16 v[208:211], v[44:47], v[68:71], v[208:211]
    ds_read_b64_tr_b16 v[58:59], v4 offset:17408
    v_mfma_f32_16x16x32_bf16 v[212:215], v[40:43], v[72:75], v[212:215]
    ds_read_b64_tr_b16 v[60:61], v4 offset:24576
    v_mfma_f32_16x16x32_bf16 v[212:215], v[44:47], v[76:79], v[212:215]
    ds_read_b64_tr_b16 v[62:63], v4 offset:25600
    v_mfma_f32_16x16x32_bf16 v[216:219], v[40:43], v[80:83], v[216:219]
    v_mfma_f32_16x16x32_bf16 v[216:219], v[44:47], v[84:87], v[216:219]
    v_mfma_f32_16x16x32_bf16 v[220:223], v[40:43], v[88:91], v[220:223]
    v_mfma_f32_16x16x32_bf16 v[220:223], v[44:47], v[92:95], v[220:223]
    s_waitcnt lgkmcnt(4)
    v_mfma_f32_16x16x32_bf16 v[224:227], v[48:51], v[64:67], v[224:227]
    v_mfma_f32_16x16x32_bf16 v[224:227], v[52:55], v[68:71], v[224:227]
    s_waitcnt lgkmcnt(0)
    s_barrier
    ds_read_b64_tr_b16 v[40:41], v1 offset:32768
    v_mfma_f32_16x16x32_bf16 v[228:231], v[48:51], v[72:75], v[228:231]
    ds_read_b64_tr_b16 v[42:43], v1 offset:33792
    v_mfma_f32_16x16x32_bf16 v[228:231], v[52:55], v[76:79], v[228:231]
    ds_read_b64_tr_b16 v[44:45], v1 offset:40960
    v_mfma_f32_16x16x32_bf16 v[232:235], v[48:51], v[80:83], v[232:235]
    ds_read_b64_tr_b16 v[46:47], v1 offset:41984
    v_mfma_f32_16x16x32_bf16 v[232:235], v[52:55], v[84:87], v[232:235]
    ds_read_b128 v[96:99], v5 offset:16384
    v_mfma_f32_16x16x32_bf16 v[236:239], v[48:51], v[88:91], v[236:239]
    ds_read_b128 v[100:103], v6 offset:16384
    v_mfma_f32_16x16x32_bf16 v[236:239], v[52:55], v[92:95], v[236:239]
    ds_read_b128 v[104:107], v5 offset:18432
    v_mfma_f32_16x16x32_bf16 v[240:243], v[56:59], v[64:67], v[240:243]
    ds_read_b64_tr_b16 v[48:49], v2 offset:32768
    v_mfma_f32_16x16x32_bf16 v[240:243], v[60:63], v[68:71], v[240:243]
    ds_read_b64_tr_b16 v[50:51], v2 offset:33792
    v_mfma_f32_16x16x32_bf16 v[244:247], v[56:59], v[72:75], v[244:247]
    ds_read_b64_tr_b16 v[52:53], v2 offset:40960
    v_mfma_f32_16x16x32_bf16 v[244:247], v[60:63], v[76:79], v[244:247]
    ds_read_b64_tr_b16 v[54:55], v2 offset:41984
    v_mfma_f32_16x16x32_bf16 v[248:251], v[56:59], v[80:83], v[248:251]
    ds_read_b128 v[108:111], v6 offset:18432
    v_mfma_f32_16x16x32_bf16 v[248:251], v[60:63], v[84:87], v[248:251]
    ds_read_b128 v[112:115], v5 offset:20480
    v_mfma_f32_16x16x32_bf16 v[252:255], v[56:59], v[88:91], v[252:255]
    ds_read_b128 v[116:119], v6 offset:20480
    v_mfma_f32_16x16x32_bf16 v[252:255], v[60:63], v[92:95], v[252:255]
    ds_read_b128 v[120:123], v5 offset:22528
    s_waitcnt lgkmcnt(10)
    v_mfma_f32_16x16x32_bf16 v[128:131], v[40:43], v[96:99], v[128:131]
    ds_read_b64_tr_b16 v[56:57], v3 offset:32768
    ds_read_b128 v[124:127], v6 offset:22528
    s_waitcnt lgkmcnt(11)
    v_mfma_f32_16x16x32_bf16 v[128:131], v[44:47], v[100:103], v[128:131]
    ds_read_b64_tr_b16 v[58:59], v3 offset:33792
    s_waitcnt lgkmcnt(11)
    v_mfma_f32_16x16x32_bf16 v[132:135], v[40:43], v[104:107], v[132:135]
    ds_read_b64_tr_b16 v[60:61], v3 offset:40960
    s_waitcnt lgkmcnt(7)
    v_mfma_f32_16x16x32_bf16 v[132:135], v[44:47], v[108:111], v[132:135]
    ds_read_b64_tr_b16 v[62:63], v3 offset:41984
    s_waitcnt lgkmcnt(7)
    v_mfma_f32_16x16x32_bf16 v[136:139], v[40:43], v[112:115], v[136:139]
    ds_read_b64 v[64:65], v7 offset:0
    ds_read_b64 v[66:67], v8 offset:0
    s_waitcnt lgkmcnt(8)
    v_mfma_f32_16x16x32_bf16 v[136:139], v[44:47], v[116:119], v[136:139]
    ds_read_b64 v[80:81], v7 offset:4096
    s_waitcnt lgkmcnt(8)
    v_mfma_f32_16x16x32_bf16 v[140:143], v[40:43], v[120:123], v[140:143]
    ds_read_b64 v[82:83], v8 offset:4096
    s_waitcnt lgkmcnt(7)
    v_mfma_f32_16x16x32_bf16 v[140:143], v[44:47], v[124:127], v[140:143]
    ds_read_b64 v[68:69], v9 offset:0
    ds_read_b64 v[70:71], v10 offset:0
    v_mfma_f32_16x16x32_bf16 v[144:147], v[48:51], v[96:99], v[144:147]
    ds_read_b64_tr_b16 v[40:41], v4 offset:32768
    ds_read_b64 v[84:85], v9 offset:4096
    v_mfma_f32_16x16x32_bf16 v[144:147], v[52:55], v[100:103], v[144:147]
    ds_read_b64_tr_b16 v[42:43], v4 offset:33792
    ds_read_b64 v[86:87], v10 offset:4096
    v_mfma_f32_16x16x32_bf16 v[148:151], v[48:51], v[104:107], v[148:151]
    ds_read_b64_tr_b16 v[44:45], v4 offset:40960
    ds_read_b64 v[72:73], v11 offset:0
    ds_read_b64 v[74:75], v12 offset:0
    v_mfma_f32_16x16x32_bf16 v[148:151], v[52:55], v[108:111], v[148:151]
    ds_read_b64_tr_b16 v[46:47], v4 offset:41984
    ds_read_b64 v[88:89], v11 offset:4096
    v_mfma_f32_16x16x32_bf16 v[152:155], v[48:51], v[112:115], v[152:155]
    ds_read_b64 v[90:91], v12 offset:4096
    v_mfma_f32_16x16x32_bf16 v[152:155], v[52:55], v[116:119], v[152:155]
    ds_read_b64 v[76:77], v13 offset:0
    ds_read_b64 v[78:79], v14 offset:0
    v_mfma_f32_16x16x32_bf16 v[156:159], v[48:51], v[120:123], v[156:159]
    ds_read_b64 v[92:93], v13 offset:4096
    v_mfma_f32_16x16x32_bf16 v[156:159], v[52:55], v[124:127], v[156:159]
    ds_read_b64 v[94:95], v14 offset:4096
    s_waitcnt lgkmcnt(15)
    v_mfma_f32_16x16x32_bf16 v[160:163], v[56:59], v[96:99], v[160:163]
    v_mfma_f32_16x16x32_bf16 v[160:163], v[60:63], v[100:103], v[160:163]
    s_waitcnt lgkmcnt(0)
    s_barrier
    ds_read_b64_tr_b16 v[48:49], v1 offset:49152
    v_mfma_f32_16x16x32_bf16 v[164:167], v[56:59], v[104:107], v[164:167]
    ds_read_b64_tr_b16 v[50:51], v1 offset:50176
    v_mfma_f32_16x16x32_bf16 v[164:167], v[60:63], v[108:111], v[164:167]
    ds_read_b64_tr_b16 v[52:53], v1 offset:57344
    v_mfma_f32_16x16x32_bf16 v[168:171], v[56:59], v[112:115], v[168:171]
    ds_read_b64_tr_b16 v[54:55], v1 offset:58368
    v_cvt_pk_bf16_f32 v128, v128, v129
    v_cvt_pk_bf16_f32 v129, v130, v131
    v_mfma_f32_16x16x32_bf16 v[168:171], v[60:63], v[116:119], v[168:171]
    v_cvt_pk_bf16_f32 v130, v144, v145
    v_mfma_f32_16x16x32_bf16 v[172:175], v[56:59], v[120:123], v[172:175]
    v_cvt_pk_bf16_f32 v131, v146, v147
    v_mfma_f32_16x16x32_bf16 v[172:175], v[60:63], v[124:127], v[172:175]
    v_cvt_pk_bf16_f32 v132, v132, v133
    v_cvt_pk_bf16_f32 v133, v134, v135
    v_mfma_f32_16x16x32_bf16 v[176:179], v[40:43], v[96:99], v[176:179]
    ds_read_b64_tr_b16 v[56:57], v2 offset:49152
    v_cvt_pk_bf16_f32 v134, v148, v149
    v_mfma_f32_16x16x32_bf16 v[176:179], v[44:47], v[100:103], v[176:179]
    ds_read_b64_tr_b16 v[58:59], v2 offset:50176
    v_cvt_pk_bf16_f32 v135, v150, v151
    v_mfma_f32_16x16x32_bf16 v[180:183], v[40:43], v[104:107], v[180:183]
    ds_read_b64_tr_b16 v[60:61], v2 offset:57344
    v_cvt_pk_bf16_f32 v136, v136, v137
    v_cvt_pk_bf16_f32 v137, v138, v139
    v_mfma_f32_16x16x32_bf16 v[180:183], v[44:47], v[108:111], v[180:183]
    ds_read_b64_tr_b16 v[62:63], v2 offset:58368
    v_cvt_pk_bf16_f32 v138, v152, v153
    v_mfma_f32_16x16x32_bf16 v[184:187], v[40:43], v[112:115], v[184:187]
    v_cvt_pk_bf16_f32 v139, v154, v155
    v_mfma_f32_16x16x32_bf16 v[184:187], v[44:47], v[116:119], v[184:187]
    v_cvt_pk_bf16_f32 v140, v140, v141
    v_cvt_pk_bf16_f32 v141, v142, v143
    v_mfma_f32_16x16x32_bf16 v[188:191], v[40:43], v[120:123], v[188:191]
    v_cvt_pk_bf16_f32 v142, v156, v157
    v_mfma_f32_16x16x32_bf16 v[188:191], v[44:47], v[124:127], v[188:191]
    v_cvt_pk_bf16_f32 v143, v158, v159
    s_waitcnt lgkmcnt(4)
    v_mfma_f32_16x16x32_bf16 v[192:195], v[48:51], v[96:99], v[192:195]
    ds_read_b64_tr_b16 v[40:41], v3 offset:49152
    v_mfma_f32_16x16x32_bf16 v[192:195], v[52:55], v[100:103], v[192:195]
    ds_read_b64_tr_b16 v[42:43], v3 offset:50176
    v_mfma_f32_16x16x32_bf16 v[196:199], v[48:51], v[104:107], v[196:199]
    ds_read_b64_tr_b16 v[44:45], v3 offset:57344
    v_mfma_f32_16x16x32_bf16 v[196:199], v[52:55], v[108:111], v[196:199]
    ds_read_b64_tr_b16 v[46:47], v3 offset:58368
    v_mfma_f32_16x16x32_bf16 v[200:203], v[48:51], v[112:115], v[200:203]
    v_cvt_pk_bf16_f32 v160, v160, v161
    v_cvt_pk_bf16_f32 v161, v162, v163
    v_mfma_f32_16x16x32_bf16 v[200:203], v[52:55], v[116:119], v[200:203]
    v_cvt_pk_bf16_f32 v162, v176, v177
    v_mfma_f32_16x16x32_bf16 v[204:207], v[48:51], v[120:123], v[204:207]
    v_cvt_pk_bf16_f32 v163, v178, v179
    v_mfma_f32_16x16x32_bf16 v[204:207], v[52:55], v[124:127], v[204:207]
    v_cvt_pk_bf16_f32 v164, v164, v165
    s_waitcnt lgkmcnt(4)
    v_mfma_f32_16x16x32_bf16 v[208:211], v[56:59], v[96:99], v[208:211]
    ds_read_b64_tr_b16 v[48:49], v4 offset:49152
    v_cvt_pk_bf16_f32 v165, v166, v167
    v_cvt_pk_bf16_f32 v166, v180, v181
    v_mfma_f32_16x16x32_bf16 v[208:211], v[60:63], v[100:103], v[208:211]
    ds_read_b64_tr_b16 v[50:51], v4 offset:50176
    v_cvt_pk_bf16_f32 v167, v182, v183
    v_mfma_f32_16x16x32_bf16 v[212:215], v[56:59], v[104:107], v[212:215]
    ds_read_b64_tr_b16 v[52:53], v4 offset:57344
    v_cvt_pk_bf16_f32 v168, v168, v169
    v_mfma_f32_16x16x32_bf16 v[212:215], v[60:63], v[108:111], v[212:215]
    ds_read_b64_tr_b16 v[54:55], v4 offset:58368
    v_cvt_pk_bf16_f32 v169, v170, v171
    v_mfma_f32_16x16x32_bf16 v[216:219], v[56:59], v[112:115], v[216:219]
    v_cvt_pk_bf16_f32 v170, v184, v185
    v_cvt_pk_bf16_f32 v171, v186, v187
    v_mfma_f32_16x16x32_bf16 v[216:219], v[60:63], v[116:119], v[216:219]
    v_cvt_pk_bf16_f32 v172, v172, v173
    v_mfma_f32_16x16x32_bf16 v[220:223], v[56:59], v[120:123], v[220:223]
    v_cvt_pk_bf16_f32 v173, v174, v175
    v_mfma_f32_16x16x32_bf16 v[220:223], v[60:63], v[124:127], v[220:223]
    v_cvt_pk_bf16_f32 v174, v188, v189
    s_waitcnt lgkmcnt(4)
    v_mfma_f32_16x16x32_bf16 v[224:227], v[40:43], v[96:99], v[224:227]
    v_cvt_pk_bf16_f32 v175, v190, v191
    v_mfma_f32_16x16x32_bf16 v[224:227], v[44:47], v[100:103], v[224:227]
    s_cmp_lg_u32 s3, 0
    s_cbranch_scc1 L_hsc
    s_waitcnt vmcnt(0)
    v_readfirstlane_b32 s78, v35
    s_nop 1
    s_cmp_lt_u32 s78, 16
    s_cbranch_scc1 L_hs_spin
L_hsc:
    s_waitcnt lgkmcnt(0)
    s_barrier
    v_mfma_f32_16x16x32_bf16 v[228:231], v[40:43], v[104:107], v[228:231]
    v_mfma_f32_16x16x32_bf16 v[228:231], v[44:47], v[108:111], v[228:231]
    v_mfma_f32_16x16x32_bf16 v[232:235], v[40:43], v[112:115], v[232:235]
    v_cvt_pk_bf16_f32 v192, v192, v193
    v_cvt_pk_bf16_f32 v193, v194, v195
    v_mfma_f32_16x16x32_bf16 v[232:235], v[44:47], v[116:119], v[232:235]
    v_cvt_pk_bf16_f32 v194, v208, v209
    v_mfma_f32_16x16x32_bf16 v[236:239], v[40:43], v[120:123], v[236:239]
    v_cvt_pk_bf16_f32 v195, v210, v211
    v_mfma_f32_16x16x32_bf16 v[236:239], v[44:47], v[124:127], v[236:239]
    v_cvt_pk_bf16_f32 v196, v196, v197
    v_cvt_pk_bf16_f32 v197, v198, v199
    v_mfma_f32_16x16x32_bf16 v[240:243], v[48:51], v[96:99], v[240:243]
    v_cvt_pk_bf16_f32 v198, v212, v213
    v_mfma_f32_16x16x32_bf16 v[240:243], v[52:55], v[100:103], v[240:243]
    v_cvt_pk_bf16_f32 v199, v214, v215
    v_mfma_f32_16x16x32_bf16 v[244:247], v[48:51], v[104:107], v[244:247]
    v_cvt_pk_bf16_f32 v200, v200, v201
    v_cvt_pk_bf16_f32 v201, v202, v203
    v_mfma_f32_16x16x32_bf16 v[244:247], v[52:55], v[108:111], v[244:247]
    v_cvt_pk_bf16_f32 v202, v216, v217
    v_mfma_f32_16x16x32_bf16 v[248:251], v[48:51], v[112:115], v[248:251]
    v_cvt_pk_bf16_f32 v203, v218, v219
    v_mfma_f32_16x16x32_bf16 v[248:251], v[52:55], v[116:119], v[248:251]
    v_cvt_pk_bf16_f32 v204, v204, v205
    v_cvt_pk_bf16_f32 v205, v206, v207
    v_mfma_f32_16x16x32_bf16 v[252:255], v[48:51], v[120:123], v[252:255]
    v_cvt_pk_bf16_f32 v206, v220, v221
    v_mfma_f32_16x16x32_bf16 v[252:255], v[52:55], v[124:127], v[252:255]
    v_cvt_pk_bf16_f32 v207, v222, v223
    v_mfma_f32_16x16x32_bf16 v[144:147], v[64:67], v[128:131], 0
    ds_read_b64 v[96:97], v7 offset:8192
    ds_read_b64 v[98:99], v8 offset:8192
    ds_read_b64 v[112:113], v7 offset:12288
    v_mfma_f32_16x16x32_bf16 v[152:155], v[64:67], v[132:135], 0
    ds_read_b64 v[114:115], v8 offset:12288
    ds_read_b64 v[100:101], v9 offset:8192
    ds_read_b64 v[102:103], v10 offset:8192
    v_cvt_pk_bf16_f32 v224, v224, v225
    v_cvt_pk_bf16_f32 v225, v226, v227
    v_mfma_f32_16x16x32_bf16 v[148:151], v[80:83], v[128:131], 0
    ds_read_b64 v[116:117], v9 offset:12288
    ds_read_b64 v[118:119], v10 offset:12288
    v_cvt_pk_bf16_f32 v226, v240, v241
    v_mfma_f32_16x16x32_bf16 v[156:159], v[80:83], v[132:135], 0
    ds_read_b64 v[104:105], v11 offset:8192
    ds_read_b64 v[106:107], v12 offset:8192
    ds_read_b64 v[120:121], v11 offset:12288
    v_cvt_pk_bf16_f32 v227, v242, v243
    v_mfma_f32_16x16x32_bf16 v[144:147], v[68:71], v[160:163], v[144:147]
    ds_read_b64 v[122:123], v12 offset:12288
    ds_read_b64 v[108:109], v13 offset:8192
    ds_read_b64 v[110:111], v14 offset:8192
    v_cvt_pk_bf16_f32 v228, v228, v229
    v_cvt_pk_bf16_f32 v229, v230, v231
    v_mfma_f32_16x16x32_bf16 v[152:155], v[68:71], v[164:167], v[152:155]
    ds_read_b64 v[124:125], v13 offset:12288
    ds_read_b64 v[126:127], v14 offset:12288
    v_cvt_pk_bf16_f32 v230, v244, v245
    v_mfma_f32_16x16x32_bf16 v[148:151], v[84:87], v[160:163], v[148:151]
    v_cvt_pk_bf16_f32 v231, v246, v247
    v_mfma_f32_16x16x32_bf16 v[156:159], v[84:87], v[164:167], v[156:159]
    v_cvt_pk_bf16_f32 v232, v232, v233
    v_cvt_pk_bf16_f32 v233, v234, v235
    v_mfma_f32_16x16x32_bf16 v[144:147], v[72:75], v[192:195], v[144:147]
    s_waitcnt lgkmcnt(0)
    s_barrier
    v_cvt_pk_bf16_f32 v234, v248, v249
    v_mfma_f32_16x16x32_bf16 v[152:155], v[72:75], v[196:199], v[152:155]
    v_cvt_pk_bf16_f32 v235, v250, v251
    v_mfma_f32_16x16x32_bf16 v[148:151], v[88:91], v[192:195], v[148:151]
    v_cvt_pk_bf16_f32 v236, v236, v237
    v_cvt_pk_bf16_f32 v237, v238, v239
    v_mfma_f32_16x16x32_bf16 v[156:159], v[88:91], v[196:199], v[156:159]
    v_cvt_pk_bf16_f32 v238, v252, v253
    v_mfma_f32_16x16x32_bf16 v[144:147], v[76:79], v[224:227], v[144:147]
    v_cvt_pk_bf16_f32 v239, v254, v255
    v_mfma_f32_16x16x32_bf16 v[152:155], v[76:79], v[228:231], v[152:155]
    v_mfma_f32_16x16x32_bf16 v[148:151], v[92:95], v[224:227], v[148:151]
    v_mfma_f32_16x16x32_bf16 v[156:159], v[92:95], v[228:231], v[156:159]
    v_mfma_f32_16x16x32_bf16 v[176:179], v[96:99], v[136:139], 0
    v_mfma_f32_16x16x32_bf16 v[184:187], v[96:99], v[140:143], 0
    v_mfma_f32_16x16x32_bf16 v[180:183], v[112:115], v[136:139], 0
    v_mfma_f32_16x16x32_bf16 v[188:191], v[112:115], v[140:143], 0
    v_mfma_f32_16x16x32_bf16 v[176:179], v[100:103], v[168:171], v[176:179]
    v_max3_f32 v208, v144, v145, v146
    v_max3_f32 v212, v152, v153, v154
    v_mfma_f32_16x16x32_bf16 v[184:187], v[100:103], v[172:175], v[184:187]
    v_max3_f32 v209, v147, v148, v149
    v_mfma_f32_16x16x32_bf16 v[180:183], v[116:119], v[168:171], v[180:183]
    v_max3_f32 v213, v155, v156, v157
    v_mfma_f32_16x16x32_bf16 v[188:191], v[116:119], v[172:175], v[188:191]
    v_max3_f32 v208, v208, v150, v151
    v_max3_f32 v212, v212, v158, v159
    v_mfma_f32_16x16x32_bf16 v[176:179], v[104:107], v[200:203], v[176:179]
    v_max_f32 v208, v208, v209
    v_mfma_f32_16x16x32_bf16 v[184:187], v[104:107], v[204:207], v[184:187]
    v_max_f32 v212, v212, v213
    v_mfma_f32_16x16x32_bf16 v[180:183], v[120:123], v[200:203], v[180:183]
    s_nop 0
    v_permlane32_swap_b32 v208, v212
    v_max_f32 v208, v208, v212
    v_mfma_f32_16x16x32_bf16 v[188:191], v[120:123], v[204:207], v[188:191]
    v_mov_b32 v212, v208
    v_mfma_f32_16x16x32_bf16 v[176:179], v[108:111], v[232:235], v[176:179]
    s_nop 0
    v_permlane16_swap_b32 v208, v212
    v_mfma_f32_16x16x32_bf16 v[184:187], v[108:111], v[236:239], v[184:187]
    v_max_f32 v208, v208, v212
    v_mul_f32 v208, s84, v208
    v_mfma_f32_16x16x32_bf16 v[180:183], v[124:127], v[232:235], v[180:183]
    v_mov_b32 v212, v208
    v_mfma_f32_16x16x32_bf16 v[188:191], v[124:127], v[236:239], v[188:191]
    s_nop 0
    v_permlane32_swap_b32 v208, v212
    v_pk_fma_f32 v[144:145], v[144:145], s[84:85], v[208:209] op_sel_hi:[1,1,0] neg_lo:[0,0,1] neg_hi:[0,0,1]
    v_pk_fma_f32 v[152:153], v[152:153], s[84:85], v[212:213] op_sel_hi:[1,1,0] neg_lo:[0,0,1] neg_hi:[0,0,1]
    v_pk_fma_f32 v[146:147], v[146:147], s[84:85], v[208:209] op_sel_hi:[1,1,0] neg_lo:[0,0,1] neg_hi:[0,0,1]
    v_pk_fma_f32 v[154:155], v[154:155], s[84:85], v[212:213] op_sel_hi:[1,1,0] neg_lo:[0,0,1] neg_hi:[0,0,1]
    v_max3_f32 v216, v176, v177, v178
    v_pk_fma_f32 v[148:149], v[148:149], s[84:85], v[208:209] op_sel_hi:[1,1,0] neg_lo:[0,0,1] neg_hi:[0,0,1]
    v_max3_f32 v220, v184, v185, v186
    v_pk_fma_f32 v[156:157], v[156:157], s[84:85], v[212:213] op_sel_hi:[1,1,0] neg_lo:[0,0,1] neg_hi:[0,0,1]
    v_max3_f32 v217, v179, v180, v181
    v_pk_fma_f32 v[150:151], v[150:151], s[84:85], v[208:209] op_sel_hi:[1,1,0] neg_lo:[0,0,1] neg_hi:[0,0,1]
    v_max3_f32 v221, v187, v188, v189
    v_pk_fma_f32 v[158:159], v[158:159], s[84:85], v[212:213] op_sel_hi:[1,1,0] neg_lo:[0,0,1] neg_hi:[0,0,1]
    v_max3_f32 v216, v216, v182, v183
    v_exp_f32 v144, v144
    v_max3_f32 v220, v220, v190, v191
    v_exp_f32 v152, v152
    v_max_f32 v216, v216, v217
    v_exp_f32 v145, v145
    v_max_f32 v220, v220, v221
    v_exp_f32 v153, v153
    s_nop 0
    v_permlane32_swap_b32 v216, v220
    v_exp_f32 v146, v146
    v_max_f32 v216, v216, v220
    v_exp_f32 v154, v154
    v_mov_b32 v220, v216
    v_exp_f32 v147, v147
    s_nop 0
    v_permlane16_swap_b32 v216, v220
    v_exp_f32 v155, v155
    v_max_f32 v216, v216, v220
    v_exp_f32 v148, v148
    v_mul_f32 v216, s84, v216
    v_exp_f32 v156, v156
    v_mov_b32 v220, v216
    v_exp_f32 v149, v149
    s_nop 0
    v_permlane32_swap_b32 v216, v220
    v_exp_f32 v157, v157
    v_pk_fma_f32 v[176:177], v[176:177], s[84:85], v[216:217] op_sel_hi:[1,1,0] neg_lo:[0,0,1] neg_hi:[0,0,1]
    v_exp_f32 v150, v150
    v_pk_fma_f32 v[184:185], v[184:185], s[84:85], v[220:221] op_sel_hi:[1,1,0] neg_lo:[0,0,1] neg_hi:[0,0,1]
    v_exp_f32 v158, v158
    v_pk_fma_f32 v[178:179], v[178:179], s[84:85], v[216:217] op_sel_hi:[1,1,0] neg_lo:[0,0,1] neg_hi:[0,0,1]
    v_exp_f32 v151, v151
    v_pk_fma_f32 v[186:187], v[186:187], s[84:85], v[220:221] op_sel_hi:[1,1,0] neg_lo:[0,0,1] neg_hi:[0,0,1]
    v_exp_f32 v159, v159
    v_pk_fma_f32 v[180:181], v[180:181], s[84:85], v[216:217] op_sel_hi:[1,1,0] neg_lo:[0,0,1] neg_hi:[0,0,1]
    v_pk_add_f32 v[208:209], v[144:145], v[146:147]
    v_pk_fma_f32 v[188:189], v[188:189], s[84:85], v[220:221] op_sel_hi:[1,1,0] neg_lo:[0,0,1] neg_hi:[0,0,1]
    v_pk_add_f32 v[212:213], v[152:153], v[154:155]
    v_pk_fma_f32 v[182:183], v[182:183], s[84:85], v[216:217] op_sel_hi:[1,1,0] neg_lo:[0,0,1] neg_hi:[0,0,1]
    v_pk_add_f32 v[210:211], v[148:149], v[150:151]
    v_pk_fma_f32 v[190:191], v[190:191], s[84:85], v[220:221] op_sel_hi:[1,1,0] neg_lo:[0,0,1] neg_hi:[0,0,1]
    v_pk_add_f32 v[214:215], v[156:157], v[158:159]
    v_exp_f32 v176, v176
    v_pk_add_f32 v[208:209], v[208:209], v[210:211]
    v_exp_f32 v184, v184
    v_pk_add_f32 v[212:213], v[212:213], v[214:215]
    v_exp_f32 v177, v177
    v_add_f32 v208, v208, v209
    v_exp_f32 v185, v185
    v_add_f32 v212, v212, v213
    v_exp_f32 v178, v178
    s_nop 0
    v_permlane32_swap_b32 v208, v212
    v_exp_f32 v186, v186
    v_add_f32 v208, v208, v212
    v_exp_f32 v179, v179
    v_mov_b32 v212, v208
    v_exp_f32 v187, v187
    s_nop 0
    v_permlane16_swap_b32 v208, v212
    v_exp_f32 v180, v180
    v_add_f32 v208, v208, v212
    v_exp_f32 v188, v188
    v_rcp_f32 v208, v208
    v_exp_f32 v181, v181
    v_mov_b32 v212, v208
    v_exp_f32 v189, v189
    s_nop 0
    v_permlane32_swap_b32 v208, v212
    v_exp_f32 v182, v182
    v_pk_mul_f32 v[144:145], v[144:145], v[208:209] op_sel_hi:[1,0]
    v_exp_f32 v190, v190
    v_pk_mul_f32 v[152:153], v[152:153], v[212:213] op_sel_hi:[1,0]
    v_exp_f32 v183, v183
    v_pk_mul_f32 v[146:147], v[146:147], v[208:209] op_sel_hi:[1,0]
    v_exp_f32 v191, v191
    v_pk_mul_f32 v[154:155], v[154:155], v[212:213] op_sel_hi:[1,0]
    v_pk_add_f32 v[216:217], v[176:177], v[178:179]
    v_pk_mul_f32 v[148:149], v[148:149], v[208:209] op_sel_hi:[1,0]
    v_pk_add_f32 v[220:221], v[184:185], v[186:187]
    v_pk_mul_f32 v[156:157], v[156:157], v[212:213] op_sel_hi:[1,0]
    v_pk_add_f32 v[218:219], v[180:181], v[182:183]
    v_pk_mul_f32 v[150:151], v[150:151], v[208:209] op_sel_hi:[1,0]
    v_pk_add_f32 v[222:223], v[188:189], v[190:191]
    v_pk_mul_f32 v[158:159], v[158:159], v[212:213] op_sel_hi:[1,0]
    v_pk_add_f32 v[216:217], v[216:217], v[218:219]
    v_cvt_pk_bf16_f32 v40, v144, v145
    v_pk_add_f32 v[220:221], v[220:221], v[222:223]
    v_cvt_pk_bf16_f32 v41, v146, v147
    v_add_f32 v216, v216, v217
    v_cvt_pk_bf16_f32 v42, v148, v149
    v_add_f32 v220, v220, v221
    v_cvt_pk_bf16_f32 v43, v150, v151
    s_nop 0
    v_permlane32_swap_b32 v216, v220
    buffer_store_dwordx4 v[40:43], v28, s[64:67], s81 offen offset:0 sc1
    v_add_f32 v216, v216, v220
    ds_write_b128 v15, v[40:43] offset:0
    v_mov_b32 v220, v216
    v_cvt_pk_bf16_f32 v44, v152, v153
    s_nop 0
    v_permlane16_swap_b32 v216, v220
    v_cvt_pk_bf16_f32 v45, v154, v155
    v_add_f32 v216, v216, v220
    v_cvt_pk_bf16_f32 v46, v156, v157
    v_rcp_f32 v216, v216
    v_cvt_pk_bf16_f32 v47, v158, v159
    v_mov_b32 v220, v216
    buffer_store_dwordx4 v[44:47], v28, s[64:67], s81 offen offset:1024 sc1
    s_nop 0
    v_permlane32_swap_b32 v216, v220
    ds_write_b128 v15, v[44:47] offset:1024
    v_pk_mul_f32 v[176:177], v[176:177], v[216:217] op_sel_hi:[1,0]
    v_pk_mul_f32 v[184:185], v[184:185], v[220:221] op_sel_hi:[1,0]
    v_pk_mul_f32 v[178:179], v[178:179], v[216:217] op_sel_hi:[1,0]
    v_pk_mul_f32 v[186:187], v[186:187], v[220:221] op_sel_hi:[1,0]
    v_pk_mul_f32 v[180:181], v[180:181], v[216:217] op_sel_hi:[1,0]
    v_pk_mul_f32 v[188:189], v[188:189], v[220:221] op_sel_hi:[1,0]
    v_pk_mul_f32 v[182:183], v[182:183], v[216:217] op_sel_hi:[1,0]
    v_pk_mul_f32 v[190:191], v[190:191], v[220:221] op_sel_hi:[1,0]
    s_add_u32 s81, s81, 65536
    v_cvt_pk_bf16_f32 v48, v176, v177
    v_cvt_pk_bf16_f32 v49, v178, v179
    v_cvt_pk_bf16_f32 v50, v180, v181
    v_cvt_pk_bf16_f32 v51, v182, v183
    buffer_store_dwordx4 v[48:51], v28, s[64:67], s81 offen offset:0 sc1
    ds_write_b128 v15, v[48:51] offset:4096
    v_cvt_pk_bf16_f32 v52, v184, v185
    v_cvt_pk_bf16_f32 v53, v186, v187
    v_cvt_pk_bf16_f32 v54, v188, v189
    v_cvt_pk_bf16_f32 v55, v190, v191
    buffer_store_dwordx4 v[52:55], v28, s[64:67], s81 offen offset:1024 sc1
    ds_write_b128 v15, v[52:55] offset:5120
    s_waitcnt lgkmcnt(0)
    s_barrier
    ds_read_b128 v[40:43], v16 offset:0
    ds_read_b128 v[44:47], v16 offset:1024
    ds_read_b64_tr_b16 v[96:97], v23 offset:0
    ds_read_b64_tr_b16 v[98:99], v23 offset:2048
    ds_read_b64_tr_b16 v[100:101], v24 offset:0
    ds_read_b64_tr_b16 v[102:103], v24 offset:2048
    ds_read_b64_tr_b16 v[104:105], v25 offset:0
    ds_read_b64_tr_b16 v[106:107], v25 offset:2048
    ds_read_b64_tr_b16 v[108:109], v26 offset:0
    ds_read_b64_tr_b16 v[110:111], v26 offset:2048
    ds_read_b128 v[48:51], v16 offset:2048
    ds_read_b128 v[52:55], v16 offset:3072
    ds_read_b64_tr_b16 v[64:65], v19 offset:0
    ds_read_b64_tr_b16 v[66:67], v19 offset:5120
    ds_read_b64_tr_b16 v[68:69], v19 offset:10240
    ds_read_b64_tr_b16 v[70:71], v19 offset:15360
    s_waitcnt lgkmcnt(10)
    v_mfma_f32_16x16x32_bf16 v[112:115], v[96:99], v[40:43], 0
    v_mfma_f32_16x16x32_bf16 v[116:119], v[96:99], v[44:47], 0
    v_mfma_f32_16x16x32_bf16 v[120:123], v[100:103], v[40:43], 0
    v_mfma_f32_16x16x32_bf16 v[124:127], v[100:103], v[44:47], 0
    s_waitcnt lgkmcnt(6)
    v_mfma_f32_16x16x32_bf16 v[128:131], v[104:107], v[40:43], 0
    v_mfma_f32_16x16x32_bf16 v[132:135], v[104:107], v[44:47], 0
    v_mfma_f32_16x16x32_bf16 v[136:139], v[108:111], v[40:43], 0
    v_mfma_f32_16x16x32_bf16 v[140:143], v[108:111], v[44:47], 0
    ds_read_b64_tr_b16 v[72:73], v20 offset:32
    ds_read_b64_tr_b16 v[74:75], v20 offset:5152
    ds_read_b64_tr_b16 v[76:77], v20 offset:10272
    ds_read_b64_tr_b16 v[78:79], v20 offset:15392
    ds_read_b64_tr_b16 v[80:81], v19 offset:64
    ds_read_b64_tr_b16 v[82:83], v19 offset:5184
    ds_read_b64_tr_b16 v[84:85], v19 offset:10304
    ds_read_b64_tr_b16 v[86:87], v19 offset:15424
    v_cvt_pk_bf16_f32 v112, v112, v113
    v_cvt_pk_bf16_f32 v113, v114, v115
    v_cvt_pk_bf16_f32 v114, v120, v121
    v_cvt_pk_bf16_f32 v115, v122, v123
    v_cvt_pk_bf16_f32 v116, v116, v117
    v_cvt_pk_bf16_f32 v117, v118, v119
    v_cvt_pk_bf16_f32 v118, v124, v125
    v_cvt_pk_bf16_f32 v119, v126, v127
    v_cvt_pk_bf16_f32 v128, v128, v129
    v_cvt_pk_bf16_f32 v129, v130, v131
    v_cvt_pk_bf16_f32 v130, v136, v137
    v_cvt_pk_bf16_f32 v131, v138, v139
    v_cvt_pk_bf16_f32 v132, v132, v133
    v_cvt_pk_bf16_f32 v133, v134, v135
    v_cvt_pk_bf16_f32 v134, v140, v141
    v_cvt_pk_bf16_f32 v135, v142, v143
    s_waitcnt lgkmcnt(8)
    v_mfma_f32_16x16x32_bf16 v[176:179], v[64:67], v[112:115], 0
    ds_read_b64_tr_b16 v[88:89], v20 offset:96
    v_mfma_f32_16x16x32_bf16 v[176:179], v[68:71], v[128:131], v[176:179]
    ds_read_b64_tr_b16 v[90:91], v20 offset:5216
    v_mfma_f32_16x16x32_bf16 v[180:183], v[64:67], v[116:119], 0
    ds_read_b64_tr_b16 v[92:93], v20 offset:10336
    v_mfma_f32_16x16x32_bf16 v[180:183], v[68:71], v[132:135], v[180:183]
    ds_read_b64_tr_b16 v[94:95], v20 offset:15456
    s_waitcnt lgkmcnt(8)
    v_mfma_f32_16x16x32_bf16 v[184:187], v[72:75], v[112:115], 0
    ds_read_b64_tr_b16 v[64:65], v19 offset:128
    v_mfma_f32_16x16x32_bf16 v[184:187], v[76:79], v[128:131], v[184:187]
    ds_read_b64_tr_b16 v[66:67], v19 offset:5248
    v_mfma_f32_16x16x32_bf16 v[188:191], v[72:75], v[116:119], 0
    ds_read_b64_tr_b16 v[68:69], v19 offset:10368
    v_mfma_f32_16x16x32_bf16 v[188:191], v[76:79], v[132:135], v[188:191]
    ds_read_b64_tr_b16 v[70:71], v19 offset:15488
    s_waitcnt lgkmcnt(8)
    v_mfma_f32_16x16x32_bf16 v[192:195], v[80:83], v[112:115], 0
    ds_read_b64_tr_b16 v[72:73], v20 offset:160
    v_mfma_f32_16x16x32_bf16 v[192:195], v[84:87], v[128:131], v[192:195]
    ds_read_b64_tr_b16 v[74:75], v20 offset:5280
    v_mfma_f32_16x16x32_bf16 v[196:199], v[80:83], v[116:119], 0
    ds_read_b64_tr_b16 v[76:77], v20 offset:10400
    v_mfma_f32_16x16x32_bf16 v[196:199], v[84:87], v[132:135], v[196:199]
    ds_read_b64_tr_b16 v[78:79], v20 offset:15520
    s_waitcnt lgkmcnt(8)
    v_mfma_f32_16x16x32_bf16 v[200:203], v[88:91], v[112:115], 0
    ds_read_b64_tr_b16 v[80:81], v19 offset:192
    v_mfma_f32_16x16x32_bf16 v[200:203], v[92:95], v[128:131], v[200:203]
    ds_read_b64_tr_b16 v[82:83], v19 offset:5312
    v_mfma_f32_16x16x32_bf16 v[204:207], v[88:91], v[116:119], 0
    ds_read_b64_tr_b16 v[84:85], v19 offset:10432
    v_mfma_f32_16x16x32_bf16 v[204:207], v[92:95], v[132:135], v[204:207]
    ds_read_b64_tr_b16 v[86:87], v19 offset:15552
    s_waitcnt lgkmcnt(8)
    v_mfma_f32_16x16x32_bf16 v[208:211], v[64:67], v[112:115], 0
    ds_read_b64_tr_b16 v[88:89], v20 offset:224
    v_mfma_f32_16x16x32_bf16 v[208:211], v[68:71], v[128:131], v[208:211]
    ds_read_b64_tr_b16 v[90:91], v20 offset:5344
    v_mfma_f32_16x16x32_bf16 v[212:215], v[64:67], v[116:119], 0
    ds_read_b64_tr_b16 v[92:93], v20 offset:10464
    v_mfma_f32_16x16x32_bf16 v[212:215], v[68:71], v[132:135], v[212:215]
    s_barrier
    ds_read_b64_tr_b16 v[96:97], v23 offset:16384
    ds_read_b64_tr_b16 v[94:95], v20 offset:15584
    s_waitcnt lgkmcnt(9)
    v_mfma_f32_16x16x32_bf16 v[216:219], v[72:75], v[112:115], 0
    ds_read_b64_tr_b16 v[98:99], v23 offset:18432
    ds_read_b64_tr_b16 v[64:65], v19 offset:256
    v_mfma_f32_16x16x32_bf16 v[216:219], v[76:79], v[128:131], v[216:219]
    ds_read_b64_tr_b16 v[100:101], v24 offset:16384
    ds_read_b64_tr_b16 v[66:67], v19 offset:5376
    v_mfma_f32_16x16x32_bf16 v[220:223], v[72:75], v[116:119], 0
    ds_read_b64_tr_b16 v[102:103], v24 offset:18432
    ds_read_b64_tr_b16 v[68:69], v19 offset:10496
    v_mfma_f32_16x16x32_bf16 v[220:223], v[76:79], v[132:135], v[220:223]
    ds_read_b64_tr_b16 v[104:105], v25 offset:16384
    ds_read_b64_tr_b16 v[70:71], v19 offset:15616
    s_waitcnt lgkmcnt(13)
    v_mfma_f32_16x16x32_bf16 v[224:227], v[80:83], v[112:115], 0
    ds_read_b64_tr_b16 v[106:107], v25 offset:18432
    v_mfma_f32_16x16x32_bf16 v[224:227], v[84:87], v[128:131], v[224:227]
    ds_read_b64_tr_b16 v[108:109], v26 offset:16384
    v_mfma_f32_16x16x32_bf16 v[228:231], v[80:83], v[116:119], 0
    ds_read_b64_tr_b16 v[110:111], v26 offset:18432
    v_mfma_f32_16x16x32_bf16 v[228:231], v[84:87], v[132:135], v[228:231]
    s_waitcnt lgkmcnt(6)
    v_mfma_f32_16x16x32_bf16 v[144:147], v[96:99], v[40:43], 0
    ds_read_b64_tr_b16 v[72:73], v20 offset:288
    v_mfma_f32_16x16x32_bf16 v[148:151], v[96:99], v[44:47], 0
    ds_read_b64_tr_b16 v[74:75], v20 offset:5408
    v_mfma_f32_16x16x32_bf16 v[152:155], v[100:103], v[40:43], 0
    ds_read_b64_tr_b16 v[76:77], v20 offset:10528
    v_mfma_f32_16x16x32_bf16 v[156:159], v[100:103], v[44:47], 0
    ds_read_b64_tr_b16 v[78:79], v20 offset:15648
    s_waitcnt lgkmcnt(4)
    v_mfma_f32_16x16x32_bf16 v[160:163], v[104:107], v[40:43], 0
    v_mfma_f32_16x16x32_bf16 v[164:167], v[104:107], v[44:47], 0
    v_mfma_f32_16x16x32_bf16 v[168:171], v[108:111], v[40:43], 0
    v_mfma_f32_16x16x32_bf16 v[172:175], v[108:111], v[44:47], 0
    v_cvt_pk_bf16_f32 v144, v144, v145
    v_cvt_pk_bf16_f32 v145, v146, v147
    v_mfma_f32_16x16x32_bf16 v[232:235], v[88:91], v[112:115], 0
    ds_read_b64_tr_b16 v[80:81], v19 offset:20480
    v_cvt_pk_bf16_f32 v146, v152, v153
    v_cvt_pk_bf16_f32 v147, v154, v155
    v_mfma_f32_16x16x32_bf16 v[232:235], v[92:95], v[128:131], v[232:235]
    ds_read_b64_tr_b16 v[82:83], v19 offset:25600
    v_cvt_pk_bf16_f32 v148, v148, v149
    v_cvt_pk_bf16_f32 v149, v150, v151
    v_mfma_f32_16x16x32_bf16 v[236:239], v[88:91], v[116:119], 0
    ds_read_b64_tr_b16 v[84:85], v19 offset:30720
    v_cvt_pk_bf16_f32 v150, v156, v157
    v_cvt_pk_bf16_f32 v151, v158, v159
    v_mfma_f32_16x16x32_bf16 v[236:239], v[92:95], v[132:135], v[236:239]
    ds_read_b64_tr_b16 v[86:87], v19 offset:35840
    v_cvt_pk_bf16_f32 v160, v160, v161
    v_mfma_f32_16x16x32_bf16 v[240:243], v[64:67], v[112:115], 0
    ds_read_b64_tr_b16 v[88:89], v20 offset:20512
    v_cvt_pk_bf16_f32 v161, v162, v163
    v_mfma_f32_16x16x32_bf16 v[240:243], v[68:71], v[128:131], v[240:243]
    ds_read_b64_tr_b16 v[90:91], v20 offset:25632
    v_cvt_pk_bf16_f32 v162, v168, v169
    v_mfma_f32_16x16x32_bf16 v[244:247], v[64:67], v[116:119], 0
    ds_read_b64_tr_b16 v[92:93], v20 offset:30752
    v_cvt_pk_bf16_f32 v163, v170, v171
    v_mfma_f32_16x16x32_bf16 v[244:247], v[68:71], v[132:135], v[244:247]
    ds_read_b64_tr_b16 v[94:95], v20 offset:35872
    v_cvt_pk_bf16_f32 v164, v164, v165
    s_waitcnt lgkmcnt(8)
    v_mfma_f32_16x16x32_bf16 v[248:251], v[72:75], v[112:115], 0
    ds_read_b64_tr_b16 v[64:65], v19 offset:20544
    v_cvt_pk_bf16_f32 v165, v166, v167
    v_mfma_f32_16x16x32_bf16 v[248:251], v[76:79], v[128:131], v[248:251]
    ds_read_b64_tr_b16 v[66:67], v19 offset:25664
    v_cvt_pk_bf16_f32 v166, v172, v173
    v_mfma_f32_16x16x32_bf16 v[252:255], v[72:75], v[116:119], 0
    ds_read_b64_tr_b16 v[68:69], v19 offset:30784
    v_cvt_pk_bf16_f32 v167, v174, v175
    v_mfma_f32_16x16x32_bf16 v[252:255], v[76:79], v[132:135], v[252:255]
    ds_read_b64_tr_b16 v[70:71], v19 offset:35904
    s_waitcnt lgkmcnt(8)
    v_mfma_f32_16x16x32_bf16 v[176:179], v[80:83], v[144:147], v[176:179]
    ds_read_b64_tr_b16 v[72:73], v20 offset:20576
    v_mfma_f32_16x16x32_bf16 v[176:179], v[84:87], v[160:163], v[176:179]
    ds_read_b64_tr_b16 v[74:75], v20 offset:25696
    v_mfma_f32_16x16x32_bf16 v[180:183], v[80:83], v[148:151], v[180:183]
    ds_read_b64_tr_b16 v[76:77], v20 offset:30816
    v_mfma_f32_16x16x32_bf16 v[180:183], v[84:87], v[164:167], v[180:183]
    ds_read_b64_tr_b16 v[78:79], v20 offset:35936
    s_waitcnt lgkmcnt(8)
    v_mfma_f32_16x16x32_bf16 v[184:187], v[88:91], v[144:147], v[184:187]
    ds_read_b64_tr_b16 v[80:81], v19 offset:20608
    v_mfma_f32_16x16x32_bf16 v[184:187], v[92:95], v[160:163], v[184:187]
    ds_read_b64_tr_b16 v[82:83], v19 offset:25728
    v_mfma_f32_16x16x32_bf16 v[188:191], v[88:91], v[148:151], v[188:191]
    ds_read_b64_tr_b16 v[84:85], v19 offset:30848
    v_mfma_f32_16x16x32_bf16 v[188:191], v[92:95], v[164:167], v[188:191]
    ds_read_b64_tr_b16 v[86:87], v19 offset:35968
    s_waitcnt lgkmcnt(8)
    v_mfma_f32_16x16x32_bf16 v[192:195], v[64:67], v[144:147], v[192:195]
    ds_read_b64_tr_b16 v[88:89], v20 offset:20640
    v_mfma_f32_16x16x32_bf16 v[192:195], v[68:71], v[160:163], v[192:195]
    ds_read_b64_tr_b16 v[90:91], v20 offset:25760
    v_mfma_f32_16x16x32_bf16 v[196:199], v[64:67], v[148:151], v[196:199]
    ds_read_b64_tr_b16 v[92:93], v20 offset:30880
    v_mfma_f32_16x16x32_bf16 v[196:199], v[68:71], v[164:167], v[196:199]
    ds_read_b64_tr_b16 v[94:95], v20 offset:36000
    s_waitcnt lgkmcnt(8)
    v_mfma_f32_16x16x32_bf16 v[200:203], v[72:75], v[144:147], v[200:203]
    ds_read_b64_tr_b16 v[64:65], v19 offset:20672
    v_mfma_f32_16x16x32_bf16 v[200:203], v[76:79], v[160:163], v[200:203]
    ds_read_b64_tr_b16 v[66:67], v19 offset:25792
    v_mfma_f32_16x16x32_bf16 v[204:207], v[72:75], v[148:151], v[204:207]
    ds_read_b64_tr_b16 v[68:69], v19 offset:30912
    v_mfma_f32_16x16x32_bf16 v[204:207], v[76:79], v[164:167], v[204:207]
    ds_read_b64_tr_b16 v[70:71], v19 offset:36032
    s_waitcnt lgkmcnt(8)
    v_mfma_f32_16x16x32_bf16 v[208:211], v[80:83], v[144:147], v[208:211]
    ds_read_b64_tr_b16 v[72:73], v20 offset:20704
    v_mfma_f32_16x16x32_bf16 v[208:211], v[84:87], v[160:163], v[208:211]
    ds_read_b64_tr_b16 v[74:75], v20 offset:25824
    v_mfma_f32_16x16x32_bf16 v[212:215], v[80:83], v[148:151], v[212:215]
    ds_read_b64_tr_b16 v[76:77], v20 offset:30944
    v_mfma_f32_16x16x32_bf16 v[212:215], v[84:87], v[164:167], v[212:215]
    s_barrier
    ds_read_b64_tr_b16 v[96:97], v23 offset:32768
    ds_read_b64_tr_b16 v[78:79], v20 offset:36064
    s_waitcnt lgkmcnt(9)
    v_mfma_f32_16x16x32_bf16 v[216:219], v[88:91], v[144:147], v[216:219]
    ds_read_b64_tr_b16 v[98:99], v23 offset:34816
    ds_read_b64_tr_b16 v[80:81], v19 offset:20736
    v_mfma_f32_16x16x32_bf16 v[216:219], v[92:95], v[160:163], v[216:219]
    ds_read_b64_tr_b16 v[100:101], v24 offset:32768
    ds_read_b64_tr_b16 v[82:83], v19 offset:25856
    v_mfma_f32_16x16x32_bf16 v[220:223], v[88:91], v[148:151], v[220:223]
    ds_read_b64_tr_b16 v[102:103], v24 offset:34816
    ds_read_b64_tr_b16 v[84:85], v19 offset:30976
    v_mfma_f32_16x16x32_bf16 v[220:223], v[92:95], v[164:167], v[220:223]
    ds_read_b64_tr_b16 v[104:105], v25 offset:32768
    ds_read_b64_tr_b16 v[86:87], v19 offset:36096
    s_waitcnt lgkmcnt(13)
    v_mfma_f32_16x16x32_bf16 v[224:227], v[64:67], v[144:147], v[224:227]
    ds_read_b64_tr_b16 v[106:107], v25 offset:34816
    v_mfma_f32_16x16x32_bf16 v[224:227], v[68:71], v[160:163], v[224:227]
    ds_read_b64_tr_b16 v[108:109], v26 offset:32768
    v_mfma_f32_16x16x32_bf16 v[228:231], v[64:67], v[148:151], v[228:231]
    ds_read_b64_tr_b16 v[110:111], v26 offset:34816
    v_mfma_f32_16x16x32_bf16 v[228:231], v[68:71], v[164:167], v[228:231]
    s_waitcnt lgkmcnt(6)
    v_mfma_f32_16x16x32_bf16 v[112:115], v[96:99], v[48:51], 0
    ds_read_b64_tr_b16 v[88:89], v20 offset:20768
    v_mfma_f32_16x16x32_bf16 v[116:119], v[96:99], v[52:55], 0
    ds_read_b64_tr_b16 v[90:91], v20 offset:25888
    v_mfma_f32_16x16x32_bf16 v[120:123], v[100:103], v[48:51], 0
    ds_read_b64_tr_b16 v[92:93], v20 offset:31008
    v_mfma_f32_16x16x32_bf16 v[124:127], v[100:103], v[52:55], 0
    ds_read_b64_tr_b16 v[94:95], v20 offset:36128
    s_waitcnt lgkmcnt(4)
    v_mfma_f32_16x16x32_bf16 v[128:131], v[104:107], v[48:51], 0
    v_mfma_f32_16x16x32_bf16 v[132:135], v[104:107], v[52:55], 0
    v_mfma_f32_16x16x32_bf16 v[136:139], v[108:111], v[48:51], 0
    v_mfma_f32_16x16x32_bf16 v[140:143], v[108:111], v[52:55], 0
    v_cvt_pk_bf16_f32 v112, v112, v113
    v_cvt_pk_bf16_f32 v113, v114, v115
    v_mfma_f32_16x16x32_bf16 v[232:235], v[72:75], v[144:147], v[232:235]
    ds_read_b64_tr_b16 v[64:65], v19 offset:40960
    v_cvt_pk_bf16_f32 v114, v120, v121
    v_cvt_pk_bf16_f32 v115, v122, v123
    v_mfma_f32_16x16x32_bf16 v[232:235], v[76:79], v[160:163], v[232:235]
    ds_read_b64_tr_b16 v[66:67], v19 offset:46080
    v_cvt_pk_bf16_f32 v116, v116, v117
    v_cvt_pk_bf16_f32 v117, v118, v119
    v_mfma_f32_16x16x32_bf16 v[236:239], v[72:75], v[148:151], v[236:239]
    ds_read_b64_tr_b16 v[68:69], v19 offset:51200
    v_cvt_pk_bf16_f32 v118, v124, v125
    v_cvt_pk_bf16_f32 v119, v126, v127
    v_mfma_f32_16x16x32_bf16 v[236:239], v[76:79], v[164:167], v[236:239]
    ds_read_b64_tr_b16 v[70:71], v19 offset:56320
    v_cvt_pk_bf16_f32 v128, v128, v129
    v_mfma_f32_16x16x32_bf16 v[240:243], v[80:83], v[144:147], v[240:243]
    ds_read_b64_tr_b16 v[72:73], v20 offset:40992
    v_cvt_pk_bf16_f32 v129, v130, v131
    v_mfma_f32_16x16x32_bf16 v[240:243], v[84:87], v[160:163], v[240:243]
    ds_read_b64_tr_b16 v[74:75], v20 offset:46112
    v_cvt_pk_bf16_f32 v130, v136, v137
    v_mfma_f32_16x16x32_bf16 v[244:247], v[80:83], v[148:151], v[244:247]
    ds_read_b64_tr_b16 v[76:77], v20 offset:51232
    v_cvt_pk_bf16_f32 v131, v138, v139
    v_mfma_f32_16x16x32_bf16 v[244:247], v[84:87], v[164:167], v[244:247]
    ds_read_b64_tr_b16 v[78:79], v20 offset:56352
    v_cvt_pk_bf16_f32 v132, v132, v133
    s_waitcnt lgkmcnt(8)
    v_mfma_f32_16x16x32_bf16 v[248:251], v[88:91], v[144:147], v[248:251]
    ds_read_b64_tr_b16 v[80:81], v19 offset:41024
    v_cvt_pk_bf16_f32 v133, v134, v135
    v_mfma_f32_16x16x32_bf16 v[248:251], v[92:95], v[160:163], v[248:251]
    ds_read_b64_tr_b16 v[82:83], v19 offset:46144
    v_cvt_pk_bf16_f32 v134, v140, v141
    v_mfma_f32_16x16x32_bf16 v[252:255], v[88:91], v[148:151], v[252:255]
    ds_read_b64_tr_b16 v[84:85], v19 offset:51264
    v_cvt_pk_bf16_f32 v135, v142, v143
    v_mfma_f32_16x16x32_bf16 v[252:255], v[92:95], v[164:167], v[252:255]
    ds_read_b64_tr_b16 v[86:87], v19 offset:56384
    s_waitcnt lgkmcnt(8)
    v_mfma_f32_16x16x32_bf16 v[176:179], v[64:67], v[112:115], v[176:179]
    ds_read_b64_tr_b16 v[88:89], v20 offset:41056
    v_mfma_f32_16x16x32_bf16 v[176:179], v[68:71], v[128:131], v[176:179]
    ds_read_b64_tr_b16 v[90:91], v20 offset:46176
    v_mfma_f32_16x16x32_bf16 v[180:183], v[64:67], v[116:119], v[180:183]
    ds_read_b64_tr_b16 v[92:93], v20 offset:51296
    v_mfma_f32_16x16x32_bf16 v[180:183], v[68:71], v[132:135], v[180:183]
    ds_read_b64_tr_b16 v[94:95], v20 offset:56416
    s_waitcnt lgkmcnt(8)
    v_mfma_f32_16x16x32_bf16 v[184:187], v[72:75], v[112:115], v[184:187]
    ds_read_b64_tr_b16 v[64:65], v19 offset:41088
    v_mfma_f32_16x16x32_bf16 v[184:187], v[76:79], v[128:131], v[184:187]
    ds_read_b64_tr_b16 v[66:67], v19 offset:46208
    v_mfma_f32_16x16x32_bf16 v[188:191], v[72:75], v[116:119], v[188:191]
    ds_read_b64_tr_b16 v[68:69], v19 offset:51328
    v_mfma_f32_16x16x32_bf16 v[188:191], v[76:79], v[132:135], v[188:191]
    ds_read_b64_tr_b16 v[70:71], v19 offset:56448
    s_waitcnt lgkmcnt(8)
    v_mfma_f32_16x16x32_bf16 v[192:195], v[80:83], v[112:115], v[192:195]
    ds_read_b64_tr_b16 v[72:73], v20 offset:41120
    s_add_u32 s77, s6, 2
    s_and_b32 s77, s77, 3
    s_lshl_b32 s77, s77, 12
    s_add_u32 s77, s77, s83
    buffer_load_dwordx4 v[56:59], v28, s[64:67], s77 offen offset:0 sc1
    v_mfma_f32_16x16x32_bf16 v[192:195], v[84:87], v[128:131], v[192:195]
    ds_read_b64_tr_b16 v[74:75], v20 offset:46240
    buffer_load_dwordx4 v[60:63], v28, s[64:67], s77 offen offset:1024 sc1
    v_mfma_f32_16x16x32_bf16 v[196:199], v[80:83], v[116:119], v[196:199]
    ds_read_b64_tr_b16 v[76:77], v20 offset:51360
    v_mfma_f32_16x16x32_bf16 v[196:199], v[84:87], v[132:135], v[196:199]
    ds_read_b64_tr_b16 v[78:79], v20 offset:56480
    buffer_load_dwordx4 v[2:5], v28, s[64:67], s77 offen offset:2048 sc1
    s_waitcnt lgkmcnt(8)
    v_mfma_f32_16x16x32_bf16 v[200:203], v[88:91], v[112:115], v[200:203]
    ds_read_b64_tr_b16 v[80:81], v19 offset:41152
    v_mfma_f32_16x16x32_bf16 v[200:203], v[92:95], v[128:131], v[200:203]
    ds_read_b64_tr_b16 v[82:83], v19 offset:46272
    buffer_load_dwordx4 v[6:9], v28, s[64:67], s77 offen offset:3072 sc1
    v_mfma_f32_16x16x32_bf16 v[204:207], v[88:91], v[116:119], v[204:207]
    ds_read_b64_tr_b16 v[84:85], v19 offset:51392
    v_mfma_f32_16x16x32_bf16 v[204:207], v[92:95], v[132:135], v[204:207]
    ds_read_b64_tr_b16 v[86:87], v19 offset:56512
    s_waitcnt lgkmcnt(8)
    v_mfma_f32_16x16x32_bf16 v[208:211], v[64:67], v[112:115], v[208:211]
    ds_read_b64_tr_b16 v[88:89], v20 offset:41184
    v_mfma_f32_16x16x32_bf16 v[208:211], v[68:71], v[128:131], v[208:211]
    ds_read_b64_tr_b16 v[90:91], v20 offset:46304
    v_mfma_f32_16x16x32_bf16 v[212:215], v[64:67], v[116:119], v[212:215]
    ds_read_b64_tr_b16 v[92:93], v20 offset:51424
    v_mfma_f32_16x16x32_bf16 v[212:215], v[68:71], v[132:135], v[212:215]
    s_barrier
    ds_read_b64_tr_b16 v[96:97], v23 offset:49152
    ds_read_b64_tr_b16 v[94:95], v20 offset:56544
    s_waitcnt lgkmcnt(9)
    v_mfma_f32_16x16x32_bf16 v[216:219], v[72:75], v[112:115], v[216:219]
    ds_read_b64_tr_b16 v[98:99], v23 offset:51200
    ds_read_b64_tr_b16 v[64:65], v19 offset:41216
    v_mfma_f32_16x16x32_bf16 v[216:219], v[76:79], v[128:131], v[216:219]
    ds_read_b64_tr_b16 v[100:101], v24 offset:49152
    ds_read_b64_tr_b16 v[66:67], v19 offset:46336
    v_mfma_f32_16x16x32_bf16 v[220:223], v[72:75], v[116:119], v[220:223]
    ds_read_b64_tr_b16 v[102:103], v24 offset:51200
    ds_read_b64_tr_b16 v[68:69], v19 offset:51456
    v_mfma_f32_16x16x32_bf16 v[220:223], v[76:79], v[132:135], v[220:223]
    ds_read_b64_tr_b16 v[104:105], v25 offset:49152
    ds_read_b64_tr_b16 v[70:71], v19 offset:56576
    s_waitcnt lgkmcnt(13)
    v_mfma_f32_16x16x32_bf16 v[224:227], v[80:83], v[112:115], v[224:227]
    ds_read_b64_tr_b16 v[106:107], v25 offset:51200
    v_mfma_f32_16x16x32_bf16 v[224:227], v[84:87], v[128:131], v[224:227]
    ds_read_b64_tr_b16 v[108:109], v26 offset:49152
    v_mfma_f32_16x16x32_bf16 v[228:231], v[80:83], v[116:119], v[228:231]
    ds_read_b64_tr_b16 v[110:111], v26 offset:51200
    v_mfma_f32_16x16x32_bf16 v[228:231], v[84:87], v[132:135], v[228:231]
    s_waitcnt lgkmcnt(6)
    v_mfma_f32_16x16x32_bf16 v[144:147], v[96:99], v[48:51], 0
    ds_read_b64_tr_b16 v[72:73], v20 offset:41248
    v_mfma_f32_16x16x32_bf16 v[148:151], v[96:99], v[52:55], 0
    ds_read_b64_tr_b16 v[74:75], v20 offset:46368
    v_mfma_f32_16x16x32_bf16 v[152:155], v[100:103], v[48:51], 0
    ds_read_b64_tr_b16 v[76:77], v20 offset:51488
    v_mfma_f32_16x16x32_bf16 v[156:159], v[100:103], v[52:55], 0
    ds_read_b64_tr_b16 v[78:79], v20 offset:56608
    s_waitcnt lgkmcnt(4)
    v_mfma_f32_16x16x32_bf16 v[160:163], v[104:107], v[48:51], 0
    v_mfma_f32_16x16x32_bf16 v[164:167], v[104:107], v[52:55], 0
    v_mfma_f32_16x16x32_bf16 v[168:171], v[108:111], v[48:51], 0
    v_mfma_f32_16x16x32_bf16 v[172:175], v[108:111], v[52:55], 0
    v_cvt_pk_bf16_f32 v144, v144, v145
    v_cvt_pk_bf16_f32 v145, v146, v147
    v_mfma_f32_16x16x32_bf16 v[232:235], v[88:91], v[112:115], v[232:235]
    ds_read_b64_tr_b16 v[80:81], v21 offset:0
    v_cvt_pk_bf16_f32 v146, v152, v153
    v_cvt_pk_bf16_f32 v147, v154, v155
    v_mfma_f32_16x16x32_bf16 v[232:235], v[92:95], v[128:131], v[232:235]
    ds_read_b64_tr_b16 v[82:83], v21 offset:5120
    v_cvt_pk_bf16_f32 v148, v148, v149
    v_cvt_pk_bf16_f32 v149, v150, v151
    v_mfma_f32_16x16x32_bf16 v[236:239], v[88:91], v[116:119], v[236:239]
    ds_read_b64_tr_b16 v[84:85], v21 offset:10240
    v_cvt_pk_bf16_f32 v150, v156, v157
    v_cvt_pk_bf16_f32 v151, v158, v159
    v_mfma_f32_16x16x32_bf16 v[236:239], v[92:95], v[132:135], v[236:239]
    ds_read_b64_tr_b16 v[86:87], v21 offset:15360
    v_cvt_pk_bf16_f32 v160, v160, v161
    v_mfma_f32_16x16x32_bf16 v[240:243], v[64:67], v[112:115], v[240:243]
    ds_read_b64_tr_b16 v[88:89], v22 offset:32
    v_cvt_pk_bf16_f32 v161, v162, v163
    v_mfma_f32_16x16x32_bf16 v[240:243], v[68:71], v[128:131], v[240:243]
    ds_read_b64_tr_b16 v[90:91], v22 offset:5152
    v_cvt_pk_bf16_f32 v162, v168, v169
    v_mfma_f32_16x16x32_bf16 v[244:247], v[64:67], v[116:119], v[244:247]
    ds_read_b64_tr_b16 v[92:93], v22 offset:10272
    v_cvt_pk_bf16_f32 v163, v170, v171
    v_mfma_f32_16x16x32_bf16 v[244:247], v[68:71], v[132:135], v[244:247]
    ds_read_b64_tr_b16 v[94:95], v22 offset:15392
    v_cvt_pk_bf16_f32 v164, v164, v165
    s_waitcnt lgkmcnt(8)
    v_mfma_f32_16x16x32_bf16 v[248:251], v[72:75], v[112:115], v[248:251]
    ds_read_b64_tr_b16 v[64:65], v21 offset:64
    v_cvt_pk_bf16_f32 v165, v166, v167
    v_mfma_f32_16x16x32_bf16 v[248:251], v[76:79], v[128:131], v[248:251]
    ds_read_b64_tr_b16 v[66:67], v21 offset:5184
    v_cvt_pk_bf16_f32 v166, v172, v173
    v_mfma_f32_16x16x32_bf16 v[252:255], v[72:75], v[116:119], v[252:255]
    ds_read_b64_tr_b16 v[68:69], v21 offset:10304
    v_cvt_pk_bf16_f32 v167, v174, v175
    v_mfma_f32_16x16x32_bf16 v[252:255], v[76:79], v[132:135], v[252:255]
    ds_read_b64_tr_b16 v[70:71], v21 offset:15424
    s_waitcnt lgkmcnt(8)
    v_mfma_f32_16x16x32_bf16 v[176:179], v[80:83], v[144:147], v[176:179]
    ds_read_b64_tr_b16 v[72:73], v22 offset:96
    v_mfma_f32_16x16x32_bf16 v[176:179], v[84:87], v[160:163], v[176:179]
    ds_read_b64_tr_b16 v[74:75], v22 offset:5216
    v_mfma_f32_16x16x32_bf16 v[180:183], v[80:83], v[148:151], v[180:183]
    ds_read_b64_tr_b16 v[76:77], v22 offset:10336
    v_mfma_f32_16x16x32_bf16 v[180:183], v[84:87], v[164:167], v[180:183]
    ds_read_b64_tr_b16 v[78:79], v22 offset:15456
    s_waitcnt lgkmcnt(8)
    v_mfma_f32_16x16x32_bf16 v[184:187], v[88:91], v[144:147], v[184:187]
    ds_read_b64_tr_b16 v[80:81], v21 offset:128
    v_mfma_f32_16x16x32_bf16 v[184:187], v[92:95], v[160:163], v[184:187]
    ds_read_b64_tr_b16 v[82:83], v21 offset:5248
    v_mfma_f32_16x16x32_bf16 v[188:191], v[88:91], v[148:151], v[188:191]
    ds_read_b64_tr_b16 v[84:85], v21 offset:10368
    v_mfma_f32_16x16x32_bf16 v[188:191], v[92:95], v[164:167], v[188:191]
    ds_read_b64_tr_b16 v[86:87], v21 offset:15488
    s_waitcnt lgkmcnt(8)
    v_mfma_f32_16x16x32_bf16 v[192:195], v[64:67], v[144:147], v[192:195]
    ds_read_b64_tr_b16 v[88:89], v22 offset:160
    v_mfma_f32_16x16x32_bf16 v[192:195], v[68:71], v[160:163], v[192:195]
    ds_read_b64_tr_b16 v[90:91], v22 offset:5280
    v_mfma_f32_16x16x32_bf16 v[196:199], v[64:67], v[148:151], v[196:199]
    ds_read_b64_tr_b16 v[92:93], v22 offset:10400
    v_mfma_f32_16x16x32_bf16 v[196:199], v[68:71], v[164:167], v[196:199]
    ds_read_b64_tr_b16 v[94:95], v22 offset:15520
    s_waitcnt lgkmcnt(8)
    v_mfma_f32_16x16x32_bf16 v[200:203], v[72:75], v[144:147], v[200:203]
    ds_read_b64_tr_b16 v[64:65], v21 offset:192
    v_mfma_f32_16x16x32_bf16 v[200:203], v[76:79], v[160:163], v[200:203]
    ds_read_b64_tr_b16 v[66:67], v21 offset:5312
    v_mfma_f32_16x16x32_bf16 v[204:207], v[72:75], v[148:151], v[204:207]
    ds_read_b64_tr_b16 v[68:69], v21 offset:10432
    v_mfma_f32_16x16x32_bf16 v[204:207], v[76:79], v[164:167], v[204:207]
    ds_read_b64_tr_b16 v[70:71], v21 offset:15552
    s_waitcnt lgkmcnt(8)
    v_mfma_f32_16x16x32_bf16 v[208:211], v[80:83], v[144:147], v[208:211]
    ds_read_b64_tr_b16 v[72:73], v22 offset:224
    v_mfma_f32_16x16x32_bf16 v[208:211], v[84:87], v[160:163], v[208:211]
    ds_read_b64_tr_b16 v[74:75], v22 offset:5344
    v_mfma_f32_16x16x32_bf16 v[212:215], v[80:83], v[148:151], v[212:215]
    ds_read_b64_tr_b16 v[76:77], v22 offset:10464
    v_mfma_f32_16x16x32_bf16 v[212:215], v[84:87], v[164:167], v[212:215]
    s_barrier
    ds_read_b64_tr_b16 v[96:97], v23 offset:0
    ds_read_b64_tr_b16 v[78:79], v22 offset:15584
    s_waitcnt lgkmcnt(9)
    v_mfma_f32_16x16x32_bf16 v[216:219], v[88:91], v[144:147], v[216:219]
    ds_read_b64_tr_b16 v[98:99], v23 offset:2048
    ds_read_b64_tr_b16 v[80:81], v21 offset:256
    s_waitcnt vmcnt(3)
    v_max3_u32 v33, v56, v57, v58
    s_waitcnt vmcnt(2)
    v_max3_u32 v33, v33, v59, v60
    v_mfma_f32_16x16x32_bf16 v[216:219], v[92:95], v[160:163], v[216:219]
    ds_read_b64_tr_b16 v[100:101], v24 offset:0
    ds_read_b64_tr_b16 v[82:83], v21 offset:5376
    v_max3_u32 v33, v33, v61, v62
    s_waitcnt vmcnt(1)
    v_max3_u32 v33, v33, v63, v2
    v_mfma_f32_16x16x32_bf16 v[220:223], v[88:91], v[148:151], v[220:223]
    ds_read_b64_tr_b16 v[102:103], v24 offset:2048
    ds_read_b64_tr_b16 v[84:85], v21 offset:10496
    v_max3_u32 v33, v33, v3, v4
    s_waitcnt vmcnt(0)
    v_max3_u32 v33, v33, v5, v6
    v_mfma_f32_16x16x32_bf16 v[220:223], v[92:95], v[164:167], v[220:223]
    ds_read_b64_tr_b16 v[104:105], v25 offset:0
    ds_read_b64_tr_b16 v[86:87], v21 offset:15616
    v_max3_u32 v33, v33, v7, v8
    v_max_u32 v33, v33, v9
    s_waitcnt lgkmcnt(13)
    v_mfma_f32_16x16x32_bf16 v[224:227], v[64:67], v[144:147], v[224:227]
    ds_read_b64_tr_b16 v[106:107], v25 offset:2048
    v_cmp_eq_u32 vcc, -1, v33
    s_nop 0
    s_cbranch_vccnz L_spin3
L_back3:
    v_mfma_f32_16x16x32_bf16 v[224:227], v[68:71], v[160:163], v[224:227]
    ds_read_b64_tr_b16 v[108:109], v26 offset:0
    v_mfma_f32_16x16x32_bf16 v[228:231], v[64:67], v[148:151], v[228:231]
    ds_read_b64_tr_b16 v[110:111], v26 offset:2048
    v_mfma_f32_16x16x32_bf16 v[228:231], v[68:71], v[164:167], v[228:231]
    s_waitcnt lgkmcnt(6)
    v_mfma_f32_16x16x32_bf16 v[112:115], v[96:99], v[56:59], 0
    ds_read_b64_tr_b16 v[88:89], v22 offset:288
    v_mfma_f32_16x16x32_bf16 v[116:119], v[96:99], v[60:63], 0
    ds_read_b64_tr_b16 v[90:91], v22 offset:5408
    v_mfma_f32_16x16x32_bf16 v[120:123], v[100:103], v[56:59], 0
    ds_read_b64_tr_b16 v[92:93], v22 offset:10528
    v_mfma_f32_16x16x32_bf16 v[124:127], v[100:103], v[60:63], 0
    ds_read_b64_tr_b16 v[94:95], v22 offset:15648
    s_waitcnt lgkmcnt(4)
    v_mfma_f32_16x16x32_bf16 v[128:131], v[104:107], v[56:59], 0
    v_mfma_f32_16x16x32_bf16 v[132:135], v[104:107], v[60:63], 0
    v_mfma_f32_16x16x32_bf16 v[136:139], v[108:111], v[56:59], 0
    v_mfma_f32_16x16x32_bf16 v[140:143], v[108:111], v[60:63], 0
    v_cvt_pk_bf16_f32 v112, v112, v113
    v_cvt_pk_bf16_f32 v113, v114, v115
    v_mfma_f32_16x16x32_bf16 v[232:235], v[72:75], v[144:147], v[232:235]
    ds_read_b64_tr_b16 v[64:65], v19 offset:0
    v_cvt_pk_bf16_f32 v114, v120, v121
    v_cvt_pk_bf16_f32 v115, v122, v123
    v_mfma_f32_16x16x32_bf16 v[232:235], v[76:79], v[160:163], v[232:235]
    ds_read_b64_tr_b16 v[66:67], v19 offset:5120
    v_cvt_pk_bf16_f32 v116, v116, v117
    v_cvt_pk_bf16_f32 v117, v118, v119
    v_mfma_f32_16x16x32_bf16 v[236:239], v[72:75], v[148:151], v[236:239]
    ds_read_b64_tr_b16 v[68:69], v19 offset:10240
    v_cvt_pk_bf16_f32 v118, v124, v125
    v_cvt_pk_bf16_f32 v119, v126, v127
    v_mfma_f32_16x16x32_bf16 v[236:239], v[76:79], v[164:167], v[236:239]
    ds_read_b64_tr_b16 v[70:71], v19 offset:15360
    v_cvt_pk_bf16_f32 v128, v128, v129
    v_mfma_f32_16x16x32_bf16 v[240:243], v[80:83], v[144:147], v[240:243]
    ds_read_b64_tr_b16 v[72:73], v20 offset:32
    v_cvt_pk_bf16_f32 v129, v130, v131
    v_mfma_f32_16x16x32_bf16 v[240:243], v[84:87], v[160:163], v[240:243]
    ds_read_b64_tr_b16 v[74:75], v20 offset:5152
    v_cvt_pk_bf16_f32 v130, v136, v137
    v_mfma_f32_16x16x32_bf16 v[244:247], v[80:83], v[148:151], v[244:247]
    ds_read_b64_tr_b16 v[76:77], v20 offset:10272
    v_cvt_pk_bf16_f32 v131, v138, v139
    v_mfma_f32_16x16x32_bf16 v[244:247], v[84:87], v[164:167], v[244:247]
    ds_read_b64_tr_b16 v[78:79], v20 offset:15392
    v_cvt_pk_bf16_f32 v132, v132, v133
    s_waitcnt lgkmcnt(8)
    v_mfma_f32_16x16x32_bf16 v[248:251], v[88:91], v[144:147], v[248:251]
    ds_read_b64_tr_b16 v[80:81], v19 offset:64
    v_cvt_pk_bf16_f32 v133, v134, v135
    v_mfma_f32_16x16x32_bf16 v[248:251], v[92:95], v[160:163], v[248:251]
    ds_read_b64_tr_b16 v[82:83], v19 offset:5184
    v_cvt_pk_bf16_f32 v134, v140, v141
    v_mfma_f32_16x16x32_bf16 v[252:255], v[88:91], v[148:151], v[252:255]
    ds_read_b64_tr_b16 v[84:85], v19 offset:10304
    v_cvt_pk_bf16_f32 v135, v142, v143
    v_mfma_f32_16x16x32_bf16 v[252:255], v[92:95], v[164:167], v[252:255]
    ds_read_b64_tr_b16 v[86:87], v19 offset:15424
    s_waitcnt lgkmcnt(8)
    v_mfma_f32_16x16x32_bf16 v[176:179], v[64:67], v[112:115], v[176:179]
    ds_read_b64_tr_b16 v[88:89], v20 offset:96
    v_mfma_f32_16x16x32_bf16 v[176:179], v[68:71], v[128:131], v[176:179]
    ds_read_b64_tr_b16 v[90:91], v20 offset:5216
    v_mfma_f32_16x16x32_bf16 v[180:183], v[64:67], v[116:119], v[180:183]
    ds_read_b64_tr_b16 v[92:93], v20 offset:10336
    v_mfma_f32_16x16x32_bf16 v[180:183], v[68:71], v[132:135], v[180:183]
    ds_read_b64_tr_b16 v[94:95], v20 offset:15456
    s_waitcnt lgkmcnt(8)
    v_mfma_f32_16x16x32_bf16 v[184:187], v[72:75], v[112:115], v[184:187]
    ds_read_b64_tr_b16 v[64:65], v19 offset:128
    v_mfma_f32_16x16x32_bf16 v[184:187], v[76:79], v[128:131], v[184:187]
    ds_read_b64_tr_b16 v[66:67], v19 offset:5248
    v_mfma_f32_16x16x32_bf16 v[188:191], v[72:75], v[116:119], v[188:191]
    ds_read_b64_tr_b16 v[68:69], v19 offset:10368
    v_mfma_f32_16x16x32_bf16 v[188:191], v[76:79], v[132:135], v[188:191]
    ds_read_b64_tr_b16 v[70:71], v19 offset:15488
    s_waitcnt lgkmcnt(8)
    v_mfma_f32_16x16x32_bf16 v[192:195], v[80:83], v[112:115], v[192:195]
    ds_read_b64_tr_b16 v[72:73], v20 offset:160
    v_mfma_f32_16x16x32_bf16 v[192:195], v[84:87], v[128:131], v[192:195]
    ds_read_b64_tr_b16 v[74:75], v20 offset:5280
    v_mfma_f32_16x16x32_bf16 v[196:199], v[80:83], v[116:119], v[196:199]
    ds_read_b64_tr_b16 v[76:77], v20 offset:10400
    v_mfma_f32_16x16x32_bf16 v[196:199], v[84:87], v[132:135], v[196:199]
    ds_read_b64_tr_b16 v[78:79], v20 offset:15520
    s_waitcnt lgkmcnt(8)
    v_mfma_f32_16x16x32_bf16 v[200:203], v[88:91], v[112:115], v[200:203]
    ds_read_b64_tr_b16 v[80:81], v19 offset:192
    v_mfma_f32_16x16x32_bf16 v[200:203], v[92:95], v[128:131], v[200:203]
    ds_read_b64_tr_b16 v[82:83], v19 offset:5312
    v_mfma_f32_16x16x32_bf16 v[204:207], v[88:91], v[116:119], v[204:207]
    ds_read_b64_tr_b16 v[84:85], v19 offset:10432
    v_mfma_f32_16x16x32_bf16 v[204:207], v[92:95], v[132:135], v[204:207]
    ds_read_b64_tr_b16 v[86:87], v19 offset:15552
    s_waitcnt lgkmcnt(8)
    v_mfma_f32_16x16x32_bf16 v[208:211], v[64:67], v[112:115], v[208:211]
    ds_read_b64_tr_b16 v[88:89], v20 offset:224
    v_mfma_f32_16x16x32_bf16 v[208:211], v[68:71], v[128:131], v[208:211]
    ds_read_b64_tr_b16 v[90:91], v20 offset:5344
    v_mfma_f32_16x16x32_bf16 v[212:215], v[64:67], v[116:119], v[212:215]
    ds_read_b64_tr_b16 v[92:93], v20 offset:10464
    v_mfma_f32_16x16x32_bf16 v[212:215], v[68:71], v[132:135], v[212:215]
    s_barrier
    ds_read_b64_tr_b16 v[96:97], v23 offset:16384
    ds_read_b64_tr_b16 v[94:95], v20 offset:15584
    s_waitcnt lgkmcnt(9)
    v_mfma_f32_16x16x32_bf16 v[216:219], v[72:75], v[112:115], v[216:219]
    ds_read_b64_tr_b16 v[98:99], v23 offset:18432
    ds_read_b64_tr_b16 v[64:65], v19 offset:256
    v_mfma_f32_16x16x32_bf16 v[216:219], v[76:79], v[128:131], v[216:219]
    ds_read_b64_tr_b16 v[100:101], v24 offset:16384
    ds_read_b64_tr_b16 v[66:67], v19 offset:5376
    v_mfma_f32_16x16x32_bf16 v[220:223], v[72:75], v[116:119], v[220:223]
    ds_read_b64_tr_b16 v[102:103], v24 offset:18432
    ds_read_b64_tr_b16 v[68:69], v19 offset:10496
    v_mfma_f32_16x16x32_bf16 v[220:223], v[76:79], v[132:135], v[220:223]
    ds_read_b64_tr_b16 v[104:105], v25 offset:16384
    ds_read_b64_tr_b16 v[70:71], v19 offset:15616
    s_waitcnt lgkmcnt(13)
    v_mfma_f32_16x16x32_bf16 v[224:227], v[80:83], v[112:115], v[224:227]
    ds_read_b64_tr_b16 v[106:107], v25 offset:18432
    v_mfma_f32_16x16x32_bf16 v[224:227], v[84:87], v[128:131], v[224:227]
    ds_read_b64_tr_b16 v[108:109], v26 offset:16384
    v_mfma_f32_16x16x32_bf16 v[228:231], v[80:83], v[116:119], v[228:231]
    ds_read_b64_tr_b16 v[110:111], v26 offset:18432
    v_mfma_f32_16x16x32_bf16 v[228:231], v[84:87], v[132:135], v[228:231]
    s_waitcnt lgkmcnt(6)
    v_mfma_f32_16x16x32_bf16 v[144:147], v[96:99], v[56:59], 0
    ds_read_b64_tr_b16 v[72:73], v20 offset:288
    s_add_u32 s77, s6, 1
    v_mfma_f32_16x16x32_bf16 v[148:151], v[96:99], v[60:63], 0
    ds_read_b64_tr_b16 v[74:75], v20 offset:5408
    s_and_b32 s77, s77, 3
    v_mfma_f32_16x16x32_bf16 v[152:155], v[100:103], v[56:59], 0
    ds_read_b64_tr_b16 v[76:77], v20 offset:10528
    s_lshl_b32 s77, s77, 12
    v_mfma_f32_16x16x32_bf16 v[156:159], v[100:103], v[60:63], 0
    ds_read_b64_tr_b16 v[78:79], v20 offset:15648
    s_add_u32 s77, s77, s83
    s_waitcnt lgkmcnt(4)
    v_mfma_f32_16x16x32_bf16 v[160:163], v[104:107], v[56:59], 0
    buffer_load_dwordx4 v[40:43], v28, s[64:67], s77 offen offset:0 sc1
    v_mfma_f32_16x16x32_bf16 v[164:167], v[104:107], v[60:63], 0
    buffer_load_dwordx4 v[44:47], v28, s[64:67], s77 offen offset:1024 sc1
    v_mfma_f32_16x16x32_bf16 v[168:171], v[108:111], v[56:59], 0
    buffer_load_dwordx4 v[48:51], v28, s[64:67], s77 offen offset:2048 sc1
    v_mfma_f32_16x16x32_bf16 v[172:175], v[108:111], v[60:63], 0
    v_cvt_pk_bf16_f32 v144, v144, v145
    v_cvt_pk_bf16_f32 v145, v146, v147
    buffer_load_dwordx4 v[52:55], v28, s[64:67], s77 offen offset:3072 sc1
    v_mfma_f32_16x16x32_bf16 v[232:235], v[88:91], v[112:115], v[232:235]
    ds_read_b64_tr_b16 v[80:81], v19 offset:20480
    v_cvt_pk_bf16_f32 v146, v152, v153
    v_cvt_pk_bf16_f32 v147, v154, v155
    v_mfma_f32_16x16x32_bf16 v[232:235], v[92:95], v[128:131], v[232:235]
    ds_read_b64_tr_b16 v[82:83], v19 offset:25600
    v_cvt_pk_bf16_f32 v148, v148, v149
    v_cvt_pk_bf16_f32 v149, v150, v151
    v_mfma_f32_16x16x32_bf16 v[236:239], v[88:91], v[116:119], v[236:239]
    ds_read_b64_tr_b16 v[84:85], v19 offset:30720
    v_cvt_pk_bf16_f32 v150, v156, v157
    v_cvt_pk_bf16_f32 v151, v158, v159
    v_mfma_f32_16x16x32_bf16 v[236:239], v[92:95], v[132:135], v[236:239]
    ds_read_b64_tr_b16 v[86:87], v19 offset:35840
    v_cvt_pk_bf16_f32 v160, v160, v161
    v_mfma_f32_16x16x32_bf16 v[240:243], v[64:67], v[112:115], v[240:243]
    ds_read_b64_tr_b16 v[88:89], v20 offset:20512
    v_cvt_pk_bf16_f32 v161, v162, v163
    v_mfma_f32_16x16x32_bf16 v[240:243], v[68:71], v[128:131], v[240:243]
    ds_read_b64_tr_b16 v[90:91], v20 offset:25632
    v_cvt_pk_bf16_f32 v162, v168, v169
    v_mfma_f32_16x16x32_bf16 v[244:247], v[64:67], v[116:119], v[244:247]
    ds_read_b64_tr_b16 v[92:93], v20 offset:30752
    v_cvt_pk_bf16_f32 v163, v170, v171
    v_mfma_f32_16x16x32_bf16 v[244:247], v[68:71], v[132:135], v[244:247]
    ds_read_b64_tr_b16 v[94:95], v20 offset:35872
    v_cvt_pk_bf16_f32 v164, v164, v165
    s_waitcnt lgkmcnt(8)
    v_mfma_f32_16x16x32_bf16 v[248:251], v[72:75], v[112:115], v[248:251]
    ds_read_b64_tr_b16 v[64:65], v19 offset:20544
    v_cvt_pk_bf16_f32 v165, v166, v167
    v_mfma_f32_16x16x32_bf16 v[248:251], v[76:79], v[128:131], v[248:251]
    ds_read_b64_tr_b16 v[66:67], v19 offset:25664
    v_cvt_pk_bf16_f32 v166, v172, v173
    v_mfma_f32_16x16x32_bf16 v[252:255], v[72:75], v[116:119], v[252:255]
    ds_read_b64_tr_b16 v[68:69], v19 offset:30784
    v_cvt_pk_bf16_f32 v167, v174, v175
    v_mfma_f32_16x16x32_bf16 v[252:255], v[76:79], v[132:135], v[252:255]
    ds_read_b64_tr_b16 v[70:71], v19 offset:35904
    s_waitcnt lgkmcnt(8)
    v_mfma_f32_16x16x32_bf16 v[176:179], v[80:83], v[144:147], v[176:179]
    ds_read_b64_tr_b16 v[72:73], v20 offset:20576
    v_mfma_f32_16x16x32_bf16 v[176:179], v[84:87], v[160:163], v[176:179]
    ds_read_b64_tr_b16 v[74:75], v20 offset:25696
    v_mfma_f32_16x16x32_bf16 v[180:183], v[80:83], v[148:151], v[180:183]
    ds_read_b64_tr_b16 v[76:77], v20 offset:30816
    v_mfma_f32_16x16x32_bf16 v[180:183], v[84:87], v[164:167], v[180:183]
    ds_read_b64_tr_b16 v[78:79], v20 offset:35936
    s_waitcnt lgkmcnt(8)
    v_mfma_f32_16x16x32_bf16 v[184:187], v[88:91], v[144:147], v[184:187]
    ds_read_b64_tr_b16 v[80:81], v19 offset:20608
    v_mfma_f32_16x16x32_bf16 v[184:187], v[92:95], v[160:163], v[184:187]
    ds_read_b64_tr_b16 v[82:83], v19 offset:25728
    v_mfma_f32_16x16x32_bf16 v[188:191], v[88:91], v[148:151], v[188:191]
    ds_read_b64_tr_b16 v[84:85], v19 offset:30848
    v_mfma_f32_16x16x32_bf16 v[188:191], v[92:95], v[164:167], v[188:191]
    ds_read_b64_tr_b16 v[86:87], v19 offset:35968
    s_waitcnt lgkmcnt(8)
    v_mfma_f32_16x16x32_bf16 v[192:195], v[64:67], v[144:147], v[192:195]
    ds_read_b64_tr_b16 v[88:89], v20 offset:20640
    v_mfma_f32_16x16x32_bf16 v[192:195], v[68:71], v[160:163], v[192:195]
    ds_read_b64_tr_b16 v[90:91], v20 offset:25760
    v_mfma_f32_16x16x32_bf16 v[196:199], v[64:67], v[148:151], v[196:199]
    ds_read_b64_tr_b16 v[92:93], v20 offset:30880
    v_mfma_f32_16x16x32_bf16 v[196:199], v[68:71], v[164:167], v[196:199]
    ds_read_b64_tr_b16 v[94:95], v20 offset:36000
    s_waitcnt lgkmcnt(8)
    v_mfma_f32_16x16x32_bf16 v[200:203], v[72:75], v[144:147], v[200:203]
    ds_read_b64_tr_b16 v[64:65], v19 offset:20672
    v_mfma_f32_16x16x32_bf16 v[200:203], v[76:79], v[160:163], v[200:203]
    ds_read_b64_tr_b16 v[66:67], v19 offset:25792
    v_mfma_f32_16x16x32_bf16 v[204:207], v[72:75], v[148:151], v[204:207]
    ds_read_b64_tr_b16 v[68:69], v19 offset:30912
    v_mfma_f32_16x16x32_bf16 v[204:207], v[76:79], v[164:167], v[204:207]
    ds_read_b64_tr_b16 v[70:71], v19 offset:36032
    s_waitcnt lgkmcnt(8)
    v_mfma_f32_16x16x32_bf16 v[208:211], v[80:83], v[144:147], v[208:211]
    ds_read_b64_tr_b16 v[72:73], v20 offset:20704
    v_mfma_f32_16x16x32_bf16 v[208:211], v[84:87], v[160:163], v[208:211]
    ds_read_b64_tr_b16 v[74:75], v20 offset:25824
    v_mfma_f32_16x16x32_bf16 v[212:215], v[80:83], v[148:151], v[212:215]
    ds_read_b64_tr_b16 v[76:77], v20 offset:30944
    v_mfma_f32_16x16x32_bf16 v[212:215], v[84:87], v[164:167], v[212:215]
    s_barrier
    ds_read_b64_tr_b16 v[96:97], v23 offset:32768
    ds_read_b64_tr_b16 v[78:79], v20 offset:36064
    s_waitcnt lgkmcnt(9)
    v_mfma_f32_16x16x32_bf16 v[216:219], v[88:91], v[144:147], v[216:219]
    ds_read_b64_tr_b16 v[98:99], v23 offset:34816
    ds_read_b64_tr_b16 v[80:81], v19 offset:20736
    v_mfma_f32_16x16x32_bf16 v[216:219], v[92:95], v[160:163], v[216:219]
    ds_read_b64_tr_b16 v[100:101], v24 offset:32768
    ds_read_b64_tr_b16 v[82:83], v19 offset:25856
    v_mfma_f32_16x16x32_bf16 v[220:223], v[88:91], v[148:151], v[220:223]
    ds_read_b64_tr_b16 v[102:103], v24 offset:34816
    ds_read_b64_tr_b16 v[84:85], v19 offset:30976
    v_mfma_f32_16x16x32_bf16 v[220:223], v[92:95], v[164:167], v[220:223]
    ds_read_b64_tr_b16 v[104:105], v25 offset:32768
    ds_read_b64_tr_b16 v[86:87], v19 offset:36096
    s_waitcnt lgkmcnt(13)
    v_mfma_f32_16x16x32_bf16 v[224:227], v[64:67], v[144:147], v[224:227]
    ds_read_b64_tr_b16 v[106:107], v25 offset:34816
    v_mfma_f32_16x16x32_bf16 v[224:227], v[68:71], v[160:163], v[224:227]
    ds_read_b64_tr_b16 v[108:109], v26 offset:32768
    v_mfma_f32_16x16x32_bf16 v[228:231], v[64:67], v[148:151], v[228:231]
    ds_read_b64_tr_b16 v[110:111], v26 offset:34816
    v_mfma_f32_16x16x32_bf16 v[228:231], v[68:71], v[164:167], v[228:231]
    s_waitcnt lgkmcnt(6)
    v_mfma_f32_16x16x32_bf16 v[112:115], v[96:99], v[2:5], 0
    ds_read_b64_tr_b16 v[88:89], v20 offset:20768
    v_mfma_f32_16x16x32_bf16 v[116:119], v[96:99], v[6:9], 0
    ds_read_b64_tr_b16 v[90:91], v20 offset:25888
    v_mfma_f32_16x16x32_bf16 v[120:123], v[100:103], v[2:5], 0
    ds_read_b64_tr_b16 v[92:93], v20 offset:31008
    v_mfma_f32_16x16x32_bf16 v[124:127], v[100:103], v[6:9], 0
    ds_read_b64_tr_b16 v[94:95], v20 offset:36128
    s_waitcnt lgkmcnt(4)
    v_mfma_f32_16x16x32_bf16 v[128:131], v[104:107], v[2:5], 0
    v_mfma_f32_16x16x32_bf16 v[132:135], v[104:107], v[6:9], 0
    v_mfma_f32_16x16x32_bf16 v[136:139], v[108:111], v[2:5], 0
    v_mfma_f32_16x16x32_bf16 v[140:143], v[108:111], v[6:9], 0
    v_cvt_pk_bf16_f32 v112, v112, v113
    v_cvt_pk_bf16_f32 v113, v114, v115
    v_mfma_f32_16x16x32_bf16 v[232:235], v[72:75], v[144:147], v[232:235]
    ds_read_b64_tr_b16 v[64:65], v19 offset:40960
    v_cvt_pk_bf16_f32 v114, v120, v121
    v_cvt_pk_bf16_f32 v115, v122, v123
    v_mfma_f32_16x16x32_bf16 v[232:235], v[76:79], v[160:163], v[232:235]
    ds_read_b64_tr_b16 v[66:67], v19 offset:46080
    v_cvt_pk_bf16_f32 v116, v116, v117
    v_cvt_pk_bf16_f32 v117, v118, v119
    v_mfma_f32_16x16x32_bf16 v[236:239], v[72:75], v[148:151], v[236:239]
    ds_read_b64_tr_b16 v[68:69], v19 offset:51200
    v_cvt_pk_bf16_f32 v118, v124, v125
    v_cvt_pk_bf16_f32 v119, v126, v127
    v_mfma_f32_16x16x32_bf16 v[236:239], v[76:79], v[164:167], v[236:239]
    ds_read_b64_tr_b16 v[70:71], v19 offset:56320
    v_cvt_pk_bf16_f32 v128, v128, v129
    v_mfma_f32_16x16x32_bf16 v[240:243], v[80:83], v[144:147], v[240:243]
    ds_read_b64_tr_b16 v[72:73], v20 offset:40992
    v_cvt_pk_bf16_f32 v129, v130, v131
    v_mfma_f32_16x16x32_bf16 v[240:243], v[84:87], v[160:163], v[240:243]
    ds_read_b64_tr_b16 v[74:75], v20 offset:46112
    v_cvt_pk_bf16_f32 v130, v136, v137
    v_mfma_f32_16x16x32_bf16 v[244:247], v[80:83], v[148:151], v[244:247]
    ds_read_b64_tr_b16 v[76:77], v20 offset:51232
    v_cvt_pk_bf16_f32 v131, v138, v139
    v_mfma_f32_16x16x32_bf16 v[244:247], v[84:87], v[164:167], v[244:247]
    ds_read_b64_tr_b16 v[78:79], v20 offset:56352
    v_cvt_pk_bf16_f32 v132, v132, v133
    s_waitcnt lgkmcnt(8)
    v_mfma_f32_16x16x32_bf16 v[248:251], v[88:91], v[144:147], v[248:251]
    ds_read_b64_tr_b16 v[80:81], v19 offset:41024
    v_cvt_pk_bf16_f32 v133, v134, v135
    v_mfma_f32_16x16x32_bf16 v[248:251], v[92:95], v[160:163], v[248:251]
    ds_read_b64_tr_b16 v[82:83], v19 offset:46144
    v_cvt_pk_bf16_f32 v134, v140, v141
    v_mfma_f32_16x16x32_bf16 v[252:255], v[88:91], v[148:151], v[252:255]
    ds_read_b64_tr_b16 v[84:85], v19 offset:51264
    v_cvt_pk_bf16_f32 v135, v142, v143
    v_mfma_f32_16x16x32_bf16 v[252:255], v[92:95], v[164:167], v[252:255]
    ds_read_b64_tr_b16 v[86:87], v19 offset:56384
    s_waitcnt lgkmcnt(8)
    v_mfma_f32_16x16x32_bf16 v[176:179], v[64:67], v[112:115], v[176:179]
    ds_read_b64_tr_b16 v[88:89], v20 offset:41056
    v_mfma_f32_16x16x32_bf16 v[176:179], v[68:71], v[128:131], v[176:179]
    ds_read_b64_tr_b16 v[90:91], v20 offset:46176
    v_mfma_f32_16x16x32_bf16 v[180:183], v[64:67], v[116:119], v[180:183]
    ds_read_b64_tr_b16 v[92:93], v20 offset:51296
    v_mfma_f32_16x16x32_bf16 v[180:183], v[68:71], v[132:135], v[180:183]
    ds_read_b64_tr_b16 v[94:95], v20 offset:56416
    s_waitcnt lgkmcnt(8)
    v_mfma_f32_16x16x32_bf16 v[184:187], v[72:75], v[112:115], v[184:187]
    ds_read_b64_tr_b16 v[64:65], v19 offset:41088
    v_mfma_f32_16x16x32_bf16 v[184:187], v[76:79], v[128:131], v[184:187]
    ds_read_b64_tr_b16 v[66:67], v19 offset:46208
    v_mfma_f32_16x16x32_bf16 v[188:191], v[72:75], v[116:119], v[188:191]
    ds_read_b64_tr_b16 v[68:69], v19 offset:51328
    v_mfma_f32_16x16x32_bf16 v[188:191], v[76:79], v[132:135], v[188:191]
    ds_read_b64_tr_b16 v[70:71], v19 offset:56448
    s_waitcnt lgkmcnt(8)
    v_mfma_f32_16x16x32_bf16 v[192:195], v[80:83], v[112:115], v[192:195]
    ds_read_b64_tr_b16 v[72:73], v20 offset:41120
    v_mfma_f32_16x16x32_bf16 v[192:195], v[84:87], v[128:131], v[192:195]
    ds_read_b64_tr_b16 v[74:75], v20 offset:46240
    v_mfma_f32_16x16x32_bf16 v[196:199], v[80:83], v[116:119], v[196:199]
    ds_read_b64_tr_b16 v[76:77], v20 offset:51360
    v_mfma_f32_16x16x32_bf16 v[196:199], v[84:87], v[132:135], v[196:199]
    ds_read_b64_tr_b16 v[78:79], v20 offset:56480
    s_waitcnt lgkmcnt(8)
    v_mfma_f32_16x16x32_bf16 v[200:203], v[88:91], v[112:115], v[200:203]
    ds_read_b64_tr_b16 v[80:81], v19 offset:41152
    v_mfma_f32_16x16x32_bf16 v[200:203], v[92:95], v[128:131], v[200:203]
    ds_read_b64_tr_b16 v[82:83], v19 offset:46272
    v_mfma_f32_16x16x32_bf16 v[204:207], v[88:91], v[116:119], v[204:207]
    ds_read_b64_tr_b16 v[84:85], v19 offset:51392
    v_mfma_f32_16x16x32_bf16 v[204:207], v[92:95], v[132:135], v[204:207]
    ds_read_b64_tr_b16 v[86:87], v19 offset:56512
    s_waitcnt lgkmcnt(8)
    v_mfma_f32_16x16x32_bf16 v[208:211], v[64:67], v[112:115], v[208:211]
    ds_read_b64_tr_b16 v[88:89], v20 offset:41184
    v_mfma_f32_16x16x32_bf16 v[208:211], v[68:71], v[128:131], v[208:211]
    ds_read_b64_tr_b16 v[90:91], v20 offset:46304
    v_mfma_f32_16x16x32_bf16 v[212:215], v[64:67], v[116:119], v[212:215]
    ds_read_b64_tr_b16 v[92:93], v20 offset:51424
    v_mfma_f32_16x16x32_bf16 v[212:215], v[68:71], v[132:135], v[212:215]
    s_barrier
    ds_read_b64_tr_b16 v[96:97], v23 offset:49152
    ds_read_b64_tr_b16 v[94:95], v20 offset:56544
    s_waitcnt lgkmcnt(9)
    v_mfma_f32_16x16x32_bf16 v[216:219], v[72:75], v[112:115], v[216:219]
    ds_read_b64_tr_b16 v[98:99], v23 offset:51200
    ds_read_b64_tr_b16 v[64:65], v19 offset:41216
    v_mfma_f32_16x16x32_bf16 v[216:219], v[76:79], v[128:131], v[216:219]
    ds_read_b64_tr_b16 v[100:101], v24 offset:49152
    ds_read_b64_tr_b16 v[66:67], v19 offset:46336
    v_mfma_f32_16x16x32_bf16 v[220:223], v[72:75], v[116:119], v[220:223]
    ds_read_b64_tr_b16 v[102:103], v24 offset:51200
    ds_read_b64_tr_b16 v[68:69], v19 offset:51456
    v_mfma_f32_16x16x32_bf16 v[220:223], v[76:79], v[132:135], v[220:223]
    ds_read_b64_tr_b16 v[104:105], v25 offset:49152
    ds_read_b64_tr_b16 v[70:71], v19 offset:56576
    s_waitcnt lgkmcnt(13)
    v_mfma_f32_16x16x32_bf16 v[224:227], v[80:83], v[112:115], v[224:227]
    ds_read_b64_tr_b16 v[106:107], v25 offset:51200
    v_mfma_f32_16x16x32_bf16 v[224:227], v[84:87], v[128:131], v[224:227]
    ds_read_b64_tr_b16 v[108:109], v26 offset:49152
    v_mfma_f32_16x16x32_bf16 v[228:231], v[80:83], v[116:119], v[228:231]
    ds_read_b64_tr_b16 v[110:111], v26 offset:51200
    v_mfma_f32_16x16x32_bf16 v[228:231], v[84:87], v[132:135], v[228:231]
    s_waitcnt lgkmcnt(6)
    v_mfma_f32_16x16x32_bf16 v[144:147], v[96:99], v[2:5], 0
    ds_read_b64_tr_b16 v[72:73], v20 offset:41248
    s_waitcnt vmcnt(3)
    v_max3_u32 v33, v40, v41, v42
    s_waitcnt vmcnt(2)
    v_max3_u32 v33, v33, v43, v44
    v_mfma_f32_16x16x32_bf16 v[148:151], v[96:99], v[6:9], 0
    ds_read_b64_tr_b16 v[74:75], v20 offset:46368
    v_max3_u32 v33, v33, v45, v46
    v_mfma_f32_16x16x32_bf16 v[152:155], v[100:103], v[2:5], 0
    ds_read_b64_tr_b16 v[76:77], v20 offset:51488
    s_waitcnt vmcnt(1)
    v_max3_u32 v33, v33, v47, v48
    v_mfma_f32_16x16x32_bf16 v[156:159], v[100:103], v[6:9], 0
    ds_read_b64_tr_b16 v[78:79], v20 offset:56608
    v_max3_u32 v33, v33, v49, v50
    s_waitcnt lgkmcnt(4)
    v_mfma_f32_16x16x32_bf16 v[160:163], v[104:107], v[2:5], 0
    s_waitcnt vmcnt(0)
    v_max3_u32 v33, v33, v51, v52
    v_mfma_f32_16x16x32_bf16 v[164:167], v[104:107], v[6:9], 0
    v_max3_u32 v33, v33, v53, v54
    v_mfma_f32_16x16x32_bf16 v[168:171], v[108:111], v[2:5], 0
    v_max_u32 v33, v33, v55
    v_mfma_f32_16x16x32_bf16 v[172:175], v[108:111], v[6:9], 0
    v_cvt_pk_bf16_f32 v144, v144, v145
    v_cvt_pk_bf16_f32 v145, v146, v147
    v_cmp_eq_u32 vcc, -1, v33
    v_mfma_f32_16x16x32_bf16 v[232:235], v[88:91], v[112:115], v[232:235]
    s_cbranch_vccnz L_spin4
L_back4:
    ds_read_b64_tr_b16 v[80:81], v21 offset:0
    v_cvt_pk_bf16_f32 v146, v152, v153
    v_cvt_pk_bf16_f32 v147, v154, v155
    v_mfma_f32_16x16x32_bf16 v[232:235], v[92:95], v[128:131], v[232:235]
    ds_read_b64_tr_b16 v[82:83], v21 offset:5120
    v_cvt_pk_bf16_f32 v148, v148, v149
    v_cvt_pk_bf16_f32 v149, v150, v151
    v_mfma_f32_16x16x32_bf16 v[236:239], v[88:91], v[116:119], v[236:239]
    ds_read_b64_tr_b16 v[84:85], v21 offset:10240
    v_cvt_pk_bf16_f32 v150, v156, v157
    v_cvt_pk_bf16_f32 v151, v158, v159
    v_mfma_f32_16x16x32_bf16 v[236:239], v[92:95], v[132:135], v[236:239]
    ds_read_b64_tr_b16 v[86:87], v21 offset:15360
    v_cvt_pk_bf16_f32 v160, v160, v161
    v_mfma_f32_16x16x32_bf16 v[240:243], v[64:67], v[112:115], v[240:243]
    ds_read_b64_tr_b16 v[88:89], v22 offset:32
    v_cvt_pk_bf16_f32 v161, v162, v163
    v_mfma_f32_16x16x32_bf16 v[240:243], v[68:71], v[128:131], v[240:243]
    ds_read_b64_tr_b16 v[90:91], v22 offset:5152
    v_cvt_pk_bf16_f32 v162, v168, v169
    v_mfma_f32_16x16x32_bf16 v[244:247], v[64:67], v[116:119], v[244:247]
    ds_read_b64_tr_b16 v[92:93], v22 offset:10272
    v_cvt_pk_bf16_f32 v163, v170, v171
    v_mfma_f32_16x16x32_bf16 v[244:247], v[68:71], v[132:135], v[244:247]
    ds_read_b64_tr_b16 v[94:95], v22 offset:15392
    v_cvt_pk_bf16_f32 v164, v164, v165
    s_waitcnt lgkmcnt(8)
    v_mfma_f32_16x16x32_bf16 v[248:251], v[72:75], v[112:115], v[248:251]
    ds_read_b64_tr_b16 v[64:65], v21 offset:64
    v_cvt_pk_bf16_f32 v165, v166, v167
    v_mfma_f32_16x16x32_bf16 v[248:251], v[76:79], v[128:131], v[248:251]
    ds_read_b64_tr_b16 v[66:67], v21 offset:5184
    v_cvt_pk_bf16_f32 v166, v172, v173
    v_mfma_f32_16x16x32_bf16 v[252:255], v[72:75], v[116:119], v[252:255]
    ds_read_b64_tr_b16 v[68:69], v21 offset:10304
    v_cvt_pk_bf16_f32 v167, v174, v175
    v_mfma_f32_16x16x32_bf16 v[252:255], v[76:79], v[132:135], v[252:255]
    ds_read_b64_tr_b16 v[70:71], v21 offset:15424
    s_waitcnt lgkmcnt(8)
    v_mfma_f32_16x16x32_bf16 v[176:179], v[80:83], v[144:147], v[176:179]
    ds_read_b64_tr_b16 v[72:73], v22 offset:96
    v_mfma_f32_16x16x32_bf16 v[176:179], v[84:87], v[160:163], v[176:179]
    ds_read_b64_tr_b16 v[74:75], v22 offset:5216
    v_mfma_f32_16x16x32_bf16 v[180:183], v[80:83], v[148:151], v[180:183]
    ds_read_b64_tr_b16 v[76:77], v22 offset:10336
    v_mfma_f32_16x16x32_bf16 v[180:183], v[84:87], v[164:167], v[180:183]
    ds_read_b64_tr_b16 v[78:79], v22 offset:15456
    s_waitcnt lgkmcnt(8)
    v_mfma_f32_16x16x32_bf16 v[184:187], v[88:91], v[144:147], v[184:187]
    ds_read_b64_tr_b16 v[80:81], v21 offset:128
    v_mfma_f32_16x16x32_bf16 v[184:187], v[92:95], v[160:163], v[184:187]
    ds_read_b64_tr_b16 v[82:83], v21 offset:5248
    v_mfma_f32_16x16x32_bf16 v[188:191], v[88:91], v[148:151], v[188:191]
    ds_read_b64_tr_b16 v[84:85], v21 offset:10368
    v_mfma_f32_16x16x32_bf16 v[188:191], v[92:95], v[164:167], v[188:191]
    ds_read_b64_tr_b16 v[86:87], v21 offset:15488
    s_waitcnt lgkmcnt(8)
    v_mfma_f32_16x16x32_bf16 v[192:195], v[64:67], v[144:147], v[192:195]
    ds_read_b64_tr_b16 v[88:89], v22 offset:160
    v_mfma_f32_16x16x32_bf16 v[192:195], v[68:71], v[160:163], v[192:195]
    ds_read_b64_tr_b16 v[90:91], v22 offset:5280
    v_mfma_f32_16x16x32_bf16 v[196:199], v[64:67], v[148:151], v[196:199]
    ds_read_b64_tr_b16 v[92:93], v22 offset:10400
    v_mfma_f32_16x16x32_bf16 v[196:199], v[68:71], v[164:167], v[196:199]
    ds_read_b64_tr_b16 v[94:95], v22 offset:15520
    s_waitcnt lgkmcnt(8)
    v_mfma_f32_16x16x32_bf16 v[200:203], v[72:75], v[144:147], v[200:203]
    ds_read_b64_tr_b16 v[64:65], v21 offset:192
    v_mfma_f32_16x16x32_bf16 v[200:203], v[76:79], v[160:163], v[200:203]
    ds_read_b64_tr_b16 v[66:67], v21 offset:5312
    v_mfma_f32_16x16x32_bf16 v[204:207], v[72:75], v[148:151], v[204:207]
    ds_read_b64_tr_b16 v[68:69], v21 offset:10432
    v_mfma_f32_16x16x32_bf16 v[204:207], v[76:79], v[164:167], v[204:207]
    ds_read_b64_tr_b16 v[70:71], v21 offset:15552
    s_waitcnt lgkmcnt(8)
    v_mfma_f32_16x16x32_bf16 v[208:211], v[80:83], v[144:147], v[208:211]
    ds_read_b64_tr_b16 v[72:73], v22 offset:224
    v_mfma_f32_16x16x32_bf16 v[208:211], v[84:87], v[160:163], v[208:211]
    ds_read_b64_tr_b16 v[74:75], v22 offset:5344
    v_mfma_f32_16x16x32_bf16 v[212:215], v[80:83], v[148:151], v[212:215]
    ds_read_b64_tr_b16 v[76:77], v22 offset:10464
    v_mfma_f32_16x16x32_bf16 v[212:215], v[84:87], v[164:167], v[212:215]
    s_barrier
    ds_read_b64_tr_b16 v[96:97], v23 offset:0
    ds_read_b64_tr_b16 v[78:79], v22 offset:15584
    s_waitcnt lgkmcnt(9)
    v_mfma_f32_16x16x32_bf16 v[216:219], v[88:91], v[144:147], v[216:219]
    ds_read_b64_tr_b16 v[98:99], v23 offset:2048
    ds_read_b64_tr_b16 v[80:81], v21 offset:256
    v_mfma_f32_16x16x32_bf16 v[216:219], v[92:95], v[160:163], v[216:219]
    ds_read_b64_tr_b16 v[100:101], v24 offset:0
    ds_read_b64_tr_b16 v[82:83], v21 offset:5376
    v_mfma_f32_16x16x32_bf16 v[220:223], v[88:91], v[148:151], v[220:223]
    ds_read_b64_tr_b16 v[102:103], v24 offset:2048
    ds_read_b64_tr_b16 v[84:85], v21 offset:10496
    v_mfma_f32_16x16x32_bf16 v[220:223], v[92:95], v[164:167], v[220:223]
    ds_read_b64_tr_b16 v[104:105], v25 offset:0
    ds_read_b64_tr_b16 v[86:87], v21 offset:15616
    s_waitcnt lgkmcnt(13)
    v_mfma_f32_16x16x32_bf16 v[224:227], v[64:67], v[144:147], v[224:227]
    ds_read_b64_tr_b16 v[106:107], v25 offset:2048
    v_mfma_f32_16x16x32_bf16 v[224:227], v[68:71], v[160:163], v[224:227]
    ds_read_b64_tr_b16 v[108:109], v26 offset:0
    v_mfma_f32_16x16x32_bf16 v[228:231], v[64:67], v[148:151], v[228:231]
    ds_read_b64_tr_b16 v[110:111], v26 offset:2048
    v_mfma_f32_16x16x32_bf16 v[228:231], v[68:71], v[164:167], v[228:231]
    s_waitcnt lgkmcnt(6)
    v_mfma_f32_16x16x32_bf16 v[112:115], v[96:99], v[40:43], 0
    ds_read_b64_tr_b16 v[88:89], v22 offset:288
    v_mfma_f32_16x16x32_bf16 v[116:119], v[96:99], v[44:47], 0
    ds_read_b64_tr_b16 v[90:91], v22 offset:5408
    v_mfma_f32_16x16x32_bf16 v[120:123], v[100:103], v[40:43], 0
    ds_read_b64_tr_b16 v[92:93], v22 offset:10528
    v_mfma_f32_16x16x32_bf16 v[124:127], v[100:103], v[44:47], 0
    ds_read_b64_tr_b16 v[94:95], v22 offset:15648
    s_waitcnt lgkmcnt(4)
    v_mfma_f32_16x16x32_bf16 v[128:131], v[104:107], v[40:43], 0
    v_mfma_f32_16x16x32_bf16 v[132:135], v[104:107], v[44:47], 0
    v_mfma_f32_16x16x32_bf16 v[136:139], v[108:111], v[40:43], 0
    v_mfma_f32_16x16x32_bf16 v[140:143], v[108:111], v[44:47], 0
    v_cvt_pk_bf16_f32 v112, v112, v113
    v_cvt_pk_bf16_f32 v113, v114, v115
    v_mfma_f32_16x16x32_bf16 v[232:235], v[72:75], v[144:147], v[232:235]
    ds_read_b64_tr_b16 v[64:65], v19 offset:0
    v_cvt_pk_bf16_f32 v114, v120, v121
    v_cvt_pk_bf16_f32 v115, v122, v123
    v_mfma_f32_16x16x32_bf16 v[232:235], v[76:79], v[160:163], v[232:235]
    ds_read_b64_tr_b16 v[66:67], v19 offset:5120
    v_cvt_pk_bf16_f32 v116, v116, v117
    v_cvt_pk_bf16_f32 v117, v118, v119
    v_mfma_f32_16x16x32_bf16 v[236:239], v[72:75], v[148:151], v[236:239]
    ds_read_b64_tr_b16 v[68:69], v19 offset:10240
    v_cvt_pk_bf16_f32 v118, v124, v125
    v_cvt_pk_bf16_f32 v119, v126, v127
    v_mfma_f32_16x16x32_bf16 v[236:239], v[76:79], v[164:167], v[236:239]
    ds_read_b64_tr_b16 v[70:71], v19 offset:15360
    v_cvt_pk_bf16_f32 v128, v128, v129
    v_mfma_f32_16x16x32_bf16 v[240:243], v[80:83], v[144:147], v[240:243]
    ds_read_b64_tr_b16 v[72:73], v20 offset:32
    v_cvt_pk_bf16_f32 v129, v130, v131
    v_mfma_f32_16x16x32_bf16 v[240:243], v[84:87], v[160:163], v[240:243]
    ds_read_b64_tr_b16 v[74:75], v20 offset:5152
    v_cvt_pk_bf16_f32 v130, v136, v137
    v_mfma_f32_16x16x32_bf16 v[244:247], v[80:83], v[148:151], v[244:247]
    ds_read_b64_tr_b16 v[76:77], v20 offset:10272
    v_cvt_pk_bf16_f32 v131, v138, v139
    v_mfma_f32_16x16x32_bf16 v[244:247], v[84:87], v[164:167], v[244:247]
    ds_read_b64_tr_b16 v[78:79], v20 offset:15392
    v_cvt_pk_bf16_f32 v132, v132, v133
    s_waitcnt lgkmcnt(8)
    v_mfma_f32_16x16x32_bf16 v[248:251], v[88:91], v[144:147], v[248:251]
    ds_read_b64_tr_b16 v[80:81], v19 offset:64
    v_cvt_pk_bf16_f32 v133, v134, v135
    v_mfma_f32_16x16x32_bf16 v[248:251], v[92:95], v[160:163], v[248:251]
    ds_read_b64_tr_b16 v[82:83], v19 offset:5184
    v_cvt_pk_bf16_f32 v134, v140, v141
    v_mfma_f32_16x16x32_bf16 v[252:255], v[88:91], v[148:151], v[252:255]
    ds_read_b64_tr_b16 v[84:85], v19 offset:10304
    v_cvt_pk_bf16_f32 v135, v142, v143
    v_mfma_f32_16x16x32_bf16 v[252:255], v[92:95], v[164:167], v[252:255]
    ds_read_b64_tr_b16 v[86:87], v19 offset:15424
    s_waitcnt lgkmcnt(8)
    v_mfma_f32_16x16x32_bf16 v[176:179], v[64:67], v[112:115], v[176:179]
    ds_read_b64_tr_b16 v[88:89], v20 offset:96
    v_mfma_f32_16x16x32_bf16 v[176:179], v[68:71], v[128:131], v[176:179]
    ds_read_b64_tr_b16 v[90:91], v20 offset:5216
    v_mfma_f32_16x16x32_bf16 v[180:183], v[64:67], v[116:119], v[180:183]
    ds_read_b64_tr_b16 v[92:93], v20 offset:10336
    v_mfma_f32_16x16x32_bf16 v[180:183], v[68:71], v[132:135], v[180:183]
    ds_read_b64_tr_b16 v[94:95], v20 offset:15456
    s_waitcnt lgkmcnt(8)
    v_mfma_f32_16x16x32_bf16 v[184:187], v[72:75], v[112:115], v[184:187]
    ds_read_b64_tr_b16 v[64:65], v19 offset:128
    v_mfma_f32_16x16x32_bf16 v[184:187], v[76:79], v[128:131], v[184:187]
    ds_read_b64_tr_b16 v[66:67], v19 offset:5248
    v_mfma_f32_16x16x32_bf16 v[188:191], v[72:75], v[116:119], v[188:191]
    ds_read_b64_tr_b16 v[68:69], v19 offset:10368
    v_mfma_f32_16x16x32_bf16 v[188:191], v[76:79], v[132:135], v[188:191]
    ds_read_b64_tr_b16 v[70:71], v19 offset:15488
    s_waitcnt lgkmcnt(8)
    v_mfma_f32_16x16x32_bf16 v[192:195], v[80:83], v[112:115], v[192:195]
    ds_read_b64_tr_b16 v[72:73], v20 offset:160
    v_mfma_f32_16x16x32_bf16 v[192:195], v[84:87], v[128:131], v[192:195]
    ds_read_b64_tr_b16 v[74:75], v20 offset:5280
    v_mfma_f32_16x16x32_bf16 v[196:199], v[80:83], v[116:119], v[196:199]
    ds_read_b64_tr_b16 v[76:77], v20 offset:10400
    v_mfma_f32_16x16x32_bf16 v[196:199], v[84:87], v[132:135], v[196:199]
    ds_read_b64_tr_b16 v[78:79], v20 offset:15520
    s_waitcnt lgkmcnt(8)
    v_mfma_f32_16x16x32_bf16 v[200:203], v[88:91], v[112:115], v[200:203]
    ds_read_b64_tr_b16 v[80:81], v19 offset:192
    v_mfma_f32_16x16x32_bf16 v[200:203], v[92:95], v[128:131], v[200:203]
    ds_read_b64_tr_b16 v[82:83], v19 offset:5312
    v_mfma_f32_16x16x32_bf16 v[204:207], v[88:91], v[116:119], v[204:207]
    ds_read_b64_tr_b16 v[84:85], v19 offset:10432
    v_mfma_f32_16x16x32_bf16 v[204:207], v[92:95], v[132:135], v[204:207]
    ds_read_b64_tr_b16 v[86:87], v19 offset:15552
    s_waitcnt lgkmcnt(8)
    v_mfma_f32_16x16x32_bf16 v[208:211], v[64:67], v[112:115], v[208:211]
    ds_read_b64_tr_b16 v[88:89], v20 offset:224
    v_mfma_f32_16x16x32_bf16 v[208:211], v[68:71], v[128:131], v[208:211]
    ds_read_b64_tr_b16 v[90:91], v20 offset:5344
    v_mfma_f32_16x16x32_bf16 v[212:215], v[64:67], v[116:119], v[212:215]
    ds_read_b64_tr_b16 v[92:93], v20 offset:10464
    v_mfma_f32_16x16x32_bf16 v[212:215], v[68:71], v[132:135], v[212:215]
    s_barrier
    ds_read_b64_tr_b16 v[96:97], v23 offset:16384
    ds_read_b64_tr_b16 v[94:95], v20 offset:15584
    s_waitcnt lgkmcnt(9)
    v_mfma_f32_16x16x32_bf16 v[216:219], v[72:75], v[112:115], v[216:219]
    ds_read_b64_tr_b16 v[98:99], v23 offset:18432
    ds_read_b64_tr_b16 v[64:65], v19 offset:256
    v_mfma_f32_16x16x32_bf16 v[216:219], v[76:79], v[128:131], v[216:219]
    ds_read_b64_tr_b16 v[100:101], v24 offset:16384
    ds_read_b64_tr_b16 v[66:67], v19 offset:5376
    v_mfma_f32_16x16x32_bf16 v[220:223], v[72:75], v[116:119], v[220:223]
    ds_read_b64_tr_b16 v[102:103], v24 offset:18432
    ds_read_b64_tr_b16 v[68:69], v19 offset:10496
    v_mfma_f32_16x16x32_bf16 v[220:223], v[76:79], v[132:135], v[220:223]
    ds_read_b64_tr_b16 v[104:105], v25 offset:16384
    ds_read_b64_tr_b16 v[70:71], v19 offset:15616
    s_waitcnt lgkmcnt(13)
    v_mfma_f32_16x16x32_bf16 v[224:227], v[80:83], v[112:115], v[224:227]
    ds_read_b64_tr_b16 v[106:107], v25 offset:18432
    v_mfma_f32_16x16x32_bf16 v[224:227], v[84:87], v[128:131], v[224:227]
    ds_read_b64_tr_b16 v[108:109], v26 offset:16384
    v_mfma_f32_16x16x32_bf16 v[228:231], v[80:83], v[116:119], v[228:231]
    ds_read_b64_tr_b16 v[110:111], v26 offset:18432
    v_mfma_f32_16x16x32_bf16 v[228:231], v[84:87], v[132:135], v[228:231]
    s_waitcnt lgkmcnt(6)
    v_mfma_f32_16x16x32_bf16 v[144:147], v[96:99], v[40:43], 0
    ds_read_b64_tr_b16 v[72:73], v20 offset:288
    s_add_u32 s77, s6, 3
    v_mfma_f32_16x16x32_bf16 v[148:151], v[96:99], v[44:47], 0
    ds_read_b64_tr_b16 v[74:75], v20 offset:5408
    s_and_b32 s77, s77, 3
    v_mfma_f32_16x16x32_bf16 v[152:155], v[100:103], v[40:43], 0
    ds_read_b64_tr_b16 v[76:77], v20 offset:10528
    s_lshl_b32 s77, s77, 12
    v_mfma_f32_16x16x32_bf16 v[156:159], v[100:103], v[44:47], 0
    ds_read_b64_tr_b16 v[78:79], v20 offset:15648
    s_add_u32 s77, s77, s83
    s_waitcnt lgkmcnt(4)
    v_mfma_f32_16x16x32_bf16 v[160:163], v[104:107], v[40:43], 0
    buffer_load_dwordx4 v[56:59], v28, s[64:67], s77 offen offset:0 sc1
    v_mfma_f32_16x16x32_bf16 v[164:167], v[104:107], v[44:47], 0
    buffer_load_dwordx4 v[60:63], v28, s[64:67], s77 offen offset:1024 sc1
    v_mfma_f32_16x16x32_bf16 v[168:171], v[108:111], v[40:43], 0
    buffer_load_dwordx4 v[2:5], v28, s[64:67], s77 offen offset:2048 sc1
    v_mfma_f32_16x16x32_bf16 v[172:175], v[108:111], v[44:47], 0
    v_cvt_pk_bf16_f32 v144, v144, v145
    v_cvt_pk_bf16_f32 v145, v146, v147
    buffer_load_dwordx4 v[6:9], v28, s[64:67], s77 offen offset:3072 sc1
    v_mfma_f32_16x16x32_bf16 v[232:235], v[88:91], v[112:115], v[232:235]
    ds_read_b64_tr_b16 v[80:81], v19 offset:20480
    v_cvt_pk_bf16_f32 v146, v152, v153
    v_cvt_pk_bf16_f32 v147, v154, v155
    v_mfma_f32_16x16x32_bf16 v[232:235], v[92:95], v[128:131], v[232:235]
    ds_read_b64_tr_b16 v[82:83], v19 offset:25600
    v_cvt_pk_bf16_f32 v148, v148, v149
    v_cvt_pk_bf16_f32 v149, v150, v151
    v_mfma_f32_16x16x32_bf16 v[236:239], v[88:91], v[116:119], v[236:239]
    ds_read_b64_tr_b16 v[84:85], v19 offset:30720
    v_cvt_pk_bf16_f32 v150, v156, v157
    v_cvt_pk_bf16_f32 v151, v158, v159
    v_mfma_f32_16x16x32_bf16 v[236:239], v[92:95], v[132:135], v[236:239]
    ds_read_b64_tr_b16 v[86:87], v19 offset:35840
    v_cvt_pk_bf16_f32 v160, v160, v161
    v_mfma_f32_16x16x32_bf16 v[240:243], v[64:67], v[112:115], v[240:243]
    ds_read_b64_tr_b16 v[88:89], v20 offset:20512
    v_cvt_pk_bf16_f32 v161, v162, v163
    v_mfma_f32_16x16x32_bf16 v[240:243], v[68:71], v[128:131], v[240:243]
    ds_read_b64_tr_b16 v[90:91], v20 offset:25632
    v_cvt_pk_bf16_f32 v162, v168, v169
    v_mfma_f32_16x16x32_bf16 v[244:247], v[64:67], v[116:119], v[244:247]
    ds_read_b64_tr_b16 v[92:93], v20 offset:30752
    v_cvt_pk_bf16_f32 v163, v170, v171
    v_mfma_f32_16x16x32_bf16 v[244:247], v[68:71], v[132:135], v[244:247]
    ds_read_b64_tr_b16 v[94:95], v20 offset:35872
    v_cvt_pk_bf16_f32 v164, v164, v165
    s_waitcnt lgkmcnt(8)
    v_mfma_f32_16x16x32_bf16 v[248:251], v[72:75], v[112:115], v[248:251]
    ds_read_b64_tr_b16 v[64:65], v19 offset:20544
    v_cvt_pk_bf16_f32 v165, v166, v167
    v_mfma_f32_16x16x32_bf16 v[248:251], v[76:79], v[128:131], v[248:251]
    ds_read_b64_tr_b16 v[66:67], v19 offset:25664
    v_cvt_pk_bf16_f32 v166, v172, v173
    v_mfma_f32_16x16x32_bf16 v[252:255], v[72:75], v[116:119], v[252:255]
    ds_read_b64_tr_b16 v[68:69], v19 offset:30784
    v_cvt_pk_bf16_f32 v167, v174, v175
    v_mfma_f32_16x16x32_bf16 v[252:255], v[76:79], v[132:135], v[252:255]
    ds_read_b64_tr_b16 v[70:71], v19 offset:35904
    s_waitcnt lgkmcnt(8)
    v_mfma_f32_16x16x32_bf16 v[176:179], v[80:83], v[144:147], v[176:179]
    ds_read_b64_tr_b16 v[72:73], v20 offset:20576
    v_mfma_f32_16x16x32_bf16 v[176:179], v[84:87], v[160:163], v[176:179]
    ds_read_b64_tr_b16 v[74:75], v20 offset:25696
    v_mfma_f32_16x16x32_bf16 v[180:183], v[80:83], v[148:151], v[180:183]
    ds_read_b64_tr_b16 v[76:77], v20 offset:30816
    v_mfma_f32_16x16x32_bf16 v[180:183], v[84:87], v[164:167], v[180:183]
    ds_read_b64_tr_b16 v[78:79], v20 offset:35936
    s_waitcnt lgkmcnt(8)
    v_mfma_f32_16x16x32_bf16 v[184:187], v[88:91], v[144:147], v[184:187]
    ds_read_b64_tr_b16 v[80:81], v19 offset:20608
    v_mfma_f32_16x16x32_bf16 v[184:187], v[92:95], v[160:163], v[184:187]
    ds_read_b64_tr_b16 v[82:83], v19 offset:25728
    v_mfma_f32_16x16x32_bf16 v[188:191], v[88:91], v[148:151], v[188:191]
    ds_read_b64_tr_b16 v[84:85], v19 offset:30848
    v_mfma_f32_16x16x32_bf16 v[188:191], v[92:95], v[164:167], v[188:191]
    ds_read_b64_tr_b16 v[86:87], v19 offset:35968
    s_waitcnt lgkmcnt(8)
    v_mfma_f32_16x16x32_bf16 v[192:195], v[64:67], v[144:147], v[192:195]
    ds_read_b64_tr_b16 v[88:89], v20 offset:20640
    v_mfma_f32_16x16x32_bf16 v[192:195], v[68:71], v[160:163], v[192:195]
    ds_read_b64_tr_b16 v[90:91], v20 offset:25760
    v_mfma_f32_16x16x32_bf16 v[196:199], v[64:67], v[148:151], v[196:199]
    ds_read_b64_tr_b16 v[92:93], v20 offset:30880
    v_mfma_f32_16x16x32_bf16 v[196:199], v[68:71], v[164:167], v[196:199]
    ds_read_b64_tr_b16 v[94:95], v20 offset:36000
    s_waitcnt lgkmcnt(8)
    v_mfma_f32_16x16x32_bf16 v[200:203], v[72:75], v[144:147], v[200:203]
    ds_read_b64_tr_b16 v[64:65], v19 offset:20672
    v_mfma_f32_16x16x32_bf16 v[200:203], v[76:79], v[160:163], v[200:203]
    ds_read_b64_tr_b16 v[66:67], v19 offset:25792
    v_mfma_f32_16x16x32_bf16 v[204:207], v[72:75], v[148:151], v[204:207]
    ds_read_b64_tr_b16 v[68:69], v19 offset:30912
    v_mfma_f32_16x16x32_bf16 v[204:207], v[76:79], v[164:167], v[204:207]
    ds_read_b64_tr_b16 v[70:71], v19 offset:36032
    s_waitcnt lgkmcnt(8)
    v_mfma_f32_16x16x32_bf16 v[208:211], v[80:83], v[144:147], v[208:211]
    ds_read_b64_tr_b16 v[72:73], v20 offset:20704
    v_mfma_f32_16x16x32_bf16 v[208:211], v[84:87], v[160:163], v[208:211]
    ds_read_b64_tr_b16 v[74:75], v20 offset:25824
    v_mfma_f32_16x16x32_bf16 v[212:215], v[80:83], v[148:151], v[212:215]
    ds_read_b64_tr_b16 v[76:77], v20 offset:30944
    v_mfma_f32_16x16x32_bf16 v[212:215], v[84:87], v[164:167], v[212:215]
    s_barrier
    ds_read_b64_tr_b16 v[96:97], v23 offset:32768
    ds_read_b64_tr_b16 v[78:79], v20 offset:36064
    s_waitcnt lgkmcnt(9)
    v_mfma_f32_16x16x32_bf16 v[216:219], v[88:91], v[144:147], v[216:219]
    ds_read_b64_tr_b16 v[98:99], v23 offset:34816
    ds_read_b64_tr_b16 v[80:81], v19 offset:20736
    v_mfma_f32_16x16x32_bf16 v[216:219], v[92:95], v[160:163], v[216:219]
    ds_read_b64_tr_b16 v[100:101], v24 offset:32768
    ds_read_b64_tr_b16 v[82:83], v19 offset:25856
    v_mfma_f32_16x16x32_bf16 v[220:223], v[88:91], v[148:151], v[220:223]
    ds_read_b64_tr_b16 v[102:103], v24 offset:34816
    ds_read_b64_tr_b16 v[84:85], v19 offset:30976
    v_mfma_f32_16x16x32_bf16 v[220:223], v[92:95], v[164:167], v[220:223]
    ds_read_b64_tr_b16 v[104:105], v25 offset:32768
    ds_read_b64_tr_b16 v[86:87], v19 offset:36096
    s_waitcnt lgkmcnt(13)
    v_mfma_f32_16x16x32_bf16 v[224:227], v[64:67], v[144:147], v[224:227]
    ds_read_b64_tr_b16 v[106:107], v25 offset:34816
    v_mfma_f32_16x16x32_bf16 v[224:227], v[68:71], v[160:163], v[224:227]
    ds_read_b64_tr_b16 v[108:109], v26 offset:32768
    v_mfma_f32_16x16x32_bf16 v[228:231], v[64:67], v[148:151], v[228:231]
    ds_read_b64_tr_b16 v[110:111], v26 offset:34816
    v_mfma_f32_16x16x32_bf16 v[228:231], v[68:71], v[164:167], v[228:231]
    s_waitcnt lgkmcnt(6)
    v_mfma_f32_16x16x32_bf16 v[112:115], v[96:99], v[48:51], 0
    ds_read_b64_tr_b16 v[88:89], v20 offset:20768
    v_mfma_f32_16x16x32_bf16 v[116:119], v[96:99], v[52:55], 0
    ds_read_b64_tr_b16 v[90:91], v20 offset:25888
    v_mfma_f32_16x16x32_bf16 v[120:123], v[100:103], v[48:51], 0
    ds_read_b64_tr_b16 v[92:93], v20 offset:31008
    v_mfma_f32_16x16x32_bf16 v[124:127], v[100:103], v[52:55], 0
    ds_read_b64_tr_b16 v[94:95], v20 offset:36128
    s_waitcnt lgkmcnt(4)
    v_mfma_f32_16x16x32_bf16 v[128:131], v[104:107], v[48:51], 0
    v_mfma_f32_16x16x32_bf16 v[132:135], v[104:107], v[52:55], 0
    v_mfma_f32_16x16x32_bf16 v[136:139], v[108:111], v[48:51], 0
    v_mfma_f32_16x16x32_bf16 v[140:143], v[108:111], v[52:55], 0
    v_cvt_pk_bf16_f32 v112, v112, v113
    v_cvt_pk_bf16_f32 v113, v114, v115
    v_mfma_f32_16x16x32_bf16 v[232:235], v[72:75], v[144:147], v[232:235]
    ds_read_b64_tr_b16 v[64:65], v19 offset:40960
    v_cvt_pk_bf16_f32 v114, v120, v121
    v_cvt_pk_bf16_f32 v115, v122, v123
    v_mfma_f32_16x16x32_bf16 v[232:235], v[76:79], v[160:163], v[232:235]
    ds_read_b64_tr_b16 v[66:67], v19 offset:46080
    v_cvt_pk_bf16_f32 v116, v116, v117
    v_cvt_pk_bf16_f32 v117, v118, v119
    v_mfma_f32_16x16x32_bf16 v[236:239], v[72:75], v[148:151], v[236:239]
    ds_read_b64_tr_b16 v[68:69], v19 offset:51200
    v_cvt_pk_bf16_f32 v118, v124, v125
    v_cvt_pk_bf16_f32 v119, v126, v127
    v_mfma_f32_16x16x32_bf16 v[236:239], v[76:79], v[164:167], v[236:239]
    ds_read_b64_tr_b16 v[70:71], v19 offset:56320
    v_cvt_pk_bf16_f32 v128, v128, v129
    v_mfma_f32_16x16x32_bf16 v[240:243], v[80:83], v[144:147], v[240:243]
    ds_read_b64_tr_b16 v[72:73], v20 offset:40992
    v_cvt_pk_bf16_f32 v129, v130, v131
    v_mfma_f32_16x16x32_bf16 v[240:243], v[84:87], v[160:163], v[240:243]
    ds_read_b64_tr_b16 v[74:75], v20 offset:46112
    v_cvt_pk_bf16_f32 v130, v136, v137
    v_mfma_f32_16x16x32_bf16 v[244:247], v[80:83], v[148:151], v[244:247]
    ds_read_b64_tr_b16 v[76:77], v20 offset:51232
    v_cvt_pk_bf16_f32 v131, v138, v139
    v_mfma_f32_16x16x32_bf16 v[244:247], v[84:87], v[164:167], v[244:247]
    ds_read_b64_tr_b16 v[78:79], v20 offset:56352
    v_cvt_pk_bf16_f32 v132, v132, v133
    s_waitcnt lgkmcnt(8)
    v_mfma_f32_16x16x32_bf16 v[248:251], v[88:91], v[144:147], v[248:251]
    ds_read_b64_tr_b16 v[80:81], v19 offset:41024
    v_cvt_pk_bf16_f32 v133, v134, v135
    v_mfma_f32_16x16x32_bf16 v[248:251], v[92:95], v[160:163], v[248:251]
    ds_read_b64_tr_b16 v[82:83], v19 offset:46144
    v_cvt_pk_bf16_f32 v134, v140, v141
    v_mfma_f32_16x16x32_bf16 v[252:255], v[88:91], v[148:151], v[252:255]
    ds_read_b64_tr_b16 v[84:85], v19 offset:51264
    v_cvt_pk_bf16_f32 v135, v142, v143
    v_mfma_f32_16x16x32_bf16 v[252:255], v[92:95], v[164:167], v[252:255]
    ds_read_b64_tr_b16 v[86:87], v19 offset:56384
    s_waitcnt lgkmcnt(8)
    v_mfma_f32_16x16x32_bf16 v[176:179], v[64:67], v[112:115], v[176:179]
    ds_read_b64_tr_b16 v[88:89], v20 offset:41056
    v_mfma_f32_16x16x32_bf16 v[176:179], v[68:71], v[128:131], v[176:179]
    ds_read_b64_tr_b16 v[90:91], v20 offset:46176
    v_mfma_f32_16x16x32_bf16 v[180:183], v[64:67], v[116:119], v[180:183]
    ds_read_b64_tr_b16 v[92:93], v20 offset:51296
    v_mfma_f32_16x16x32_bf16 v[180:183], v[68:71], v[132:135], v[180:183]
    ds_read_b64_tr_b16 v[94:95], v20 offset:56416
    s_waitcnt lgkmcnt(8)
    v_mfma_f32_16x16x32_bf16 v[184:187], v[72:75], v[112:115], v[184:187]
    ds_read_b64_tr_b16 v[64:65], v19 offset:41088
    v_mfma_f32_16x16x32_bf16 v[184:187], v[76:79], v[128:131], v[184:187]
    ds_read_b64_tr_b16 v[66:67], v19 offset:46208
    v_mfma_f32_16x16x32_bf16 v[188:191], v[72:75], v[116:119], v[188:191]
    ds_read_b64_tr_b16 v[68:69], v19 offset:51328
    v_mfma_f32_16x16x32_bf16 v[188:191], v[76:79], v[132:135], v[188:191]
    ds_read_b64_tr_b16 v[70:71], v19 offset:56448
    s_waitcnt lgkmcnt(8)
    v_mfma_f32_16x16x32_bf16 v[192:195], v[80:83], v[112:115], v[192:195]
    ds_read_b64_tr_b16 v[72:73], v20 offset:41120
    v_mfma_f32_16x16x32_bf16 v[192:195], v[84:87], v[128:131], v[192:195]
    ds_read_b64_tr_b16 v[74:75], v20 offset:46240
    v_mfma_f32_16x16x32_bf16 v[196:199], v[80:83], v[116:119], v[196:199]
    ds_read_b64_tr_b16 v[76:77], v20 offset:51360
    v_mfma_f32_16x16x32_bf16 v[196:199], v[84:87], v[132:135], v[196:199]
    ds_read_b64_tr_b16 v[78:79], v20 offset:56480
    s_waitcnt lgkmcnt(8)
    v_mfma_f32_16x16x32_bf16 v[200:203], v[88:91], v[112:115], v[200:203]
    ds_read_b64_tr_b16 v[80:81], v19 offset:41152
    v_mfma_f32_16x16x32_bf16 v[200:203], v[92:95], v[128:131], v[200:203]
    ds_read_b64_tr_b16 v[82:83], v19 offset:46272
    v_mfma_f32_16x16x32_bf16 v[204:207], v[88:91], v[116:119], v[204:207]
    ds_read_b64_tr_b16 v[84:85], v19 offset:51392
    v_mfma_f32_16x16x32_bf16 v[204:207], v[92:95], v[132:135], v[204:207]
    ds_read_b64_tr_b16 v[86:87], v19 offset:56512
    s_waitcnt lgkmcnt(8)
    v_mfma_f32_16x16x32_bf16 v[208:211], v[64:67], v[112:115], v[208:211]
    ds_read_b64_tr_b16 v[88:89], v20 offset:41184
    v_mfma_f32_16x16x32_bf16 v[208:211], v[68:71], v[128:131], v[208:211]
    ds_read_b64_tr_b16 v[90:91], v20 offset:46304
    v_mfma_f32_16x16x32_bf16 v[212:215], v[64:67], v[116:119], v[212:215]
    ds_read_b64_tr_b16 v[92:93], v20 offset:51424
    v_mfma_f32_16x16x32_bf16 v[212:215], v[68:71], v[132:135], v[212:215]
    s_barrier
    ds_read_b64_tr_b16 v[96:97], v23 offset:49152
    ds_read_b64_tr_b16 v[94:95], v20 offset:56544
    s_waitcnt lgkmcnt(9)
    v_mfma_f32_16x16x32_bf16 v[216:219], v[72:75], v[112:115], v[216:219]
    ds_read_b64_tr_b16 v[98:99], v23 offset:51200
    ds_read_b64_tr_b16 v[64:65], v19 offset:41216
    v_mfma_f32_16x16x32_bf16 v[216:219], v[76:79], v[128:131], v[216:219]
    ds_read_b64_tr_b16 v[100:101], v24 offset:49152
    ds_read_b64_tr_b16 v[66:67], v19 offset:46336
    v_mfma_f32_16x16x32_bf16 v[220:223], v[72:75], v[116:119], v[220:223]
    ds_read_b64_tr_b16 v[102:103], v24 offset:51200
    ds_read_b64_tr_b16 v[68:69], v19 offset:51456
    v_mfma_f32_16x16x32_bf16 v[220:223], v[76:79], v[132:135], v[220:223]
    ds_read_b64_tr_b16 v[104:105], v25 offset:49152
    ds_read_b64_tr_b16 v[70:71], v19 offset:56576
    s_waitcnt lgkmcnt(13)
    v_mfma_f32_16x16x32_bf16 v[224:227], v[80:83], v[112:115], v[224:227]
    ds_read_b64_tr_b16 v[106:107], v25 offset:51200
    v_mfma_f32_16x16x32_bf16 v[224:227], v[84:87], v[128:131], v[224:227]
    ds_read_b64_tr_b16 v[108:109], v26 offset:49152
    v_mfma_f32_16x16x32_bf16 v[228:231], v[80:83], v[116:119], v[228:231]
    ds_read_b64_tr_b16 v[110:111], v26 offset:51200
    v_mfma_f32_16x16x32_bf16 v[228:231], v[84:87], v[132:135], v[228:231]
    s_waitcnt lgkmcnt(6)
    v_mfma_f32_16x16x32_bf16 v[144:147], v[96:99], v[48:51], 0
    ds_read_b64_tr_b16 v[72:73], v20 offset:41248
    s_waitcnt vmcnt(3)
    v_max3_u32 v33, v56, v57, v58
    s_waitcnt vmcnt(2)
    v_max3_u32 v33, v33, v59, v60
    v_mfma_f32_16x16x32_bf16 v[148:151], v[96:99], v[52:55], 0
    ds_read_b64_tr_b16 v[74:75], v20 offset:46368
    v_max3_u32 v33, v33, v61, v62
    v_mfma_f32_16x16x32_bf16 v[152:155], v[100:103], v[48:51], 0
    ds_read_b64_tr_b16 v[76:77], v20 offset:51488
    s_waitcnt vmcnt(1)
    v_max3_u32 v33, v33, v63, v2
    v_mfma_f32_16x16x32_bf16 v[156:159], v[100:103], v[52:55], 0
    ds_read_b64_tr_b16 v[78:79], v20 offset:56608
    v_max3_u32 v33, v33, v3, v4
    s_waitcnt lgkmcnt(4)
    v_mfma_f32_16x16x32_bf16 v[160:163], v[104:107], v[48:51], 0
    s_waitcnt vmcnt(0)
    v_max3_u32 v33, v33, v5, v6
    v_mfma_f32_16x16x32_bf16 v[164:167], v[104:107], v[52:55], 0
    v_max3_u32 v33, v33, v7, v8
    v_mfma_f32_16x16x32_bf16 v[168:171], v[108:111], v[48:51], 0
    v_max_u32 v33, v33, v9
    v_mfma_f32_16x16x32_bf16 v[172:175], v[108:111], v[52:55], 0
    v_cvt_pk_bf16_f32 v144, v144, v145
    v_cvt_pk_bf16_f32 v145, v146, v147
    v_cmp_eq_u32 vcc, -1, v33
    v_mfma_f32_16x16x32_bf16 v[232:235], v[88:91], v[112:115], v[232:235]
    s_cbranch_vccnz L_spin5
L_back5:
    ds_read_b64_tr_b16 v[80:81], v21 offset:0
    v_cvt_pk_bf16_f32 v146, v152, v153
    v_cvt_pk_bf16_f32 v147, v154, v155
    v_mfma_f32_16x16x32_bf16 v[232:235], v[92:95], v[128:131], v[232:235]
    ds_read_b64_tr_b16 v[82:83], v21 offset:5120
    v_cvt_pk_bf16_f32 v148, v148, v149
    v_cvt_pk_bf16_f32 v149, v150, v151
    v_mfma_f32_16x16x32_bf16 v[236:239], v[88:91], v[116:119], v[236:239]
    ds_read_b64_tr_b16 v[84:85], v21 offset:10240
    v_cvt_pk_bf16_f32 v150, v156, v157
    v_cvt_pk_bf16_f32 v151, v158, v159
    v_mfma_f32_16x16x32_bf16 v[236:239], v[92:95], v[132:135], v[236:239]
    ds_read_b64_tr_b16 v[86:87], v21 offset:15360
    v_cvt_pk_bf16_f32 v160, v160, v161
    v_mfma_f32_16x16x32_bf16 v[240:243], v[64:67], v[112:115], v[240:243]
    ds_read_b64_tr_b16 v[88:89], v22 offset:32
    v_cvt_pk_bf16_f32 v161, v162, v163
    v_mfma_f32_16x16x32_bf16 v[240:243], v[68:71], v[128:131], v[240:243]
    ds_read_b64_tr_b16 v[90:91], v22 offset:5152
    v_cvt_pk_bf16_f32 v162, v168, v169
    v_mfma_f32_16x16x32_bf16 v[244:247], v[64:67], v[116:119], v[244:247]
    ds_read_b64_tr_b16 v[92:93], v22 offset:10272
    v_cvt_pk_bf16_f32 v163, v170, v171
    v_mfma_f32_16x16x32_bf16 v[244:247], v[68:71], v[132:135], v[244:247]
    ds_read_b64_tr_b16 v[94:95], v22 offset:15392
    v_cvt_pk_bf16_f32 v164, v164, v165
    s_waitcnt lgkmcnt(8)
    v_mfma_f32_16x16x32_bf16 v[248:251], v[72:75], v[112:115], v[248:251]
    ds_read_b64_tr_b16 v[64:65], v21 offset:64
    v_cvt_pk_bf16_f32 v165, v166, v167
    v_mfma_f32_16x16x32_bf16 v[248:251], v[76:79], v[128:131], v[248:251]
    ds_read_b64_tr_b16 v[66:67], v21 offset:5184
    v_cvt_pk_bf16_f32 v166, v172, v173
    v_mfma_f32_16x16x32_bf16 v[252:255], v[72:75], v[116:119], v[252:255]
    ds_read_b64_tr_b16 v[68:69], v21 offset:10304
    v_cvt_pk_bf16_f32 v167, v174, v175
    v_mfma_f32_16x16x32_bf16 v[252:255], v[76:79], v[132:135], v[252:255]
    ds_read_b64_tr_b16 v[70:71], v21 offset:15424
    s_waitcnt lgkmcnt(8)
    v_mfma_f32_16x16x32_bf16 v[176:179], v[80:83], v[144:147], v[176:179]
    ds_read_b64_tr_b16 v[72:73], v22 offset:96
    v_mfma_f32_16x16x32_bf16 v[176:179], v[84:87], v[160:163], v[176:179]
    ds_read_b64_tr_b16 v[74:75], v22 offset:5216
    v_mfma_f32_16x16x32_bf16 v[180:183], v[80:83], v[148:151], v[180:183]
    ds_read_b64_tr_b16 v[76:77], v22 offset:10336
    v_mfma_f32_16x16x32_bf16 v[180:183], v[84:87], v[164:167], v[180:183]
    ds_read_b64_tr_b16 v[78:79], v22 offset:15456
    s_waitcnt lgkmcnt(8)
    v_mfma_f32_16x16x32_bf16 v[184:187], v[88:91], v[144:147], v[184:187]
    ds_read_b64_tr_b16 v[80:81], v21 offset:128
    v_mfma_f32_16x16x32_bf16 v[184:187], v[92:95], v[160:163], v[184:187]
    ds_read_b64_tr_b16 v[82:83], v21 offset:5248
    v_mfma_f32_16x16x32_bf16 v[188:191], v[88:91], v[148:151], v[188:191]
    ds_read_b64_tr_b16 v[84:85], v21 offset:10368
    v_mfma_f32_16x16x32_bf16 v[188:191], v[92:95], v[164:167], v[188:191]
    ds_read_b64_tr_b16 v[86:87], v21 offset:15488
    s_waitcnt lgkmcnt(8)
    v_mfma_f32_16x16x32_bf16 v[192:195], v[64:67], v[144:147], v[192:195]
    ds_read_b64_tr_b16 v[88:89], v22 offset:160
    v_mfma_f32_16x16x32_bf16 v[192:195], v[68:71], v[160:163], v[192:195]
    ds_read_b64_tr_b16 v[90:91], v22 offset:5280
    v_mfma_f32_16x16x32_bf16 v[196:199], v[64:67], v[148:151], v[196:199]
    ds_read_b64_tr_b16 v[92:93], v22 offset:10400
    v_mfma_f32_16x16x32_bf16 v[196:199], v[68:71], v[164:167], v[196:199]
    ds_read_b64_tr_b16 v[94:95], v22 offset:15520
    s_waitcnt lgkmcnt(8)
    v_mfma_f32_16x16x32_bf16 v[200:203], v[72:75], v[144:147], v[200:203]
    ds_read_b64_tr_b16 v[64:65], v21 offset:192
    v_mfma_f32_16x16x32_bf16 v[200:203], v[76:79], v[160:163], v[200:203]
    ds_read_b64_tr_b16 v[66:67], v21 offset:5312
    v_mfma_f32_16x16x32_bf16 v[204:207], v[72:75], v[148:151], v[204:207]
    ds_read_b64_tr_b16 v[68:69], v21 offset:10432
    v_mfma_f32_16x16x32_bf16 v[204:207], v[76:79], v[164:167], v[204:207]
    ds_read_b64_tr_b16 v[70:71], v21 offset:15552
    s_waitcnt lgkmcnt(8)
    v_mfma_f32_16x16x32_bf16 v[208:211], v[80:83], v[144:147], v[208:211]
    ds_read_b64_tr_b16 v[72:73], v22 offset:224
    v_mfma_f32_16x16x32_bf16 v[208:211], v[84:87], v[160:163], v[208:211]
    ds_read_b64_tr_b16 v[74:75], v22 offset:5344
    v_mfma_f32_16x16x32_bf16 v[212:215], v[80:83], v[148:151], v[212:215]
    ds_read_b64_tr_b16 v[76:77], v22 offset:10464
    v_mfma_f32_16x16x32_bf16 v[212:215], v[84:87], v[164:167], v[212:215]
    s_barrier
    ds_read_b64_tr_b16 v[96:97], v23 offset:0
    ds_read_b64_tr_b16 v[78:79], v22 offset:15584
    s_waitcnt lgkmcnt(9)
    v_mfma_f32_16x16x32_bf16 v[216:219], v[88:91], v[144:147], v[216:219]
    ds_read_b64_tr_b16 v[98:99], v23 offset:2048
    ds_read_b64_tr_b16 v[80:81], v21 offset:256
    v_mfma_f32_16x16x32_bf16 v[216:219], v[92:95], v[160:163], v[216:219]
    ds_read_b64_tr_b16 v[100:101], v24 offset:0
    ds_read_b64_tr_b16 v[82:83], v21 offset:5376
    v_mfma_f32_16x16x32_bf16 v[220:223], v[88:91], v[148:151], v[220:223]
    ds_read_b64_tr_b16 v[102:103], v24 offset:2048
    ds_read_b64_tr_b16 v[84:85], v21 offset:10496
    v_mfma_f32_16x16x32_bf16 v[220:223], v[92:95], v[164:167], v[220:223]
    ds_read_b64_tr_b16 v[104:105], v25 offset:0
    ds_read_b64_tr_b16 v[86:87], v21 offset:15616
    s_waitcnt lgkmcnt(13)
    v_mfma_f32_16x16x32_bf16 v[224:227], v[64:67], v[144:147], v[224:227]
    ds_read_b64_tr_b16 v[106:107], v25 offset:2048
    v_mfma_f32_16x16x32_bf16 v[224:227], v[68:71], v[160:163], v[224:227]
    ds_read_b64_tr_b16 v[108:109], v26 offset:0
    v_mfma_f32_16x16x32_bf16 v[228:231], v[64:67], v[148:151], v[228:231]
    ds_read_b64_tr_b16 v[110:111], v26 offset:2048
    v_mfma_f32_16x16x32_bf16 v[228:231], v[68:71], v[164:167], v[228:231]
    s_waitcnt lgkmcnt(6)
    v_mfma_f32_16x16x32_bf16 v[112:115], v[96:99], v[56:59], 0
    ds_read_b64_tr_b16 v[88:89], v22 offset:288
    v_mfma_f32_16x16x32_bf16 v[116:119], v[96:99], v[60:63], 0
    ds_read_b64_tr_b16 v[90:91], v22 offset:5408
    v_mfma_f32_16x16x32_bf16 v[120:123], v[100:103], v[56:59], 0
    ds_read_b64_tr_b16 v[92:93], v22 offset:10528
    v_mfma_f32_16x16x32_bf16 v[124:127], v[100:103], v[60:63], 0
    ds_read_b64_tr_b16 v[94:95], v22 offset:15648
    s_waitcnt lgkmcnt(4)
    v_mfma_f32_16x16x32_bf16 v[128:131], v[104:107], v[56:59], 0
    v_mfma_f32_16x16x32_bf16 v[132:135], v[104:107], v[60:63], 0
    v_mfma_f32_16x16x32_bf16 v[136:139], v[108:111], v[56:59], 0
    v_mfma_f32_16x16x32_bf16 v[140:143], v[108:111], v[60:63], 0
    v_cvt_pk_bf16_f32 v112, v112, v113
    v_cvt_pk_bf16_f32 v113, v114, v115
    v_mfma_f32_16x16x32_bf16 v[232:235], v[72:75], v[144:147], v[232:235]
    ds_read_b64_tr_b16 v[64:65], v19 offset:256
    v_cvt_pk_bf16_f32 v114, v120, v121
    v_cvt_pk_bf16_f32 v115, v122, v123
    v_mfma_f32_16x16x32_bf16 v[232:235], v[76:79], v[160:163], v[232:235]
    ds_read_b64_tr_b16 v[66:67], v19 offset:5376
    v_cvt_pk_bf16_f32 v116, v116, v117
    v_cvt_pk_bf16_f32 v117, v118, v119
    v_mfma_f32_16x16x32_bf16 v[236:239], v[72:75], v[148:151], v[236:239]
    ds_read_b64_tr_b16 v[68:69], v19 offset:10496
    v_cvt_pk_bf16_f32 v118, v124, v125
    v_cvt_pk_bf16_f32 v119, v126, v127
    v_mfma_f32_16x16x32_bf16 v[236:239], v[76:79], v[164:167], v[236:239]
    ds_read_b64_tr_b16 v[70:71], v19 offset:15616
    v_cvt_pk_bf16_f32 v128, v128, v129
    v_mfma_f32_16x16x32_bf16 v[240:243], v[80:83], v[144:147], v[240:243]
    ds_read_b64_tr_b16 v[96:97], v23 offset:16384
    ds_read_b64_tr_b16 v[98:99], v23 offset:18432
    ds_read_b64_tr_b16 v[72:73], v20 offset:288
    v_cvt_pk_bf16_f32 v129, v130, v131
    v_mfma_f32_16x16x32_bf16 v[240:243], v[84:87], v[160:163], v[240:243]
    ds_read_b64_tr_b16 v[100:101], v24 offset:16384
    ds_read_b64_tr_b16 v[102:103], v24 offset:18432
    ds_read_b64_tr_b16 v[74:75], v20 offset:5408
    v_cvt_pk_bf16_f32 v130, v136, v137
    v_mfma_f32_16x16x32_bf16 v[244:247], v[80:83], v[148:151], v[244:247]
    ds_read_b64_tr_b16 v[104:105], v25 offset:16384
    ds_read_b64_tr_b16 v[106:107], v25 offset:18432
    ds_read_b64_tr_b16 v[76:77], v20 offset:10528
    v_cvt_pk_bf16_f32 v131, v138, v139
    v_mfma_f32_16x16x32_bf16 v[244:247], v[84:87], v[164:167], v[244:247]
    ds_read_b64_tr_b16 v[108:109], v26 offset:16384
    ds_read_b64_tr_b16 v[110:111], v26 offset:18432
    ds_read_b64_tr_b16 v[78:79], v20 offset:15648
    v_cvt_pk_bf16_f32 v132, v132, v133
    s_waitcnt lgkmcnt(15)
    v_mfma_f32_16x16x32_bf16 v[248:251], v[88:91], v[144:147], v[248:251]
    s_barrier
    ds_read_b64_tr_b16 v[80:81], v19 offset:20736
    v_cvt_pk_bf16_f32 v133, v134, v135
    v_mfma_f32_16x16x32_bf16 v[248:251], v[92:95], v[160:163], v[248:251]
    ds_read_b64_tr_b16 v[82:83], v19 offset:25856
    v_cvt_pk_bf16_f32 v134, v140, v141
    v_mfma_f32_16x16x32_bf16 v[252:255], v[88:91], v[148:151], v[252:255]
    ds_read_b64_tr_b16 v[84:85], v19 offset:30976
    v_cvt_pk_bf16_f32 v135, v142, v143
    v_mfma_f32_16x16x32_bf16 v[252:255], v[92:95], v[164:167], v[252:255]
    ds_read_b64_tr_b16 v[86:87], v19 offset:36096
    s_waitcnt lgkmcnt(11)
    v_mfma_f32_16x16x32_bf16 v[144:147], v[96:99], v[56:59], 0
    v_mfma_f32_16x16x32_bf16 v[148:151], v[96:99], v[60:63], 0
    v_mfma_f32_16x16x32_bf16 v[152:155], v[100:103], v[56:59], 0
    v_mfma_f32_16x16x32_bf16 v[156:159], v[100:103], v[60:63], 0
    s_waitcnt lgkmcnt(5)
    v_mfma_f32_16x16x32_bf16 v[160:163], v[104:107], v[56:59], 0
    v_mfma_f32_16x16x32_bf16 v[164:167], v[104:107], v[60:63], 0
    v_mfma_f32_16x16x32_bf16 v[168:171], v[108:111], v[56:59], 0
    v_mfma_f32_16x16x32_bf16 v[172:175], v[108:111], v[60:63], 0
    v_mfma_f32_16x16x32_bf16 v[240:243], v[64:67], v[112:115], v[240:243]
    ds_read_b64_tr_b16 v[96:97], v23 offset:32768
    ds_read_b64_tr_b16 v[98:99], v23 offset:34816
    ds_read_b64_tr_b16 v[88:89], v20 offset:20768
    v_mfma_f32_16x16x32_bf16 v[240:243], v[68:71], v[128:131], v[240:243]
    ds_read_b64_tr_b16 v[100:101], v24 offset:32768
    ds_read_b64_tr_b16 v[102:103], v24 offset:34816
    v_cvt_pk_bf16_f32 v144, v144, v145
    v_cvt_pk_bf16_f32 v145, v146, v147
    ds_read_b64_tr_b16 v[90:91], v20 offset:25888
    v_mfma_f32_16x16x32_bf16 v[244:247], v[64:67], v[116:119], v[244:247]
    ds_read_b64_tr_b16 v[104:105], v25 offset:32768
    ds_read_b64_tr_b16 v[106:107], v25 offset:34816
    v_cvt_pk_bf16_f32 v146, v152, v153
    ds_read_b64_tr_b16 v[92:93], v20 offset:31008
    v_mfma_f32_16x16x32_bf16 v[244:247], v[68:71], v[132:135], v[244:247]
    ds_read_b64_tr_b16 v[108:109], v26 offset:32768
    ds_read_b64_tr_b16 v[110:111], v26 offset:34816
    v_cvt_pk_bf16_f32 v147, v154, v155
    ds_read_b64_tr_b16 v[94:95], v20 offset:36128
    s_waitcnt lgkmcnt(15)
    v_mfma_f32_16x16x32_bf16 v[248:251], v[72:75], v[112:115], v[248:251]
    v_cvt_pk_bf16_f32 v148, v148, v149
    v_mfma_f32_16x16x32_bf16 v[248:251], v[76:79], v[128:131], v[248:251]
    v_cvt_pk_bf16_f32 v149, v150, v151
    v_mfma_f32_16x16x32_bf16 v[252:255], v[72:75], v[116:119], v[252:255]
    v_cvt_pk_bf16_f32 v150, v156, v157
    v_mfma_f32_16x16x32_bf16 v[252:255], v[76:79], v[132:135], v[252:255]
    v_cvt_pk_bf16_f32 v151, v158, v159
    s_waitcnt lgkmcnt(7)
    v_mfma_f32_16x16x32_bf16 v[120:123], v[96:99], v[2:5], 0
    v_cvt_pk_bf16_f32 v160, v160, v161
    v_cvt_pk_bf16_f32 v161, v162, v163
    v_mfma_f32_16x16x32_bf16 v[124:127], v[96:99], v[6:9], 0
    v_cvt_pk_bf16_f32 v162, v168, v169
    v_mfma_f32_16x16x32_bf16 v[40:43], v[100:103], v[2:5], 0
    v_cvt_pk_bf16_f32 v163, v170, v171
    v_mfma_f32_16x16x32_bf16 v[44:47], v[100:103], v[6:9], 0
    v_cvt_pk_bf16_f32 v164, v164, v165
    s_waitcnt lgkmcnt(1)
    v_mfma_f32_16x16x32_bf16 v[136:139], v[104:107], v[2:5], 0
    v_cvt_pk_bf16_f32 v165, v166, v167
    v_mfma_f32_16x16x32_bf16 v[140:143], v[104:107], v[6:9], 0
    v_cvt_pk_bf16_f32 v166, v172, v173
    v_mfma_f32_16x16x32_bf16 v[48:51], v[108:111], v[2:5], 0
    v_cvt_pk_bf16_f32 v167, v174, v175
    v_mfma_f32_16x16x32_bf16 v[52:55], v[108:111], v[6:9], 0
    v_mfma_f32_16x16x32_bf16 v[240:243], v[80:83], v[144:147], v[240:243]
    s_barrier
    ds_read_b64_tr_b16 v[96:97], v23 offset:49152
    ds_read_b64_tr_b16 v[98:99], v23 offset:51200
    ds_read_b64_tr_b16 v[64:65], v19 offset:41216
    ds_read_b64_tr_b16 v[72:73], v20 offset:41248
    v_mfma_f32_16x16x32_bf16 v[240:243], v[84:87], v[160:163], v[240:243]
    ds_read_b64_tr_b16 v[100:101], v24 offset:49152
    ds_read_b64_tr_b16 v[102:103], v24 offset:51200
    v_cvt_pk_bf16_f32 v120, v120, v121
    v_cvt_pk_bf16_f32 v121, v122, v123
    ds_read_b64_tr_b16 v[66:67], v19 offset:46336
    ds_read_b64_tr_b16 v[74:75], v20 offset:46368
    v_mfma_f32_16x16x32_bf16 v[244:247], v[80:83], v[148:151], v[244:247]
    ds_read_b64_tr_b16 v[104:105], v25 offset:49152
    ds_read_b64_tr_b16 v[106:107], v25 offset:51200
    v_cvt_pk_bf16_f32 v122, v40, v41
    ds_read_b64_tr_b16 v[68:69], v19 offset:51456
    ds_read_b64_tr_b16 v[76:77], v20 offset:51488
    v_mfma_f32_16x16x32_bf16 v[244:247], v[84:87], v[164:167], v[244:247]
    ds_read_b64_tr_b16 v[108:109], v26 offset:49152
    ds_read_b64_tr_b16 v[110:111], v26 offset:51200
    v_cvt_pk_bf16_f32 v123, v42, v43
    ds_read_b64_tr_b16 v[70:71], v19 offset:56576
    ds_read_b64_tr_b16 v[78:79], v20 offset:56608
    s_waitcnt lgkmcnt(15)
    v_mfma_f32_16x16x32_bf16 v[248:251], v[88:91], v[144:147], v[248:251]
    v_cvt_pk_bf16_f32 v124, v124, v125
    v_mfma_f32_16x16x32_bf16 v[248:251], v[92:95], v[160:163], v[248:251]
    v_cvt_pk_bf16_f32 v125, v126, v127
    v_mfma_f32_16x16x32_bf16 v[252:255], v[88:91], v[148:151], v[252:255]
    v_cvt_pk_bf16_f32 v126, v44, v45
    v_mfma_f32_16x16x32_bf16 v[252:255], v[92:95], v[164:167], v[252:255]
    v_cvt_pk_bf16_f32 v127, v46, v47
    s_waitcnt lgkmcnt(10)
    v_mfma_f32_16x16x32_bf16 v[152:155], v[96:99], v[2:5], 0
    v_cvt_pk_bf16_f32 v136, v136, v137
    v_cvt_pk_bf16_f32 v137, v138, v139
    v_mfma_f32_16x16x32_bf16 v[156:159], v[96:99], v[6:9], 0
    v_cvt_pk_bf16_f32 v138, v48, v49
    v_mfma_f32_16x16x32_bf16 v[56:59], v[100:103], v[2:5], 0
    v_cvt_pk_bf16_f32 v139, v50, v51
    v_mfma_f32_16x16x32_bf16 v[60:63], v[100:103], v[6:9], 0
    v_cvt_pk_bf16_f32 v140, v140, v141
    s_waitcnt lgkmcnt(2)
    v_mfma_f32_16x16x32_bf16 v[168:171], v[104:107], v[2:5], 0
    v_cvt_pk_bf16_f32 v141, v142, v143
    v_mfma_f32_16x16x32_bf16 v[172:175], v[104:107], v[6:9], 0
    v_cvt_pk_bf16_f32 v142, v52, v53
    v_mfma_f32_16x16x32_bf16 v[10:13], v[108:111], v[2:5], 0
    v_cvt_pk_bf16_f32 v143, v54, v55
    v_mfma_f32_16x16x32_bf16 v[34:37], v[108:111], v[6:9], 0
    s_waitcnt lgkmcnt(1)
    v_mfma_f32_16x16x32_bf16 v[240:243], v[64:67], v[120:123], v[240:243]
    s_barrier
    ds_read_b64_tr_b16 v[80:81], v21 offset:256
    ds_read_b64_tr_b16 v[88:89], v22 offset:288
    v_mfma_f32_16x16x32_bf16 v[240:243], v[68:71], v[136:139], v[240:243]
    v_cvt_pk_bf16_f32 v152, v152, v153
    v_cvt_pk_bf16_f32 v153, v154, v155
    v_cvt_pk_bf16_f32 v154, v56, v57
    ds_read_b64_tr_b16 v[82:83], v21 offset:5376
    ds_read_b64_tr_b16 v[90:91], v22 offset:5408
    v_mfma_f32_16x16x32_bf16 v[244:247], v[64:67], v[124:127], v[244:247]
    v_cvt_pk_bf16_f32 v155, v58, v59
    v_cvt_pk_bf16_f32 v156, v156, v157
    ds_read_b64_tr_b16 v[84:85], v21 offset:10496
    ds_read_b64_tr_b16 v[92:93], v22 offset:10528
    v_mfma_f32_16x16x32_bf16 v[244:247], v[68:71], v[140:143], v[244:247]
    v_cvt_pk_bf16_f32 v157, v158, v159
    v_cvt_pk_bf16_f32 v158, v60, v61
    ds_read_b64_tr_b16 v[86:87], v21 offset:15616
    ds_read_b64_tr_b16 v[94:95], v22 offset:15648
    s_waitcnt lgkmcnt(8)
    v_mfma_f32_16x16x32_bf16 v[248:251], v[72:75], v[120:123], v[248:251]
    v_cvt_pk_bf16_f32 v159, v62, v63
    v_cvt_pk_bf16_f32 v168, v168, v169
    v_cvt_pk_bf16_f32 v169, v170, v171
    ds_read_b64_tr_b16 v[64:65], v19 offset:0
    v_mfma_f32_16x16x32_bf16 v[248:251], v[76:79], v[136:139], v[248:251]
    v_cvt_pk_bf16_f32 v170, v10, v11
    v_cvt_pk_bf16_f32 v171, v12, v13
    ds_read_b64_tr_b16 v[66:67], v19 offset:5120
    v_mfma_f32_16x16x32_bf16 v[252:255], v[72:75], v[124:127], v[252:255]
    v_cvt_pk_bf16_f32 v172, v172, v173
    v_cvt_pk_bf16_f32 v173, v174, v175
    ds_read_b64_tr_b16 v[68:69], v19 offset:10240
    v_mfma_f32_16x16x32_bf16 v[252:255], v[76:79], v[140:143], v[252:255]
    v_cvt_pk_bf16_f32 v174, v34, v35
    v_cvt_pk_bf16_f32 v175, v36, v37
    ds_read_b64_tr_b16 v[70:71], v19 offset:15360
    s_waitcnt lgkmcnt(5)
    v_mfma_f32_16x16x32_bf16 v[240:243], v[80:83], v[152:155], v[240:243]
    ds_read_b64_tr_b16 v[72:73], v19 offset:20480
    v_mfma_f32_16x16x32_bf16 v[240:243], v[84:87], v[168:171], v[240:243]
    ds_read_b64_tr_b16 v[74:75], v19 offset:25600
    v_mfma_f32_16x16x32_bf16 v[244:247], v[80:83], v[156:159], v[244:247]
    ds_read_b64_tr_b16 v[76:77], v19 offset:30720
    v_mfma_f32_16x16x32_bf16 v[244:247], v[84:87], v[172:175], v[244:247]
    ds_read_b64_tr_b16 v[78:79], v19 offset:35840
    s_waitcnt lgkmcnt(8)
    v_mfma_f32_16x16x32_bf16 v[248:251], v[88:91], v[152:155], v[248:251]
    ds_read_b64_tr_b16 v[80:81], v19 offset:40960
    v_mfma_f32_16x16x32_bf16 v[248:251], v[92:95], v[168:171], v[248:251]
    ds_read_b64_tr_b16 v[82:83], v19 offset:46080
    v_mfma_f32_16x16x32_bf16 v[252:255], v[88:91], v[156:159], v[252:255]
    ds_read_b64_tr_b16 v[84:85], v19 offset:51200
    v_mfma_f32_16x16x32_bf16 v[252:255], v[92:95], v[172:175], v[252:255]
    ds_read_b64_tr_b16 v[86:87], v19 offset:56320
    s_waitcnt lgkmcnt(8)
    v_mfma_f32_16x16x32_bf16 v[176:179], v[64:67], v[112:115], v[176:179]
    ds_read_b64_tr_b16 v[88:89], v21 offset:0
    v_mfma_f32_16x16x32_bf16 v[176:179], v[68:71], v[128:131], v[176:179]
    ds_read_b64_tr_b16 v[90:91], v21 offset:5120
    v_mfma_f32_16x16x32_bf16 v[180:183], v[64:67], v[116:119], v[180:183]
    ds_read_b64_tr_b16 v[92:93], v21 offset:10240
    v_cvt_pk_bf16_f32 v2, v240, v241
    v_mfma_f32_16x16x32_bf16 v[180:183], v[68:71], v[132:135], v[180:183]
    ds_read_b64_tr_b16 v[94:95], v21 offset:15360
    s_waitcnt lgkmcnt(8)
    v_mfma_f32_16x16x32_bf16 v[176:179], v[72:75], v[144:147], v[176:179]
    ds_read_b64_tr_b16 v[64:65], v20 offset:32
    v_cvt_pk_bf16_f32 v3, v242, v243
    v_mfma_f32_16x16x32_bf16 v[176:179], v[76:79], v[160:163], v[176:179]
    ds_read_b64_tr_b16 v[66:67], v20 offset:5152
    v_mfma_f32_16x16x32_bf16 v[180:183], v[72:75], v[148:151], v[180:183]
    ds_read_b64_tr_b16 v[68:69], v20 offset:10272
    s_add_u32 s77, s79, 2048
    s_cmp_eq_u32 s35, 0
    s_cselect_b32 s77, 1073741824, s77
    buffer_store_dwordx2 v[2:3], v29, s[64:67], s77 offen sc1
    v_mfma_f32_16x16x32_bf16 v[180:183], v[76:79], v[164:167], v[180:183]
    ds_read_b64_tr_b16 v[70:71], v20 offset:15392
    s_waitcnt lgkmcnt(8)
    v_mfma_f32_16x16x32_bf16 v[176:179], v[80:83], v[120:123], v[176:179]
    ds_read_b64_tr_b16 v[72:73], v20 offset:20512
    v_mfma_f32_16x16x32_bf16 v[176:179], v[84:87], v[136:139], v[176:179]
    ds_read_b64_tr_b16 v[74:75], v20 offset:25632
    v_cvt_pk_bf16_f32 v4, v244, v245
    v_mfma_f32_16x16x32_bf16 v[180:183], v[80:83], v[124:127], v[180:183]
    ds_read_b64_tr_b16 v[76:77], v20 offset:30752
    v_mfma_f32_16x16x32_bf16 v[180:183], v[84:87], v[140:143], v[180:183]
    ds_read_b64_tr_b16 v[78:79], v20 offset:35872
    v_cvt_pk_bf16_f32 v5, v246, v247
    s_waitcnt lgkmcnt(8)
    v_mfma_f32_16x16x32_bf16 v[176:179], v[88:91], v[152:155], v[176:179]
    ds_read_b64_tr_b16 v[80:81], v20 offset:40992
    v_mfma_f32_16x16x32_bf16 v[176:179], v[92:95], v[168:171], v[176:179]
    ds_read_b64_tr_b16 v[82:83], v20 offset:46112
    s_add_u32 s77, s79, 67584
    s_cmp_eq_u32 s35, 1
    s_cselect_b32 s77, 1073741824, s77
    buffer_store_dwordx2 v[4:5], v29, s[64:67], s77 offen sc1
    v_mfma_f32_16x16x32_bf16 v[180:183], v[88:91], v[156:159], v[180:183]
    ds_read_b64_tr_b16 v[84:85], v20 offset:51232
    v_mfma_f32_16x16x32_bf16 v[180:183], v[92:95], v[172:175], v[180:183]
    ds_read_b64_tr_b16 v[86:87], v20 offset:56352
    s_waitcnt lgkmcnt(8)
    v_mfma_f32_16x16x32_bf16 v[184:187], v[64:67], v[112:115], v[184:187]
    ds_read_b64_tr_b16 v[88:89], v22 offset:32
    v_cvt_pk_bf16_f32 v6, v248, v249
    v_mfma_f32_16x16x32_bf16 v[184:187], v[68:71], v[128:131], v[184:187]
    ds_read_b64_tr_b16 v[90:91], v22 offset:5152
    v_mfma_f32_16x16x32_bf16 v[188:191], v[64:67], v[116:119], v[188:191]
    ds_read_b64_tr_b16 v[92:93], v22 offset:10272
    v_cvt_pk_bf16_f32 v7, v250, v251
    v_cvt_pk_bf16_f32 v56, v176, v177
    v_mfma_f32_16x16x32_bf16 v[188:191], v[68:71], v[132:135], v[188:191]
    ds_read_b64_tr_b16 v[94:95], v22 offset:15392
    v_cvt_pk_bf16_f32 v57, v178, v179
    s_waitcnt lgkmcnt(8)
    v_mfma_f32_16x16x32_bf16 v[184:187], v[72:75], v[144:147], v[184:187]
    ds_read_b64_tr_b16 v[64:65], v19 offset:64
    s_add_u32 s77, s79, 133120
    s_cmp_eq_u32 s35, 2
    s_cselect_b32 s77, 1073741824, s77
    buffer_store_dwordx2 v[6:7], v29, s[64:67], s77 offen sc1
    v_cvt_pk_bf16_f32 v58, v180, v181
    v_mfma_f32_16x16x32_bf16 v[184:187], v[76:79], v[160:163], v[184:187]
    ds_read_b64_tr_b16 v[66:67], v19 offset:5184
    v_mfma_f32_16x16x32_bf16 v[188:191], v[72:75], v[148:151], v[188:191]
    ds_read_b64_tr_b16 v[68:69], v19 offset:10304
    v_cvt_pk_bf16_f32 v59, v182, v183
    v_mfma_f32_16x16x32_bf16 v[188:191], v[76:79], v[164:167], v[188:191]
    ds_read_b64_tr_b16 v[70:71], v19 offset:15424
    v_cvt_pk_bf16_f32 v8, v252, v253
    s_add_u32 s77, s35, 1
    s_and_b32 s77, s77, 3
    s_lshl_b32 s77, s77, 16
    s_add_u32 s78, s77, s79
    buffer_store_dwordx4 v[56:59], v28, s[64:67], s78 offen offset:0 sc1
    s_waitcnt lgkmcnt(8)
    v_mfma_f32_16x16x32_bf16 v[184:187], v[80:83], v[120:123], v[184:187]
    ds_read_b64_tr_b16 v[72:73], v19 offset:20544
    v_mfma_f32_16x16x32_bf16 v[184:187], v[84:87], v[136:139], v[184:187]
    ds_read_b64_tr_b16 v[74:75], v19 offset:25664
    v_cvt_pk_bf16_f32 v9, v254, v255
    v_mfma_f32_16x16x32_bf16 v[188:191], v[80:83], v[124:127], v[188:191]
    ds_read_b64_tr_b16 v[76:77], v19 offset:30784
    v_mfma_f32_16x16x32_bf16 v[188:191], v[84:87], v[140:143], v[188:191]
    ds_read_b64_tr_b16 v[78:79], v19 offset:35904
    s_add_u32 s77, s79, 198656
    s_cmp_eq_u32 s35, 3
    s_cselect_b32 s77, 1073741824, s77
    buffer_store_dwordx2 v[8:9], v29, s[64:67], s77 offen sc1
    s_waitcnt lgkmcnt(8)
    v_mfma_f32_16x16x32_bf16 v[184:187], v[88:91], v[152:155], v[184:187]
    ds_read_b64_tr_b16 v[80:81], v19 offset:41024
    v_mfma_f32_16x16x32_bf16 v[184:187], v[92:95], v[168:171], v[184:187]
    ds_read_b64_tr_b16 v[82:83], v19 offset:46144
    v_mfma_f32_16x16x32_bf16 v[188:191], v[88:91], v[156:159], v[188:191]
    ds_read_b64_tr_b16 v[84:85], v19 offset:51264
    v_mfma_f32_16x16x32_bf16 v[188:191], v[92:95], v[172:175], v[188:191]
    ds_read_b64_tr_b16 v[86:87], v19 offset:56384
    s_waitcnt lgkmcnt(8)
    v_mfma_f32_16x16x32_bf16 v[192:195], v[64:67], v[112:115], v[192:195]
    ds_read_b64_tr_b16 v[88:89], v21 offset:64
    v_mfma_f32_16x16x32_bf16 v[192:195], v[68:71], v[128:131], v[192:195]
    ds_read_b64_tr_b16 v[90:91], v21 offset:5184
    v_mfma_f32_16x16x32_bf16 v[196:199], v[64:67], v[116:119], v[196:199]
    ds_read_b64_tr_b16 v[92:93], v21 offset:10304
    v_cvt_pk_bf16_f32 v60, v184, v185
    v_mfma_f32_16x16x32_bf16 v[196:199], v[68:71], v[132:135], v[196:199]
    ds_read_b64_tr_b16 v[94:95], v21 offset:15424
    v_cvt_pk_bf16_f32 v61, v186, v187
    s_waitcnt lgkmcnt(8)
    v_mfma_f32_16x16x32_bf16 v[192:195], v[72:75], v[144:147], v[192:195]
    ds_read_b64_tr_b16 v[64:65], v20 offset:96
    v_cvt_pk_bf16_f32 v62, v188, v189
    v_mfma_f32_16x16x32_bf16 v[192:195], v[76:79], v[160:163], v[192:195]
    ds_read_b64_tr_b16 v[66:67], v20 offset:5216
    v_mfma_f32_16x16x32_bf16 v[196:199], v[72:75], v[148:151], v[196:199]
    ds_read_b64_tr_b16 v[68:69], v20 offset:10336
    v_cvt_pk_bf16_f32 v63, v190, v191
    v_mfma_f32_16x16x32_bf16 v[196:199], v[76:79], v[164:167], v[196:199]
    ds_read_b64_tr_b16 v[70:71], v20 offset:15456
    buffer_store_dwordx4 v[60:63], v28, s[64:67], s78 offen offset:1024 sc1
    s_waitcnt lgkmcnt(8)
    v_mfma_f32_16x16x32_bf16 v[192:195], v[80:83], v[120:123], v[192:195]
    ds_read_b64_tr_b16 v[72:73], v20 offset:20576
    v_mfma_f32_16x16x32_bf16 v[192:195], v[84:87], v[136:139], v[192:195]
    ds_read_b64_tr_b16 v[74:75], v20 offset:25696
    v_mfma_f32_16x16x32_bf16 v[196:199], v[80:83], v[124:127], v[196:199]
    ds_read_b64_tr_b16 v[76:77], v20 offset:30816
    v_mfma_f32_16x16x32_bf16 v[196:199], v[84:87], v[140:143], v[196:199]
    ds_read_b64_tr_b16 v[78:79], v20 offset:35936
    s_waitcnt lgkmcnt(8)
    v_mfma_f32_16x16x32_bf16 v[192:195], v[88:91], v[152:155], v[192:195]
    ds_read_b64_tr_b16 v[80:81], v20 offset:41056
    v_mfma_f32_16x16x32_bf16 v[192:195], v[92:95], v[168:171], v[192:195]
    ds_read_b64_tr_b16 v[82:83], v20 offset:46176
    v_mfma_f32_16x16x32_bf16 v[196:199], v[88:91], v[156:159], v[196:199]
    ds_read_b64_tr_b16 v[84:85], v20 offset:51296
    v_mfma_f32_16x16x32_bf16 v[196:199], v[92:95], v[172:175], v[196:199]
    ds_read_b64_tr_b16 v[86:87], v20 offset:56416
    s_waitcnt lgkmcnt(8)
    v_mfma_f32_16x16x32_bf16 v[200:203], v[64:67], v[112:115], v[200:203]
    ds_read_b64_tr_b16 v[88:89], v22 offset:96
    v_mfma_f32_16x16x32_bf16 v[200:203], v[68:71], v[128:131], v[200:203]
    ds_read_b64_tr_b16 v[90:91], v22 offset:5216
    v_mfma_f32_16x16x32_bf16 v[204:207], v[64:67], v[116:119], v[204:207]
    ds_read_b64_tr_b16 v[92:93], v22 offset:10336
    v_cvt_pk_bf16_f32 v2, v192, v193
    v_mfma_f32_16x16x32_bf16 v[204:207], v[68:71], v[132:135], v[204:207]
    ds_read_b64_tr_b16 v[94:95], v22 offset:15456
    v_cvt_pk_bf16_f32 v3, v194, v195
    s_waitcnt lgkmcnt(8)
    v_mfma_f32_16x16x32_bf16 v[200:203], v[72:75], v[144:147], v[200:203]
    ds_read_b64_tr_b16 v[64:65], v19 offset:128
    v_cvt_pk_bf16_f32 v4, v196, v197
    v_mfma_f32_16x16x32_bf16 v[200:203], v[76:79], v[160:163], v[200:203]
    ds_read_b64_tr_b16 v[66:67], v19 offset:5248
    v_mfma_f32_16x16x32_bf16 v[204:207], v[72:75], v[148:151], v[204:207]
    ds_read_b64_tr_b16 v[68:69], v19 offset:10368
    v_cvt_pk_bf16_f32 v5, v198, v199
    v_mfma_f32_16x16x32_bf16 v[204:207], v[76:79], v[164:167], v[204:207]
    ds_read_b64_tr_b16 v[70:71], v19 offset:15488
    s_add_u32 s77, s35, 2
    s_and_b32 s77, s77, 3
    s_lshl_b32 s77, s77, 16
    s_add_u32 s78, s77, s79
    buffer_store_dwordx4 v[2:5], v28, s[64:67], s78 offen offset:0 sc1
    s_waitcnt lgkmcnt(8)
    v_mfma_f32_16x16x32_bf16 v[200:203], v[80:83], v[120:123], v[200:203]
    ds_read_b64_tr_b16 v[72:73], v19 offset:20608
    v_mfma_f32_16x16x32_bf16 v[200:203], v[84:87], v[136:139], v[200:203]
    ds_read_b64_tr_b16 v[74:75], v19 offset:25728
    v_mfma_f32_16x16x32_bf16 v[204:207], v[80:83], v[124:127], v[204:207]
    ds_read_b64_tr_b16 v[76:77], v19 offset:30848
    v_mfma_f32_16x16x32_bf16 v[204:207], v[84:87], v[140:143], v[204:207]
    ds_read_b64_tr_b16 v[78:79], v19 offset:35968
    s_waitcnt lgkmcnt(8)
    v_mfma_f32_16x16x32_bf16 v[200:203], v[88:91], v[152:155], v[200:203]
    ds_read_b64_tr_b16 v[80:81], v19 offset:41088
    v_mfma_f32_16x16x32_bf16 v[200:203], v[92:95], v[168:171], v[200:203]
    ds_read_b64_tr_b16 v[82:83], v19 offset:46208
    v_mfma_f32_16x16x32_bf16 v[204:207], v[88:91], v[156:159], v[204:207]
    ds_read_b64_tr_b16 v[84:85], v19 offset:51328
    v_mfma_f32_16x16x32_bf16 v[204:207], v[92:95], v[172:175], v[204:207]
    ds_read_b64_tr_b16 v[86:87], v19 offset:56448
    s_waitcnt lgkmcnt(8)
    v_mfma_f32_16x16x32_bf16 v[208:211], v[64:67], v[112:115], v[208:211]
    ds_read_b64_tr_b16 v[88:89], v21 offset:128
    v_mfma_f32_16x16x32_bf16 v[208:211], v[68:71], v[128:131], v[208:211]
    ds_read_b64_tr_b16 v[90:91], v21 offset:5248
    v_mfma_f32_16x16x32_bf16 v[212:215], v[64:67], v[116:119], v[212:215]
    ds_read_b64_tr_b16 v[92:93], v21 offset:10368
    v_cvt_pk_bf16_f32 v6, v200, v201
    v_mfma_f32_16x16x32_bf16 v[212:215], v[68:71], v[132:135], v[212:215]
    ds_read_b64_tr_b16 v[94:95], v21 offset:15488
    v_cvt_pk_bf16_f32 v7, v202, v203
    s_waitcnt lgkmcnt(8)
    v_mfma_f32_16x16x32_bf16 v[208:211], v[72:75], v[144:147], v[208:211]
    ds_read_b64_tr_b16 v[64:65], v20 offset:160
    v_cvt_pk_bf16_f32 v8, v204, v205
    v_mfma_f32_16x16x32_bf16 v[208:211], v[76:79], v[160:163], v[208:211]
    ds_read_b64_tr_b16 v[66:67], v20 offset:5280
    v_mfma_f32_16x16x32_bf16 v[212:215], v[72:75], v[148:151], v[212:215]
    ds_read_b64_tr_b16 v[68:69], v20 offset:10400
    v_cvt_pk_bf16_f32 v9, v206, v207
    v_mfma_f32_16x16x32_bf16 v[212:215], v[76:79], v[164:167], v[212:215]
    ds_read_b64_tr_b16 v[70:71], v20 offset:15520
    buffer_store_dwordx4 v[6:9], v28, s[64:67], s78 offen offset:1024 sc1
    s_waitcnt lgkmcnt(8)
    v_mfma_f32_16x16x32_bf16 v[208:211], v[80:83], v[120:123], v[208:211]
    ds_read_b64_tr_b16 v[72:73], v20 offset:20640
    v_mfma_f32_16x16x32_bf16 v[208:211], v[84:87], v[136:139], v[208:211]
    ds_read_b64_tr_b16 v[74:75], v20 offset:25760
    v_mfma_f32_16x16x32_bf16 v[212:215], v[80:83], v[124:127], v[212:215]
    ds_read_b64_tr_b16 v[76:77], v20 offset:30880
    v_mfma_f32_16x16x32_bf16 v[212:215], v[84:87], v[140:143], v[212:215]
    ds_read_b64_tr_b16 v[78:79], v20 offset:36000
    s_waitcnt lgkmcnt(8)
    v_mfma_f32_16x16x32_bf16 v[208:211], v[88:91], v[152:155], v[208:211]
    ds_read_b64_tr_b16 v[80:81], v20 offset:41120
    v_mfma_f32_16x16x32_bf16 v[208:211], v[92:95], v[168:171], v[208:211]
    ds_read_b64_tr_b16 v[82:83], v20 offset:46240
    v_mfma_f32_16x16x32_bf16 v[212:215], v[88:91], v[156:159], v[212:215]
    ds_read_b64_tr_b16 v[84:85], v20 offset:51360
    v_mfma_f32_16x16x32_bf16 v[212:215], v[92:95], v[172:175], v[212:215]
    ds_read_b64_tr_b16 v[86:87], v20 offset:56480
    s_waitcnt lgkmcnt(8)
    v_mfma_f32_16x16x32_bf16 v[216:219], v[64:67], v[112:115], v[216:219]
    ds_read_b64_tr_b16 v[88:89], v22 offset:160
    v_mfma_f32_16x16x32_bf16 v[216:219], v[68:71], v[128:131], v[216:219]
    ds_read_b64_tr_b16 v[90:91], v22 offset:5280
    v_mfma_f32_16x16x32_bf16 v[220:223], v[64:67], v[116:119], v[220:223]
    ds_read_b64_tr_b16 v[92:93], v22 offset:10400
    v_cvt_pk_bf16_f32 v56, v208, v209
    v_mfma_f32_16x16x32_bf16 v[220:223], v[68:71], v[132:135], v[220:223]
    ds_read_b64_tr_b16 v[94:95], v22 offset:15520
    v_cvt_pk_bf16_f32 v57, v210, v211
    s_waitcnt lgkmcnt(8)
    v_mfma_f32_16x16x32_bf16 v[216:219], v[72:75], v[144:147], v[216:219]
    ds_read_b64_tr_b16 v[64:65], v19 offset:192
    v_cvt_pk_bf16_f32 v58, v212, v213
    v_mfma_f32_16x16x32_bf16 v[216:219], v[76:79], v[160:163], v[216:219]
    ds_read_b64_tr_b16 v[66:67], v19 offset:5312
    v_mfma_f32_16x16x32_bf16 v[220:223], v[72:75], v[148:151], v[220:223]
    ds_read_b64_tr_b16 v[68:69], v19 offset:10432
    v_cvt_pk_bf16_f32 v59, v214, v215
    v_mfma_f32_16x16x32_bf16 v[220:223], v[76:79], v[164:167], v[220:223]
    ds_read_b64_tr_b16 v[70:71], v19 offset:15552
    s_add_u32 s77, s35, 3
    s_and_b32 s77, s77, 3
    s_lshl_b32 s77, s77, 16
    s_add_u32 s78, s77, s79
    buffer_store_dwordx4 v[56:59], v28, s[64:67], s78 offen offset:0 sc1
    s_waitcnt lgkmcnt(8)
    v_mfma_f32_16x16x32_bf16 v[216:219], v[80:83], v[120:123], v[216:219]
    ds_read_b64_tr_b16 v[72:73], v19 offset:20672
    v_mfma_f32_16x16x32_bf16 v[216:219], v[84:87], v[136:139], v[216:219]
    ds_read_b64_tr_b16 v[74:75], v19 offset:25792
    v_mfma_f32_16x16x32_bf16 v[220:223], v[80:83], v[124:127], v[220:223]
    ds_read_b64_tr_b16 v[76:77], v19 offset:30912
    v_mfma_f32_16x16x32_bf16 v[220:223], v[84:87], v[140:143], v[220:223]
    ds_read_b64_tr_b16 v[78:79], v19 offset:36032
    s_waitcnt lgkmcnt(8)
    v_mfma_f32_16x16x32_bf16 v[216:219], v[88:91], v[152:155], v[216:219]
    ds_read_b64_tr_b16 v[80:81], v19 offset:41152
    v_mfma_f32_16x16x32_bf16 v[216:219], v[92:95], v[168:171], v[216:219]
    ds_read_b64_tr_b16 v[82:83], v19 offset:46272
    v_mfma_f32_16x16x32_bf16 v[220:223], v[88:91], v[156:159], v[220:223]
    ds_read_b64_tr_b16 v[84:85], v19 offset:51392
    v_mfma_f32_16x16x32_bf16 v[220:223], v[92:95], v[172:175], v[220:223]
    ds_read_b64_tr_b16 v[86:87], v19 offset:56512
    s_waitcnt lgkmcnt(8)
    v_mfma_f32_16x16x32_bf16 v[224:227], v[64:67], v[112:115], v[224:227]
    ds_read_b64_tr_b16 v[88:89], v21 offset:192
    v_mfma_f32_16x16x32_bf16 v[224:227], v[68:71], v[128:131], v[224:227]
    ds_read_b64_tr_b16 v[90:91], v21 offset:5312
    v_mfma_f32_16x16x32_bf16 v[228:231], v[64:67], v[116:119], v[228:231]
    ds_read_b64_tr_b16 v[92:93], v21 offset:10432
    v_cvt_pk_bf16_f32 v60, v216, v217
    v_mfma_f32_16x16x32_bf16 v[228:231], v[68:71], v[132:135], v[228:231]
    ds_read_b64_tr_b16 v[94:95], v21 offset:15552
    v_cvt_pk_bf16_f32 v61, v218, v219
    s_waitcnt lgkmcnt(8)
    v_mfma_f32_16x16x32_bf16 v[224:227], v[72:75], v[144:147], v[224:227]
    ds_read_b64_tr_b16 v[64:65], v20 offset:224
    v_cvt_pk_bf16_f32 v62, v220, v221
    v_mfma_f32_16x16x32_bf16 v[224:227], v[76:79], v[160:163], v[224:227]
    ds_read_b64_tr_b16 v[66:67], v20 offset:5344
    v_mfma_f32_16x16x32_bf16 v[228:231], v[72:75], v[148:151], v[228:231]
    ds_read_b64_tr_b16 v[68:69], v20 offset:10464
    v_cvt_pk_bf16_f32 v63, v222, v223
    v_mfma_f32_16x16x32_bf16 v[228:231], v[76:79], v[164:167], v[228:231]
    ds_read_b64_tr_b16 v[70:71], v20 offset:15584
    buffer_store_dwordx4 v[60:63], v28, s[64:67], s78 offen offset:1024 sc1
    s_waitcnt lgkmcnt(8)
    v_mfma_f32_16x16x32_bf16 v[224:227], v[80:83], v[120:123], v[224:227]
    ds_read_b64_tr_b16 v[72:73], v20 offset:20704
    v_mfma_f32_16x16x32_bf16 v[224:227], v[84:87], v[136:139], v[224:227]
    ds_read_b64_tr_b16 v[74:75], v20 offset:25824
    v_mfma_f32_16x16x32_bf16 v[228:231], v[80:83], v[124:127], v[228:231]
    ds_read_b64_tr_b16 v[76:77], v20 offset:30944
    v_mfma_f32_16x16x32_bf16 v[228:231], v[84:87], v[140:143], v[228:231]
    ds_read_b64_tr_b16 v[78:79], v20 offset:36064
    s_waitcnt lgkmcnt(8)
    v_mfma_f32_16x16x32_bf16 v[224:227], v[88:91], v[152:155], v[224:227]
    ds_read_b64_tr_b16 v[80:81], v20 offset:41184
    v_mfma_f32_16x16x32_bf16 v[224:227], v[92:95], v[168:171], v[224:227]
    ds_read_b64_tr_b16 v[82:83], v20 offset:46304
    v_mfma_f32_16x16x32_bf16 v[228:231], v[88:91], v[156:159], v[228:231]
    ds_read_b64_tr_b16 v[84:85], v20 offset:51424
    v_mfma_f32_16x16x32_bf16 v[228:231], v[92:95], v[172:175], v[228:231]
    ds_read_b64_tr_b16 v[86:87], v20 offset:56544
    s_waitcnt lgkmcnt(8)
    v_mfma_f32_16x16x32_bf16 v[232:235], v[64:67], v[112:115], v[232:235]
    ds_read_b64_tr_b16 v[88:89], v22 offset:224
    v_mfma_f32_16x16x32_bf16 v[232:235], v[68:71], v[128:131], v[232:235]
    ds_read_b64_tr_b16 v[90:91], v22 offset:5344
    v_mfma_f32_16x16x32_bf16 v[236:239], v[64:67], v[116:119], v[236:239]
    ds_read_b64_tr_b16 v[92:93], v22 offset:10464
    v_mfma_f32_16x16x32_bf16 v[236:239], v[68:71], v[132:135], v[236:239]
    ds_read_b64_tr_b16 v[94:95], v22 offset:15584
    s_waitcnt lgkmcnt(8)
    v_mfma_f32_16x16x32_bf16 v[232:235], v[72:75], v[144:147], v[232:235]
    ds_write_b128 v17, v[240:243] offset:32768
    v_mfma_f32_16x16x32_bf16 v[232:235], v[76:79], v[160:163], v[232:235]
    v_mfma_f32_16x16x32_bf16 v[236:239], v[72:75], v[148:151], v[236:239]
    v_mfma_f32_16x16x32_bf16 v[236:239], v[76:79], v[164:167], v[236:239]
    ds_write_b128 v17, v[244:247] offset:33792
    s_waitcnt lgkmcnt(6)
    v_mfma_f32_16x16x32_bf16 v[232:235], v[80:83], v[120:123], v[232:235]
    s_waitcnt vmcnt(4)
    s_add_u32 s77, s35, 1
    s_and_b32 s77, s77, 3
    s_lshl_b32 s77, s77, 11
    s_add_u32 s77, s77, s82
    buffer_store_dword v31, v30, s[64:67], s77 offen offset:0 sc1
    v_mfma_f32_16x16x32_bf16 v[232:235], v[84:87], v[136:139], v[232:235]
    v_mfma_f32_16x16x32_bf16 v[236:239], v[80:83], v[124:127], v[236:239]
    ds_write_b128 v17, v[248:251] offset:34816
    v_mfma_f32_16x16x32_bf16 v[236:239], v[84:87], v[140:143], v[236:239]
    s_barrier
    s_waitcnt lgkmcnt(3)
    v_mfma_f32_16x16x32_bf16 v[232:235], v[88:91], v[152:155], v[232:235]
    v_mfma_f32_16x16x32_bf16 v[232:235], v[92:95], v[168:171], v[232:235]
    ds_write_b128 v17, v[252:255] offset:35840
    v_mfma_f32_16x16x32_bf16 v[236:239], v[88:91], v[156:159], v[236:239]
    v_mfma_f32_16x16x32_bf16 v[236:239], v[92:95], v[172:175], v[236:239]
    s_waitcnt vmcnt(3)
    s_add_u32 s77, s35, 2
    s_and_b32 s77, s77, 3
    s_lshl_b32 s77, s77, 11
    s_add_u32 s77, s77, s82
    buffer_store_dword v31, v30, s[64:67], s77 offen offset:128 sc1
    ds_write_b128 v17, v[224:227] offset:0
    ds_write_b128 v17, v[228:231] offset:1024
    ds_write_b128 v17, v[232:235] offset:2048
    ds_write_b128 v17, v[236:239] offset:3072
    s_waitcnt vmcnt(2)
    s_add_u32 s77, s35, 3
    s_and_b32 s77, s77, 3
    s_lshl_b32 s77, s77, 11
    s_add_u32 s77, s77, s82
    buffer_store_dword v31, v30, s[64:67], s77 offen offset:256 sc1
    s_waitcnt lgkmcnt(0)
    s_barrier
    s_endpgm
L_code_end:
.section .rodata,"a"
.p2align 6
.amdhsa_kernel concat_heads__mha_block_cached__gqa_block_cached__near_ridge_kernel
  .amdhsa_next_free_vgpr 256
  .amdhsa_next_free_sgpr 102
  .amdhsa_accum_offset 256
  .amdhsa_group_segment_fixed_size 0
  .amdhsa_kernarg_size 104
  .amdhsa_user_sgpr_count 2
  .amdhsa_user_sgpr_kernarg_segment_ptr 1
  .amdhsa_system_sgpr_workgroup_id_x 1
.end_amdhsa_kernel
```
